```python
import torch

def _softmax(x, axis=-1):
    return torch.softmax(x, dim=axis)

def _gelu(x):
    return torch.nn.functional.gelu(x, approximate='tanh')

def _silu(x):
    return torch.nn.functional.silu(x)

def _sigmoid(x):
    return torch.sigmoid(x)

def _layernorm(x, axis=-1, eps=1e-05):
    m = x.mean(dim=axis, keepdim=True)
    v = x.var(dim=axis, keepdim=True, unbiased=False)
    return (x - m) / torch.sqrt(v + eps)

def _scatter_add(tgt, idx, src, axis=0):
    return tgt.clone().index_add_(axis, idx, src)

def _segment_sum(src, seg, n):
    out = torch.zeros((n,) + src.shape[1:], dtype=src.dtype)
    return out.index_add_(0, seg, src)

def _pad(x, pw):
    flat = tuple((v for pair in reversed(pw) for v in pair))
    return torch.nn.functional.pad(x, flat)
kernel_name = 'adaLN_cond__memory_aug_recurrent_mem_tr__moe_arch_mod__prompt'

def setup_inputs():

    _w = lambda a: (lambda t: t.to(torch.bfloat16) if t.is_floating_point() else t)(torch.as_tensor(a))

    def _A_setup():
        B, S, Dm = (1, 2048, 448)
        H, Dh = (16, 256)
        M, seg = (8, 32)
        seg = min(seg, S)
        S = S // seg * seg
        return {'x': _w((lambda *s: torch.randn(*s, dtype=torch.bfloat16) * 0.05)(B, S, Dm)), 'mem0': _w((lambda *s: torch.randn(*s, dtype=torch.bfloat16) * 0.4)(B, M, Dm)), 'Wq': _w((lambda *s: torch.randn(*s, dtype=torch.bfloat16) * 3.2)(Dm, H, Dh) * Dm ** (-0.5)), 'Wk': _w((lambda *s: torch.randn(*s, dtype=torch.bfloat16) * 3.2)(Dm, H, Dh) * Dm ** (-0.5)), 'Wv': _w((lambda *s: torch.randn(*s, dtype=torch.bfloat16) * 0.4)(Dm, H, Dh) * Dm ** (-0.5)), 'Wo': _w((lambda *s: torch.randn(*s, dtype=torch.bfloat16) * 0.4)(H, Dh, Dm) * (H * Dh) ** (-0.5)), 'seg_len': seg}
    _A_in = _A_setup()

    def _B_setup():
        B, S, D, F, C = (1, 2048, 448, 1792, 2)
        return {'x': _w((lambda *s: torch.randn(*s, dtype=torch.bfloat16) * 0.05)(B, S, D)), 'w_r': _w((lambda *s: torch.randn(*s, dtype=torch.bfloat16) * 3.2)(D)), 'w_gate': _w((lambda *s: torch.randn(*s, dtype=torch.bfloat16) * 0.1)(D, F)), 'w_up': _w((lambda *s: torch.randn(*s, dtype=torch.bfloat16) * 0.1)(D, F)), 'w_down': _w((lambda *s: torch.randn(*s, dtype=torch.bfloat16) * 0.1)(F, D))}
    _B_in = _B_setup()
    return {'A_x': _A_in['x'], 'A_mem0': _A_in['mem0'], 'A_Wq': _A_in['Wq'], 'A_Wk': _A_in['Wk'], 'A_Wv': _A_in['Wv'], 'A_Wo': _A_in['Wo'], 'A_seg_len': _A_in['seg_len'], 'B_x': _B_in['x'], 'B_w_r': _B_in['w_r'], 'B_w_gate': _B_in['w_gate'], 'B_w_up': _B_in['w_up'], 'B_w_down': _B_in['w_down'], 'c': _w((lambda *s: torch.randn(*s, dtype=torch.bfloat16) * 0.1)(1, 448) * 8.0), 'w_mod': _w((lambda *s: torch.randn(*s, dtype=torch.bfloat16) * 0.1)(448, 6 * 448) * 448 ** (-0.5) * 8.0)}

def reference(A_x, A_mem0, A_Wq, A_Wk, A_Wv, A_Wo, A_seg_len, B_x, B_w_r, B_w_gate, B_w_up, B_w_down, c, w_mod):

    def _A_ref(x, mem0, Wq, Wk, Wv, Wo, seg_len):
        B, S, Dm = x.shape
        H, Dh = (Wq.shape[1], Wq.shape[2])
        M = mem0.shape[1]
        scale = Dh ** (-0.5)
        n_seg = S // seg_len
        L = M + seg_len
        idx = torch.arange(L)
        mask = (idx[:, None] < M) | (idx[:, None] >= idx[None, :])
        mem = mem0
        outs = []
        for s in range(n_seg):
            xs = x[:, s * seg_len:(s + 1) * seg_len, :].clone()
            h = torch.concatenate([mem, xs], axis=1)
            q = torch.einsum('btd,dhe->bhte', h, Wq)
            k = torch.einsum('btd,dhe->bhte', h, Wk)
            v = torch.einsum('btd,dhe->bhte', h, Wv)
            scores = torch.einsum('bhqe,bhke->bhqk', q, k) * scale
            scores = torch.where(mask[None, None], scores, -1000000000.0)
            p = _softmax(scores, axis=-1)
            o = torch.einsum('bhqk,bhke->bhqe', p, v)
            o = torch.einsum('bhte,hed->btd', o, Wo)
            mem = o[:, :M, :].clone()
            outs.append(o[:, M:, :])
        return torch.concatenate(outs, axis=1)

    def _B_ref(x, w_r, w_gate, w_up, w_down):
        B, S, D = x.shape
        C = 2
        r = x @ w_r
        idx = torch.argsort(-r, axis=-1)[:, :C]
        idx_e = (lambda x, n, axis: torch.repeat_interleave(x, n, dim=axis))(idx.reshape(B, C, 1), D, axis=2)
        x_sel = (lambda x, i, axis: torch.take_along_dim(x, i, dim=axis))(x, idx_e, axis=1)
        g = _silu(x_sel @ w_gate)
        u = x_sel @ w_up
        y = g * u @ w_down
        r_sel = _sigmoid((lambda x, i, axis: torch.take_along_dim(x, i, dim=axis))(r, idx, axis=1))
        y = y * r_sel.reshape(B, C, 1)
        b_off = (torch.arange(B) * S).reshape(B, 1)
        flat_idx = (idx + b_off).reshape(B * C)
        zero = (x * 0.0).reshape(B * S, D)
        upd = _scatter_add(zero, flat_idx, y.reshape(B * C, D), axis=0)
        return x + upd.reshape(B, S, D)
    x = A_x
    mod = (_silu(c) @ w_mod).reshape(c.shape[0], 6, 1, -1)
    sa, ca, ga, sb, cb, gb = (mod[:, 0].clone(), mod[:, 1].clone(), mod[:, 2].clone(), mod[:, 3].clone(), mod[:, 4].clone(), mod[:, 5].clone())
    h = _layernorm(x, axis=-1) * (1 + ca) + sa
    x = x + ga * _A_ref(h, A_mem0, A_Wq, A_Wk, A_Wv, A_Wo, A_seg_len)
    h = _layernorm(x, axis=-1) * (1 + cb) + sb
    x = x + gb * _B_ref(h, B_w_r, B_w_gate, B_w_up, B_w_down)
    return x
```

```asm
; @launch kernel=main_kernel grid=(256,1,1) block=(256,1,1) lds=163840
.amdgcn_target "amdgcn-amd-amdhsa--gfx950"
.text
.globl main_kernel
.p2align 8
.type main_kernel,@function
main_kernel:
    s_cmp_lt_u32 s2, 256
    s_cbranch_scc0 Lm_exit
    s_load_dwordx2 s[18:19], s[0:1], 120
    s_load_dwordx2 s[90:91], s[0:1], 128
    s_getreg_b32 s98, hwreg(HW_REG_XCC_ID)
    s_and_b32 s98, s98, 7
    s_memrealtime s[96:97]
    s_waitcnt lgkmcnt(0)
    s_mov_b32 s92, s90
    s_and_b32 s93, s91, 0xffff
    s_mov_b32 s94, 268435456
    s_mov_b32 s95, 0x20000
    s_mov_b32 s8, s18
    s_and_b32 s9, s19, 0xffff
    s_mov_b32 s10, 256
    s_mov_b32 s11, 0x20000
    s_lshr_b32 s96, s96, 2
    s_add_u32 s96, s96, s2
    s_and_b32 s96, s96, 15
    s_lshl_b32 s96, s96, 3
    s_or_b32 s96, s96, s98
    s_or_b32 s96, s96, 0x80
    v_mov_b32 v254, s2
    v_mov_b32 v255, s96
    v_cmp_eq_u32 vcc, 0, v0
    s_and_saveexec_b64 s[96:97], vcc
    s_cbranch_execz Lm_ra_1
    buffer_store_byte v255, v254, s[8:11], 0 offen sc1
Lm_ra_1:
    s_mov_b64 exec, s[96:97]
    v_and_b32 v1, 63, v0
    v_lshrrev_b32 v2, 6, v0
    s_nop 0
    v_readfirstlane_b32 s22, v2
    s_load_dwordx2 s[60:61], s[0:1], 16
    s_load_dwordx2 s[62:63], s[0:1], 24
    s_load_dwordx2 s[64:65], s[0:1], 32
    s_load_dwordx2 s[66:67], s[0:1], 40
    s_load_dwordx2 s[68:69], s[0:1], 128
    s_load_dwordx2 s[70:71], s[0:1], 104
    s_load_dwordx2 s[72:73], s[0:1], 96
    s_load_dwordx2 s[74:75], s[0:1], 8
    s_load_dwordx2 s[76:77], s[0:1], 0
    s_load_dwordx2 s[78:79], s[0:1], 120
    s_waitcnt lgkmcnt(0)
    s_mov_b32 s16, s68
    s_and_b32 s17, s69, 0xffff
    s_mov_b32 s18, 268435456
    s_mov_b32 s19, 0x20000
    s_mov_b32 s44, s76
    s_and_b32 s45, s77, 0xffff
    s_mov_b32 s46, 1835008
    s_mov_b32 s47, 0x20000
    s_mov_b32 s48, s78
    s_and_b32 s49, s79, 0xffff
    s_mov_b32 s50, 256
    s_mov_b32 s51, 0x20000
    s_and_b32 s20, s2, 31
    s_lshr_b32 s21, s2, 5
    s_and_b32 s23, s20, 15
    s_and_b32 s26, s21, 1
    s_lshr_b32 s27, s21, 1
    s_cmp_lt_u32 s20, 16
    s_cbranch_scc0 Lm_isU
    s_mov_b32 s8, s60
    s_and_b32 s9, s61, 0xffff
    s_mov_b32 s10, 3670016
    s_mov_b32 s11, 0x20000
    s_mov_b32 s12, s62
    s_and_b32 s13, s63, 0xffff
    s_mov_b32 s14, 3670016
    s_mov_b32 s15, 0x20000
    s_branch Lm_srd
Lm_isU:
    s_mov_b32 s8, s64
    s_and_b32 s9, s65, 0xffff
    s_mov_b32 s10, 3670016
    s_mov_b32 s11, 0x20000
    s_mov_b32 s12, s66
    s_and_b32 s13, s67, 0xffff
    s_mov_b32 s14, 3670016
    s_mov_b32 s15, 0x20000
Lm_srd:
    s_lshl_b32 s24, s27, 2
    s_add_u32 s24, s24, s22
    s_cmp_lt_u32 s24, 14
    s_cselect_b32 s25, 1, 0
    v_and_b32 v20, 31, v1
    v_lshrrev_b32 v21, 5, v1
    v_mov_b32 v3, 155648
    v_mov_b32 v4, 0
    v_mov_b32 v5, 0
    v_mov_b32 v6, 0
    v_mov_b32 v7, 0
    ds_write_b128 v3, v[4:7]
    s_waitcnt lgkmcnt(0)
    s_cmp_lt_u32 s22, 2
    s_cbranch_scc0 Lm_ef_2
    v_lshlrev_b32 v12, 4, v0
    v_mov_b32 v16, -1
    v_mov_b32 v17, -1
    v_mov_b32 v18, -1
    v_mov_b32 v19, -1
    s_lshl_b32 s28, s2, 11
    s_add_u32 s28, s28, 16534528
Lm_pz_3:
    s_cmp_lt_u32 s28, 16993280
    s_cbranch_scc0 Lm_pz_3_e
    buffer_store_dwordx4 v[16:19], v12, s[16:19], s28 offen sc1
    s_add_u32 s28, s28, 524288
    s_branch Lm_pz_3
Lm_pz_3_e:
    s_lshl_b32 s28, s2, 11
    s_add_u32 s28, s28, 16994304
Lm_pz_4:
    s_cmp_lt_u32 s28, 17518592
    s_cbranch_scc0 Lm_pz_4_e
    buffer_store_dwordx4 v[16:19], v12, s[16:19], s28 offen sc1
    s_add_u32 s28, s28, 524288
    s_branch Lm_pz_4
Lm_pz_4_e:
    s_lshl_b32 s28, s2, 11
    s_add_u32 s28, s28, 17518592
Lm_pz_5:
    s_cmp_lt_u32 s28, 17649664
    s_cbranch_scc0 Lm_pz_5_e
    buffer_store_dwordx4 v[16:19], v12, s[16:19], s28 offen sc1
    s_add_u32 s28, s28, 524288
    s_branch Lm_pz_5
Lm_pz_5_e:
    s_lshl_b32 s28, s2, 11
    s_add_u32 s28, s28, 91950080
Lm_pz_6:
    s_cmp_lt_u32 s28, 92402688
    s_cbranch_scc0 Lm_pz_6_e
    buffer_store_dwordx4 v[16:19], v12, s[16:19], s28 offen sc1
    s_add_u32 s28, s28, 524288
    s_branch Lm_pz_6
Lm_pz_6_e:
    s_cmp_eq_u32 s2, 100
    s_cbranch_scc0 Lm_ef_2
    s_mov_b32 s52, s74
    s_and_b32 s53, s75, 0xffff
    s_mov_b32 s54, 7168
    s_mov_b32 s55, 0x20000
    v_add_u32 v13, 0, v0
    v_cmp_gt_u32 vcc, 448, v13
    s_and_saveexec_b64 s[30:31], vcc
    v_and_b32 v14, 7, v13
    v_mul_u32_u24 v14, 896, v14
    v_lshrrev_b32 v15, 3, v13
    v_lshlrev_b32 v15, 4, v15
    v_add_u32 v14, v14, v15
    buffer_load_dwordx4 v[16:19], v14, s[52:55], 0 offen
    s_waitcnt vmcnt(0)
    v_lshlrev_b32 v15, 4, v13
    s_mov_b32 s28, 16527360
    buffer_store_dwordx4 v[16:19], v15, s[16:19], s28 offen sc1
    s_mov_b32 s28, 91942912
    buffer_store_dwordx4 v[16:19], v15, s[16:19], s28 offen sc1
    s_nop 1
    s_mov_b64 exec, s[30:31]
    v_add_u32 v13, 128, v0
    v_cmp_gt_u32 vcc, 448, v13
    s_and_saveexec_b64 s[30:31], vcc
    v_and_b32 v14, 7, v13
    v_mul_u32_u24 v14, 896, v14
    v_lshrrev_b32 v15, 3, v13
    v_lshlrev_b32 v15, 4, v15
    v_add_u32 v14, v14, v15
    buffer_load_dwordx4 v[16:19], v14, s[52:55], 0 offen
    s_waitcnt vmcnt(0)
    v_lshlrev_b32 v15, 4, v13
    s_mov_b32 s28, 16527360
    buffer_store_dwordx4 v[16:19], v15, s[16:19], s28 offen sc1
    s_mov_b32 s28, 91942912
    buffer_store_dwordx4 v[16:19], v15, s[16:19], s28 offen sc1
    s_nop 1
    s_mov_b64 exec, s[30:31]
    v_add_u32 v13, 256, v0
    v_cmp_gt_u32 vcc, 448, v13
    s_and_saveexec_b64 s[30:31], vcc
    v_and_b32 v14, 7, v13
    v_mul_u32_u24 v14, 896, v14
    v_lshrrev_b32 v15, 3, v13
    v_lshlrev_b32 v15, 4, v15
    v_add_u32 v14, v14, v15
    buffer_load_dwordx4 v[16:19], v14, s[52:55], 0 offen
    s_waitcnt vmcnt(0)
    v_lshlrev_b32 v15, 4, v13
    s_mov_b32 s28, 16527360
    buffer_store_dwordx4 v[16:19], v15, s[16:19], s28 offen sc1
    s_mov_b32 s28, 91942912
    buffer_store_dwordx4 v[16:19], v15, s[16:19], s28 offen sc1
    s_nop 1
    s_mov_b64 exec, s[30:31]
    v_add_u32 v13, 384, v0
    v_cmp_gt_u32 vcc, 448, v13
    s_and_saveexec_b64 s[30:31], vcc
    v_and_b32 v14, 7, v13
    v_mul_u32_u24 v14, 896, v14
    v_lshrrev_b32 v15, 3, v13
    v_lshlrev_b32 v15, 4, v15
    v_add_u32 v14, v14, v15
    buffer_load_dwordx4 v[16:19], v14, s[52:55], 0 offen
    s_waitcnt vmcnt(0)
    v_lshlrev_b32 v15, 4, v13
    s_mov_b32 s28, 16527360
    buffer_store_dwordx4 v[16:19], v15, s[16:19], s28 offen sc1
    s_mov_b32 s28, 91942912
    buffer_store_dwordx4 v[16:19], v15, s[16:19], s28 offen sc1
    s_nop 1
    s_mov_b64 exec, s[30:31]
Lm_ef_2:
    s_cmp_eq_u32 s22, 3
    s_cbranch_scc0 Lm_nox
    v_and_b32 v3, 7, v1
    v_lshrrev_b32 v4, 3, v1
    s_and_b32 s28, s2, 3
    s_lshl_b32 s28, s28, 3
    v_add_u32 v5, s28, v3
    v_mul_u32_u24 v6, 896, v5
    v_lshlrev_b32 v7, 4, v4
    v_add_u32 v6, v6, v7
    s_lshr_b32 s29, s2, 2
    s_mul_i32 s29, s29, 28672
    buffer_load_dwordx4 a[0:3], v6, s[44:47], s29 offen offset:0
    buffer_load_dwordx4 a[4:7], v6, s[44:47], s29 offen offset:128
    buffer_load_dwordx4 a[8:11], v6, s[44:47], s29 offen offset:256
    buffer_load_dwordx4 a[12:15], v6, s[44:47], s29 offen offset:384
    buffer_load_dwordx4 a[16:19], v6, s[44:47], s29 offen offset:512
    buffer_load_dwordx4 a[20:23], v6, s[44:47], s29 offen offset:640
    buffer_load_dwordx4 a[24:27], v6, s[44:47], s29 offen offset:768
Lm_nox:
    s_cmp_ge_u32 s2, 192
    s_cbranch_scc0 Lm_nomod
    s_cmp_lt_u32 s2, 234
    s_cbranch_scc0 Lm_nomod
    s_cmp_ge_u32 s22, 2
    s_cbranch_scc0 Lm_nomod
    s_mov_b32 s56, s70
    s_and_b32 s57, s71, 0xffff
    s_mov_b32 s58, 2408448
    s_mov_b32 s59, 0x20000
    s_mov_b32 s40, s72
    s_and_b32 s41, s73, 0xffff
    s_mov_b32 s42, 896
    s_mov_b32 s43, 0x20000
    s_sub_u32 s37, s2, 192
    s_lshl_b32 s37, s37, 1
    s_add_u32 s37, s37, s22
    s_sub_u32 s37, s37, 2
    v_and_b32 v30, 3, v1
    v_lshrrev_b32 v31, 2, v1
    v_mul_u32_u24 v32, 56, v31
    buffer_load_dword v192, v32, s[40:43], 0 offen offset:0
    buffer_load_dword v193, v32, s[40:43], 0 offen offset:4
    buffer_load_dword v194, v32, s[40:43], 0 offen offset:8
    buffer_load_dword v195, v32, s[40:43], 0 offen offset:12
    buffer_load_dword v196, v32, s[40:43], 0 offen offset:16
    buffer_load_dword v197, v32, s[40:43], 0 offen offset:20
    buffer_load_dword v198, v32, s[40:43], 0 offen offset:24
    buffer_load_dword v199, v32, s[40:43], 0 offen offset:28
    buffer_load_dword v200, v32, s[40:43], 0 offen offset:32
    buffer_load_dword v201, v32, s[40:43], 0 offen offset:36
    buffer_load_dword v202, v32, s[40:43], 0 offen offset:40
    buffer_load_dword v203, v32, s[40:43], 0 offen offset:44
    buffer_load_dword v204, v32, s[40:43], 0 offen offset:48
    buffer_load_dword v205, v32, s[40:43], 0 offen offset:52
    v_mul_u32_u24 v33, 28, v31
    s_movk_i32 s38, 5376
    v_mul_lo_u32 v33, v33, s38
    v_lshlrev_b32 v34, 4, v30
    v_add_u32 v33, v33, v34
    s_lshl_b32 s39, s37, 6
    buffer_load_dwordx4 v[64:67], v33, s[56:59], s39 offen
    s_add_u32 s39, s39, 5376
    buffer_load_dwordx4 v[68:71], v33, s[56:59], s39 offen
    s_add_u32 s39, s39, 5376
    buffer_load_dwordx4 v[72:75], v33, s[56:59], s39 offen
    s_add_u32 s39, s39, 5376
    buffer_load_dwordx4 v[76:79], v33, s[56:59], s39 offen
    s_add_u32 s39, s39, 5376
    buffer_load_dwordx4 v[80:83], v33, s[56:59], s39 offen
    s_add_u32 s39, s39, 5376
    buffer_load_dwordx4 v[84:87], v33, s[56:59], s39 offen
    s_add_u32 s39, s39, 5376
    buffer_load_dwordx4 v[88:91], v33, s[56:59], s39 offen
    s_add_u32 s39, s39, 5376
    buffer_load_dwordx4 v[92:95], v33, s[56:59], s39 offen
    s_add_u32 s39, s39, 5376
    buffer_load_dwordx4 v[96:99], v33, s[56:59], s39 offen
    s_add_u32 s39, s39, 5376
    buffer_load_dwordx4 v[100:103], v33, s[56:59], s39 offen
    s_add_u32 s39, s39, 5376
    buffer_load_dwordx4 v[104:107], v33, s[56:59], s39 offen
    s_add_u32 s39, s39, 5376
    buffer_load_dwordx4 v[108:111], v33, s[56:59], s39 offen
    s_add_u32 s39, s39, 5376
    buffer_load_dwordx4 v[112:115], v33, s[56:59], s39 offen
    s_add_u32 s39, s39, 5376
    buffer_load_dwordx4 v[116:119], v33, s[56:59], s39 offen
    s_add_u32 s39, s39, 5376
    buffer_load_dwordx4 v[120:123], v33, s[56:59], s39 offen
    s_add_u32 s39, s39, 5376
    buffer_load_dwordx4 v[124:127], v33, s[56:59], s39 offen
    s_add_u32 s39, s39, 5376
    buffer_load_dwordx4 v[128:131], v33, s[56:59], s39 offen
    s_add_u32 s39, s39, 5376
    buffer_load_dwordx4 v[132:135], v33, s[56:59], s39 offen
    s_add_u32 s39, s39, 5376
    buffer_load_dwordx4 v[136:139], v33, s[56:59], s39 offen
    s_add_u32 s39, s39, 5376
    buffer_load_dwordx4 v[140:143], v33, s[56:59], s39 offen
    s_add_u32 s39, s39, 5376
    buffer_load_dwordx4 v[144:147], v33, s[56:59], s39 offen
    s_add_u32 s39, s39, 5376
    buffer_load_dwordx4 v[148:151], v33, s[56:59], s39 offen
    s_add_u32 s39, s39, 5376
    buffer_load_dwordx4 v[152:155], v33, s[56:59], s39 offen
    s_add_u32 s39, s39, 5376
    buffer_load_dwordx4 v[156:159], v33, s[56:59], s39 offen
    s_add_u32 s39, s39, 5376
    buffer_load_dwordx4 v[160:163], v33, s[56:59], s39 offen
    s_add_u32 s39, s39, 5376
    buffer_load_dwordx4 v[164:167], v33, s[56:59], s39 offen
    s_add_u32 s39, s39, 5376
    buffer_load_dwordx4 v[168:171], v33, s[56:59], s39 offen
    s_add_u32 s39, s39, 5376
    buffer_load_dwordx4 v[172:175], v33, s[56:59], s39 offen
    s_add_u32 s39, s39, 5376
    s_waitcnt vmcnt(28)
    v_lshlrev_b32 v208, 16, v192
    v_mul_f32 v35, 0xbfb8aa3b, v208
    v_exp_f32 v35, v35
    s_nop 0
    v_add_f32 v35, 1.0, v35
    v_rcp_f32 v35, v35
    s_nop 0
    v_mul_f32 v208, v208, v35
    v_cvt_pk_bf16_f32 v208, v208, v208
    v_lshlrev_b32 v208, 16, v208
    v_and_b32 v209, 0xffff0000, v192
    v_mul_f32 v35, 0xbfb8aa3b, v209
    v_exp_f32 v35, v35
    s_nop 0
    v_add_f32 v35, 1.0, v35
    v_rcp_f32 v35, v35
    s_nop 0
    v_mul_f32 v209, v209, v35
    v_cvt_pk_bf16_f32 v209, v209, v209
    v_lshlrev_b32 v209, 16, v209
    v_lshlrev_b32 v210, 16, v193
    v_mul_f32 v35, 0xbfb8aa3b, v210
    v_exp_f32 v35, v35
    s_nop 0
    v_add_f32 v35, 1.0, v35
    v_rcp_f32 v35, v35
    s_nop 0
    v_mul_f32 v210, v210, v35
    v_cvt_pk_bf16_f32 v210, v210, v210
    v_lshlrev_b32 v210, 16, v210
    v_and_b32 v211, 0xffff0000, v193
    v_mul_f32 v35, 0xbfb8aa3b, v211
    v_exp_f32 v35, v35
    s_nop 0
    v_add_f32 v35, 1.0, v35
    v_rcp_f32 v35, v35
    s_nop 0
    v_mul_f32 v211, v211, v35
    v_cvt_pk_bf16_f32 v211, v211, v211
    v_lshlrev_b32 v211, 16, v211
    v_lshlrev_b32 v212, 16, v194
    v_mul_f32 v35, 0xbfb8aa3b, v212
    v_exp_f32 v35, v35
    s_nop 0
    v_add_f32 v35, 1.0, v35
    v_rcp_f32 v35, v35
    s_nop 0
    v_mul_f32 v212, v212, v35
    v_cvt_pk_bf16_f32 v212, v212, v212
    v_lshlrev_b32 v212, 16, v212
    v_and_b32 v213, 0xffff0000, v194
    v_mul_f32 v35, 0xbfb8aa3b, v213
    v_exp_f32 v35, v35
    s_nop 0
    v_add_f32 v35, 1.0, v35
    v_rcp_f32 v35, v35
    s_nop 0
    v_mul_f32 v213, v213, v35
    v_cvt_pk_bf16_f32 v213, v213, v213
    v_lshlrev_b32 v213, 16, v213
    v_lshlrev_b32 v214, 16, v195
    v_mul_f32 v35, 0xbfb8aa3b, v214
    v_exp_f32 v35, v35
    s_nop 0
    v_add_f32 v35, 1.0, v35
    v_rcp_f32 v35, v35
    s_nop 0
    v_mul_f32 v214, v214, v35
    v_cvt_pk_bf16_f32 v214, v214, v214
    v_lshlrev_b32 v214, 16, v214
    v_and_b32 v215, 0xffff0000, v195
    v_mul_f32 v35, 0xbfb8aa3b, v215
    v_exp_f32 v35, v35
    s_nop 0
    v_add_f32 v35, 1.0, v35
    v_rcp_f32 v35, v35
    s_nop 0
    v_mul_f32 v215, v215, v35
    v_cvt_pk_bf16_f32 v215, v215, v215
    v_lshlrev_b32 v215, 16, v215
    v_lshlrev_b32 v216, 16, v196
    v_mul_f32 v35, 0xbfb8aa3b, v216
    v_exp_f32 v35, v35
    s_nop 0
    v_add_f32 v35, 1.0, v35
    v_rcp_f32 v35, v35
    s_nop 0
    v_mul_f32 v216, v216, v35
    v_cvt_pk_bf16_f32 v216, v216, v216
    v_lshlrev_b32 v216, 16, v216
    v_and_b32 v217, 0xffff0000, v196
    v_mul_f32 v35, 0xbfb8aa3b, v217
    v_exp_f32 v35, v35
    s_nop 0
    v_add_f32 v35, 1.0, v35
    v_rcp_f32 v35, v35
    s_nop 0
    v_mul_f32 v217, v217, v35
    v_cvt_pk_bf16_f32 v217, v217, v217
    v_lshlrev_b32 v217, 16, v217
    v_lshlrev_b32 v218, 16, v197
    v_mul_f32 v35, 0xbfb8aa3b, v218
    v_exp_f32 v35, v35
    s_nop 0
    v_add_f32 v35, 1.0, v35
    v_rcp_f32 v35, v35
    s_nop 0
    v_mul_f32 v218, v218, v35
    v_cvt_pk_bf16_f32 v218, v218, v218
    v_lshlrev_b32 v218, 16, v218
    v_and_b32 v219, 0xffff0000, v197
    v_mul_f32 v35, 0xbfb8aa3b, v219
    v_exp_f32 v35, v35
    s_nop 0
    v_add_f32 v35, 1.0, v35
    v_rcp_f32 v35, v35
    s_nop 0
    v_mul_f32 v219, v219, v35
    v_cvt_pk_bf16_f32 v219, v219, v219
    v_lshlrev_b32 v219, 16, v219
    v_lshlrev_b32 v220, 16, v198
    v_mul_f32 v35, 0xbfb8aa3b, v220
    v_exp_f32 v35, v35
    s_nop 0
    v_add_f32 v35, 1.0, v35
    v_rcp_f32 v35, v35
    s_nop 0
    v_mul_f32 v220, v220, v35
    v_cvt_pk_bf16_f32 v220, v220, v220
    v_lshlrev_b32 v220, 16, v220
    v_and_b32 v221, 0xffff0000, v198
    v_mul_f32 v35, 0xbfb8aa3b, v221
    v_exp_f32 v35, v35
    s_nop 0
    v_add_f32 v35, 1.0, v35
    v_rcp_f32 v35, v35
    s_nop 0
    v_mul_f32 v221, v221, v35
    v_cvt_pk_bf16_f32 v221, v221, v221
    v_lshlrev_b32 v221, 16, v221
    v_lshlrev_b32 v222, 16, v199
    v_mul_f32 v35, 0xbfb8aa3b, v222
    v_exp_f32 v35, v35
    s_nop 0
    v_add_f32 v35, 1.0, v35
    v_rcp_f32 v35, v35
    s_nop 0
    v_mul_f32 v222, v222, v35
    v_cvt_pk_bf16_f32 v222, v222, v222
    v_lshlrev_b32 v222, 16, v222
    v_and_b32 v223, 0xffff0000, v199
    v_mul_f32 v35, 0xbfb8aa3b, v223
    v_exp_f32 v35, v35
    s_nop 0
    v_add_f32 v35, 1.0, v35
    v_rcp_f32 v35, v35
    s_nop 0
    v_mul_f32 v223, v223, v35
    v_cvt_pk_bf16_f32 v223, v223, v223
    v_lshlrev_b32 v223, 16, v223
    v_lshlrev_b32 v224, 16, v200
    v_mul_f32 v35, 0xbfb8aa3b, v224
    v_exp_f32 v35, v35
    s_nop 0
    v_add_f32 v35, 1.0, v35
    v_rcp_f32 v35, v35
    s_nop 0
    v_mul_f32 v224, v224, v35
    v_cvt_pk_bf16_f32 v224, v224, v224
    v_lshlrev_b32 v224, 16, v224
    v_and_b32 v225, 0xffff0000, v200
    v_mul_f32 v35, 0xbfb8aa3b, v225
    v_exp_f32 v35, v35
    s_nop 0
    v_add_f32 v35, 1.0, v35
    v_rcp_f32 v35, v35
    s_nop 0
    v_mul_f32 v225, v225, v35
    v_cvt_pk_bf16_f32 v225, v225, v225
    v_lshlrev_b32 v225, 16, v225
    v_lshlrev_b32 v226, 16, v201
    v_mul_f32 v35, 0xbfb8aa3b, v226
    v_exp_f32 v35, v35
    s_nop 0
    v_add_f32 v35, 1.0, v35
    v_rcp_f32 v35, v35
    s_nop 0
    v_mul_f32 v226, v226, v35
    v_cvt_pk_bf16_f32 v226, v226, v226
    v_lshlrev_b32 v226, 16, v226
    v_and_b32 v227, 0xffff0000, v201
    v_mul_f32 v35, 0xbfb8aa3b, v227
    v_exp_f32 v35, v35
    s_nop 0
    v_add_f32 v35, 1.0, v35
    v_rcp_f32 v35, v35
    s_nop 0
    v_mul_f32 v227, v227, v35
    v_cvt_pk_bf16_f32 v227, v227, v227
    v_lshlrev_b32 v227, 16, v227
    v_lshlrev_b32 v228, 16, v202
    v_mul_f32 v35, 0xbfb8aa3b, v228
    v_exp_f32 v35, v35
    s_nop 0
    v_add_f32 v35, 1.0, v35
    v_rcp_f32 v35, v35
    s_nop 0
    v_mul_f32 v228, v228, v35
    v_cvt_pk_bf16_f32 v228, v228, v228
    v_lshlrev_b32 v228, 16, v228
    v_and_b32 v229, 0xffff0000, v202
    v_mul_f32 v35, 0xbfb8aa3b, v229
    v_exp_f32 v35, v35
    s_nop 0
    v_add_f32 v35, 1.0, v35
    v_rcp_f32 v35, v35
    s_nop 0
    v_mul_f32 v229, v229, v35
    v_cvt_pk_bf16_f32 v229, v229, v229
    v_lshlrev_b32 v229, 16, v229
    v_lshlrev_b32 v230, 16, v203
    v_mul_f32 v35, 0xbfb8aa3b, v230
    v_exp_f32 v35, v35
    s_nop 0
    v_add_f32 v35, 1.0, v35
    v_rcp_f32 v35, v35
    s_nop 0
    v_mul_f32 v230, v230, v35
    v_cvt_pk_bf16_f32 v230, v230, v230
    v_lshlrev_b32 v230, 16, v230
    v_and_b32 v231, 0xffff0000, v203
    v_mul_f32 v35, 0xbfb8aa3b, v231
    v_exp_f32 v35, v35
    s_nop 0
    v_add_f32 v35, 1.0, v35
    v_rcp_f32 v35, v35
    s_nop 0
    v_mul_f32 v231, v231, v35
    v_cvt_pk_bf16_f32 v231, v231, v231
    v_lshlrev_b32 v231, 16, v231
    v_lshlrev_b32 v232, 16, v204
    v_mul_f32 v35, 0xbfb8aa3b, v232
    v_exp_f32 v35, v35
    s_nop 0
    v_add_f32 v35, 1.0, v35
    v_rcp_f32 v35, v35
    s_nop 0
    v_mul_f32 v232, v232, v35
    v_cvt_pk_bf16_f32 v232, v232, v232
    v_lshlrev_b32 v232, 16, v232
    v_and_b32 v233, 0xffff0000, v204
    v_mul_f32 v35, 0xbfb8aa3b, v233
    v_exp_f32 v35, v35
    s_nop 0
    v_add_f32 v35, 1.0, v35
    v_rcp_f32 v35, v35
    s_nop 0
    v_mul_f32 v233, v233, v35
    v_cvt_pk_bf16_f32 v233, v233, v233
    v_lshlrev_b32 v233, 16, v233
    v_lshlrev_b32 v234, 16, v205
    v_mul_f32 v35, 0xbfb8aa3b, v234
    v_exp_f32 v35, v35
    s_nop 0
    v_add_f32 v35, 1.0, v35
    v_rcp_f32 v35, v35
    s_nop 0
    v_mul_f32 v234, v234, v35
    v_cvt_pk_bf16_f32 v234, v234, v234
    v_lshlrev_b32 v234, 16, v234
    v_and_b32 v235, 0xffff0000, v205
    v_mul_f32 v35, 0xbfb8aa3b, v235
    v_exp_f32 v35, v35
    s_nop 0
    v_add_f32 v35, 1.0, v35
    v_rcp_f32 v35, v35
    s_nop 0
    v_mul_f32 v235, v235, v35
    v_cvt_pk_bf16_f32 v235, v235, v235
    v_lshlrev_b32 v235, 16, v235
    v_mov_b32 v40, 0
    v_mov_b32 v41, 0
    v_mov_b32 v42, 0
    v_mov_b32 v43, 0
    v_mov_b32 v44, 0
    v_mov_b32 v45, 0
    v_mov_b32 v46, 0
    v_mov_b32 v47, 0
    s_waitcnt vmcnt(27)
    v_lshlrev_b32 v36, 16, v64
    v_and_b32 v37, 0xffff0000, v64
    v_fmac_f32 v40, v36, v208
    v_fmac_f32 v41, v37, v208
    v_lshlrev_b32 v36, 16, v65
    v_and_b32 v37, 0xffff0000, v65
    v_fmac_f32 v42, v36, v208
    v_fmac_f32 v43, v37, v208
    v_lshlrev_b32 v36, 16, v66
    v_and_b32 v37, 0xffff0000, v66
    v_fmac_f32 v44, v36, v208
    v_fmac_f32 v45, v37, v208
    v_lshlrev_b32 v36, 16, v67
    v_and_b32 v37, 0xffff0000, v67
    v_fmac_f32 v46, v36, v208
    v_fmac_f32 v47, v37, v208
    s_waitcnt vmcnt(26)
    v_lshlrev_b32 v36, 16, v68
    v_and_b32 v37, 0xffff0000, v68
    v_fmac_f32 v40, v36, v209
    v_fmac_f32 v41, v37, v209
    v_lshlrev_b32 v36, 16, v69
    v_and_b32 v37, 0xffff0000, v69
    v_fmac_f32 v42, v36, v209
    v_fmac_f32 v43, v37, v209
    v_lshlrev_b32 v36, 16, v70
    v_and_b32 v37, 0xffff0000, v70
    v_fmac_f32 v44, v36, v209
    v_fmac_f32 v45, v37, v209
    v_lshlrev_b32 v36, 16, v71
    v_and_b32 v37, 0xffff0000, v71
    v_fmac_f32 v46, v36, v209
    v_fmac_f32 v47, v37, v209
    s_waitcnt vmcnt(25)
    v_lshlrev_b32 v36, 16, v72
    v_and_b32 v37, 0xffff0000, v72
    v_fmac_f32 v40, v36, v210
    v_fmac_f32 v41, v37, v210
    v_lshlrev_b32 v36, 16, v73
    v_and_b32 v37, 0xffff0000, v73
    v_fmac_f32 v42, v36, v210
    v_fmac_f32 v43, v37, v210
    v_lshlrev_b32 v36, 16, v74
    v_and_b32 v37, 0xffff0000, v74
    v_fmac_f32 v44, v36, v210
    v_fmac_f32 v45, v37, v210
    v_lshlrev_b32 v36, 16, v75
    v_and_b32 v37, 0xffff0000, v75
    v_fmac_f32 v46, v36, v210
    v_fmac_f32 v47, v37, v210
    s_waitcnt vmcnt(24)
    v_lshlrev_b32 v36, 16, v76
    v_and_b32 v37, 0xffff0000, v76
    v_fmac_f32 v40, v36, v211
    v_fmac_f32 v41, v37, v211
    v_lshlrev_b32 v36, 16, v77
    v_and_b32 v37, 0xffff0000, v77
    v_fmac_f32 v42, v36, v211
    v_fmac_f32 v43, v37, v211
    v_lshlrev_b32 v36, 16, v78
    v_and_b32 v37, 0xffff0000, v78
    v_fmac_f32 v44, v36, v211
    v_fmac_f32 v45, v37, v211
    v_lshlrev_b32 v36, 16, v79
    v_and_b32 v37, 0xffff0000, v79
    v_fmac_f32 v46, v36, v211
    v_fmac_f32 v47, v37, v211
    s_waitcnt vmcnt(23)
    v_lshlrev_b32 v36, 16, v80
    v_and_b32 v37, 0xffff0000, v80
    v_fmac_f32 v40, v36, v212
    v_fmac_f32 v41, v37, v212
    v_lshlrev_b32 v36, 16, v81
    v_and_b32 v37, 0xffff0000, v81
    v_fmac_f32 v42, v36, v212
    v_fmac_f32 v43, v37, v212
    v_lshlrev_b32 v36, 16, v82
    v_and_b32 v37, 0xffff0000, v82
    v_fmac_f32 v44, v36, v212
    v_fmac_f32 v45, v37, v212
    v_lshlrev_b32 v36, 16, v83
    v_and_b32 v37, 0xffff0000, v83
    v_fmac_f32 v46, v36, v212
    v_fmac_f32 v47, v37, v212
    s_waitcnt vmcnt(22)
    v_lshlrev_b32 v36, 16, v84
    v_and_b32 v37, 0xffff0000, v84
    v_fmac_f32 v40, v36, v213
    v_fmac_f32 v41, v37, v213
    v_lshlrev_b32 v36, 16, v85
    v_and_b32 v37, 0xffff0000, v85
    v_fmac_f32 v42, v36, v213
    v_fmac_f32 v43, v37, v213
    v_lshlrev_b32 v36, 16, v86
    v_and_b32 v37, 0xffff0000, v86
    v_fmac_f32 v44, v36, v213
    v_fmac_f32 v45, v37, v213
    v_lshlrev_b32 v36, 16, v87
    v_and_b32 v37, 0xffff0000, v87
    v_fmac_f32 v46, v36, v213
    v_fmac_f32 v47, v37, v213
    s_waitcnt vmcnt(21)
    v_lshlrev_b32 v36, 16, v88
    v_and_b32 v37, 0xffff0000, v88
    v_fmac_f32 v40, v36, v214
    v_fmac_f32 v41, v37, v214
    v_lshlrev_b32 v36, 16, v89
    v_and_b32 v37, 0xffff0000, v89
    v_fmac_f32 v42, v36, v214
    v_fmac_f32 v43, v37, v214
    v_lshlrev_b32 v36, 16, v90
    v_and_b32 v37, 0xffff0000, v90
    v_fmac_f32 v44, v36, v214
    v_fmac_f32 v45, v37, v214
    v_lshlrev_b32 v36, 16, v91
    v_and_b32 v37, 0xffff0000, v91
    v_fmac_f32 v46, v36, v214
    v_fmac_f32 v47, v37, v214
    s_waitcnt vmcnt(20)
    v_lshlrev_b32 v36, 16, v92
    v_and_b32 v37, 0xffff0000, v92
    v_fmac_f32 v40, v36, v215
    v_fmac_f32 v41, v37, v215
    v_lshlrev_b32 v36, 16, v93
    v_and_b32 v37, 0xffff0000, v93
    v_fmac_f32 v42, v36, v215
    v_fmac_f32 v43, v37, v215
    v_lshlrev_b32 v36, 16, v94
    v_and_b32 v37, 0xffff0000, v94
    v_fmac_f32 v44, v36, v215
    v_fmac_f32 v45, v37, v215
    v_lshlrev_b32 v36, 16, v95
    v_and_b32 v37, 0xffff0000, v95
    v_fmac_f32 v46, v36, v215
    v_fmac_f32 v47, v37, v215
    s_waitcnt vmcnt(19)
    v_lshlrev_b32 v36, 16, v96
    v_and_b32 v37, 0xffff0000, v96
    v_fmac_f32 v40, v36, v216
    v_fmac_f32 v41, v37, v216
    v_lshlrev_b32 v36, 16, v97
    v_and_b32 v37, 0xffff0000, v97
    v_fmac_f32 v42, v36, v216
    v_fmac_f32 v43, v37, v216
    v_lshlrev_b32 v36, 16, v98
    v_and_b32 v37, 0xffff0000, v98
    v_fmac_f32 v44, v36, v216
    v_fmac_f32 v45, v37, v216
    v_lshlrev_b32 v36, 16, v99
    v_and_b32 v37, 0xffff0000, v99
    v_fmac_f32 v46, v36, v216
    v_fmac_f32 v47, v37, v216
    s_waitcnt vmcnt(18)
    v_lshlrev_b32 v36, 16, v100
    v_and_b32 v37, 0xffff0000, v100
    v_fmac_f32 v40, v36, v217
    v_fmac_f32 v41, v37, v217
    v_lshlrev_b32 v36, 16, v101
    v_and_b32 v37, 0xffff0000, v101
    v_fmac_f32 v42, v36, v217
    v_fmac_f32 v43, v37, v217
    v_lshlrev_b32 v36, 16, v102
    v_and_b32 v37, 0xffff0000, v102
    v_fmac_f32 v44, v36, v217
    v_fmac_f32 v45, v37, v217
    v_lshlrev_b32 v36, 16, v103
    v_and_b32 v37, 0xffff0000, v103
    v_fmac_f32 v46, v36, v217
    v_fmac_f32 v47, v37, v217
    s_waitcnt vmcnt(17)
    v_lshlrev_b32 v36, 16, v104
    v_and_b32 v37, 0xffff0000, v104
    v_fmac_f32 v40, v36, v218
    v_fmac_f32 v41, v37, v218
    v_lshlrev_b32 v36, 16, v105
    v_and_b32 v37, 0xffff0000, v105
    v_fmac_f32 v42, v36, v218
    v_fmac_f32 v43, v37, v218
    v_lshlrev_b32 v36, 16, v106
    v_and_b32 v37, 0xffff0000, v106
    v_fmac_f32 v44, v36, v218
    v_fmac_f32 v45, v37, v218
    v_lshlrev_b32 v36, 16, v107
    v_and_b32 v37, 0xffff0000, v107
    v_fmac_f32 v46, v36, v218
    v_fmac_f32 v47, v37, v218
    s_waitcnt vmcnt(16)
    v_lshlrev_b32 v36, 16, v108
    v_and_b32 v37, 0xffff0000, v108
    v_fmac_f32 v40, v36, v219
    v_fmac_f32 v41, v37, v219
    v_lshlrev_b32 v36, 16, v109
    v_and_b32 v37, 0xffff0000, v109
    v_fmac_f32 v42, v36, v219
    v_fmac_f32 v43, v37, v219
    v_lshlrev_b32 v36, 16, v110
    v_and_b32 v37, 0xffff0000, v110
    v_fmac_f32 v44, v36, v219
    v_fmac_f32 v45, v37, v219
    v_lshlrev_b32 v36, 16, v111
    v_and_b32 v37, 0xffff0000, v111
    v_fmac_f32 v46, v36, v219
    v_fmac_f32 v47, v37, v219
    s_waitcnt vmcnt(15)
    v_lshlrev_b32 v36, 16, v112
    v_and_b32 v37, 0xffff0000, v112
    v_fmac_f32 v40, v36, v220
    v_fmac_f32 v41, v37, v220
    v_lshlrev_b32 v36, 16, v113
    v_and_b32 v37, 0xffff0000, v113
    v_fmac_f32 v42, v36, v220
    v_fmac_f32 v43, v37, v220
    v_lshlrev_b32 v36, 16, v114
    v_and_b32 v37, 0xffff0000, v114
    v_fmac_f32 v44, v36, v220
    v_fmac_f32 v45, v37, v220
    v_lshlrev_b32 v36, 16, v115
    v_and_b32 v37, 0xffff0000, v115
    v_fmac_f32 v46, v36, v220
    v_fmac_f32 v47, v37, v220
    s_waitcnt vmcnt(14)
    v_lshlrev_b32 v36, 16, v116
    v_and_b32 v37, 0xffff0000, v116
    v_fmac_f32 v40, v36, v221
    v_fmac_f32 v41, v37, v221
    v_lshlrev_b32 v36, 16, v117
    v_and_b32 v37, 0xffff0000, v117
    v_fmac_f32 v42, v36, v221
    v_fmac_f32 v43, v37, v221
    v_lshlrev_b32 v36, 16, v118
    v_and_b32 v37, 0xffff0000, v118
    v_fmac_f32 v44, v36, v221
    v_fmac_f32 v45, v37, v221
    v_lshlrev_b32 v36, 16, v119
    v_and_b32 v37, 0xffff0000, v119
    v_fmac_f32 v46, v36, v221
    v_fmac_f32 v47, v37, v221
    s_waitcnt vmcnt(13)
    v_lshlrev_b32 v36, 16, v120
    v_and_b32 v37, 0xffff0000, v120
    v_fmac_f32 v40, v36, v222
    v_fmac_f32 v41, v37, v222
    v_lshlrev_b32 v36, 16, v121
    v_and_b32 v37, 0xffff0000, v121
    v_fmac_f32 v42, v36, v222
    v_fmac_f32 v43, v37, v222
    v_lshlrev_b32 v36, 16, v122
    v_and_b32 v37, 0xffff0000, v122
    v_fmac_f32 v44, v36, v222
    v_fmac_f32 v45, v37, v222
    v_lshlrev_b32 v36, 16, v123
    v_and_b32 v37, 0xffff0000, v123
    v_fmac_f32 v46, v36, v222
    v_fmac_f32 v47, v37, v222
    s_waitcnt vmcnt(12)
    v_lshlrev_b32 v36, 16, v124
    v_and_b32 v37, 0xffff0000, v124
    v_fmac_f32 v40, v36, v223
    v_fmac_f32 v41, v37, v223
    v_lshlrev_b32 v36, 16, v125
    v_and_b32 v37, 0xffff0000, v125
    v_fmac_f32 v42, v36, v223
    v_fmac_f32 v43, v37, v223
    v_lshlrev_b32 v36, 16, v126
    v_and_b32 v37, 0xffff0000, v126
    v_fmac_f32 v44, v36, v223
    v_fmac_f32 v45, v37, v223
    v_lshlrev_b32 v36, 16, v127
    v_and_b32 v37, 0xffff0000, v127
    v_fmac_f32 v46, v36, v223
    v_fmac_f32 v47, v37, v223
    s_waitcnt vmcnt(11)
    v_lshlrev_b32 v36, 16, v128
    v_and_b32 v37, 0xffff0000, v128
    v_fmac_f32 v40, v36, v224
    v_fmac_f32 v41, v37, v224
    v_lshlrev_b32 v36, 16, v129
    v_and_b32 v37, 0xffff0000, v129
    v_fmac_f32 v42, v36, v224
    v_fmac_f32 v43, v37, v224
    v_lshlrev_b32 v36, 16, v130
    v_and_b32 v37, 0xffff0000, v130
    v_fmac_f32 v44, v36, v224
    v_fmac_f32 v45, v37, v224
    v_lshlrev_b32 v36, 16, v131
    v_and_b32 v37, 0xffff0000, v131
    v_fmac_f32 v46, v36, v224
    v_fmac_f32 v47, v37, v224
    s_waitcnt vmcnt(10)
    v_lshlrev_b32 v36, 16, v132
    v_and_b32 v37, 0xffff0000, v132
    v_fmac_f32 v40, v36, v225
    v_fmac_f32 v41, v37, v225
    v_lshlrev_b32 v36, 16, v133
    v_and_b32 v37, 0xffff0000, v133
    v_fmac_f32 v42, v36, v225
    v_fmac_f32 v43, v37, v225
    v_lshlrev_b32 v36, 16, v134
    v_and_b32 v37, 0xffff0000, v134
    v_fmac_f32 v44, v36, v225
    v_fmac_f32 v45, v37, v225
    v_lshlrev_b32 v36, 16, v135
    v_and_b32 v37, 0xffff0000, v135
    v_fmac_f32 v46, v36, v225
    v_fmac_f32 v47, v37, v225
    s_waitcnt vmcnt(9)
    v_lshlrev_b32 v36, 16, v136
    v_and_b32 v37, 0xffff0000, v136
    v_fmac_f32 v40, v36, v226
    v_fmac_f32 v41, v37, v226
    v_lshlrev_b32 v36, 16, v137
    v_and_b32 v37, 0xffff0000, v137
    v_fmac_f32 v42, v36, v226
    v_fmac_f32 v43, v37, v226
    v_lshlrev_b32 v36, 16, v138
    v_and_b32 v37, 0xffff0000, v138
    v_fmac_f32 v44, v36, v226
    v_fmac_f32 v45, v37, v226
    v_lshlrev_b32 v36, 16, v139
    v_and_b32 v37, 0xffff0000, v139
    v_fmac_f32 v46, v36, v226
    v_fmac_f32 v47, v37, v226
    s_waitcnt vmcnt(8)
    v_lshlrev_b32 v36, 16, v140
    v_and_b32 v37, 0xffff0000, v140
    v_fmac_f32 v40, v36, v227
    v_fmac_f32 v41, v37, v227
    v_lshlrev_b32 v36, 16, v141
    v_and_b32 v37, 0xffff0000, v141
    v_fmac_f32 v42, v36, v227
    v_fmac_f32 v43, v37, v227
    v_lshlrev_b32 v36, 16, v142
    v_and_b32 v37, 0xffff0000, v142
    v_fmac_f32 v44, v36, v227
    v_fmac_f32 v45, v37, v227
    v_lshlrev_b32 v36, 16, v143
    v_and_b32 v37, 0xffff0000, v143
    v_fmac_f32 v46, v36, v227
    v_fmac_f32 v47, v37, v227
    s_waitcnt vmcnt(7)
    v_lshlrev_b32 v36, 16, v144
    v_and_b32 v37, 0xffff0000, v144
    v_fmac_f32 v40, v36, v228
    v_fmac_f32 v41, v37, v228
    v_lshlrev_b32 v36, 16, v145
    v_and_b32 v37, 0xffff0000, v145
    v_fmac_f32 v42, v36, v228
    v_fmac_f32 v43, v37, v228
    v_lshlrev_b32 v36, 16, v146
    v_and_b32 v37, 0xffff0000, v146
    v_fmac_f32 v44, v36, v228
    v_fmac_f32 v45, v37, v228
    v_lshlrev_b32 v36, 16, v147
    v_and_b32 v37, 0xffff0000, v147
    v_fmac_f32 v46, v36, v228
    v_fmac_f32 v47, v37, v228
    s_waitcnt vmcnt(6)
    v_lshlrev_b32 v36, 16, v148
    v_and_b32 v37, 0xffff0000, v148
    v_fmac_f32 v40, v36, v229
    v_fmac_f32 v41, v37, v229
    v_lshlrev_b32 v36, 16, v149
    v_and_b32 v37, 0xffff0000, v149
    v_fmac_f32 v42, v36, v229
    v_fmac_f32 v43, v37, v229
    v_lshlrev_b32 v36, 16, v150
    v_and_b32 v37, 0xffff0000, v150
    v_fmac_f32 v44, v36, v229
    v_fmac_f32 v45, v37, v229
    v_lshlrev_b32 v36, 16, v151
    v_and_b32 v37, 0xffff0000, v151
    v_fmac_f32 v46, v36, v229
    v_fmac_f32 v47, v37, v229
    s_waitcnt vmcnt(5)
    v_lshlrev_b32 v36, 16, v152
    v_and_b32 v37, 0xffff0000, v152
    v_fmac_f32 v40, v36, v230
    v_fmac_f32 v41, v37, v230
    v_lshlrev_b32 v36, 16, v153
    v_and_b32 v37, 0xffff0000, v153
    v_fmac_f32 v42, v36, v230
    v_fmac_f32 v43, v37, v230
    v_lshlrev_b32 v36, 16, v154
    v_and_b32 v37, 0xffff0000, v154
    v_fmac_f32 v44, v36, v230
    v_fmac_f32 v45, v37, v230
    v_lshlrev_b32 v36, 16, v155
    v_and_b32 v37, 0xffff0000, v155
    v_fmac_f32 v46, v36, v230
    v_fmac_f32 v47, v37, v230
    s_waitcnt vmcnt(4)
    v_lshlrev_b32 v36, 16, v156
    v_and_b32 v37, 0xffff0000, v156
    v_fmac_f32 v40, v36, v231
    v_fmac_f32 v41, v37, v231
    v_lshlrev_b32 v36, 16, v157
    v_and_b32 v37, 0xffff0000, v157
    v_fmac_f32 v42, v36, v231
    v_fmac_f32 v43, v37, v231
    v_lshlrev_b32 v36, 16, v158
    v_and_b32 v37, 0xffff0000, v158
    v_fmac_f32 v44, v36, v231
    v_fmac_f32 v45, v37, v231
    v_lshlrev_b32 v36, 16, v159
    v_and_b32 v37, 0xffff0000, v159
    v_fmac_f32 v46, v36, v231
    v_fmac_f32 v47, v37, v231
    s_waitcnt vmcnt(3)
    v_lshlrev_b32 v36, 16, v160
    v_and_b32 v37, 0xffff0000, v160
    v_fmac_f32 v40, v36, v232
    v_fmac_f32 v41, v37, v232
    v_lshlrev_b32 v36, 16, v161
    v_and_b32 v37, 0xffff0000, v161
    v_fmac_f32 v42, v36, v232
    v_fmac_f32 v43, v37, v232
    v_lshlrev_b32 v36, 16, v162
    v_and_b32 v37, 0xffff0000, v162
    v_fmac_f32 v44, v36, v232
    v_fmac_f32 v45, v37, v232
    v_lshlrev_b32 v36, 16, v163
    v_and_b32 v37, 0xffff0000, v163
    v_fmac_f32 v46, v36, v232
    v_fmac_f32 v47, v37, v232
    s_waitcnt vmcnt(2)
    v_lshlrev_b32 v36, 16, v164
    v_and_b32 v37, 0xffff0000, v164
    v_fmac_f32 v40, v36, v233
    v_fmac_f32 v41, v37, v233
    v_lshlrev_b32 v36, 16, v165
    v_and_b32 v37, 0xffff0000, v165
    v_fmac_f32 v42, v36, v233
    v_fmac_f32 v43, v37, v233
    v_lshlrev_b32 v36, 16, v166
    v_and_b32 v37, 0xffff0000, v166
    v_fmac_f32 v44, v36, v233
    v_fmac_f32 v45, v37, v233
    v_lshlrev_b32 v36, 16, v167
    v_and_b32 v37, 0xffff0000, v167
    v_fmac_f32 v46, v36, v233
    v_fmac_f32 v47, v37, v233
    s_waitcnt vmcnt(1)
    v_lshlrev_b32 v36, 16, v168
    v_and_b32 v37, 0xffff0000, v168
    v_fmac_f32 v40, v36, v234
    v_fmac_f32 v41, v37, v234
    v_lshlrev_b32 v36, 16, v169
    v_and_b32 v37, 0xffff0000, v169
    v_fmac_f32 v42, v36, v234
    v_fmac_f32 v43, v37, v234
    v_lshlrev_b32 v36, 16, v170
    v_and_b32 v37, 0xffff0000, v170
    v_fmac_f32 v44, v36, v234
    v_fmac_f32 v45, v37, v234
    v_lshlrev_b32 v36, 16, v171
    v_and_b32 v37, 0xffff0000, v171
    v_fmac_f32 v46, v36, v234
    v_fmac_f32 v47, v37, v234
    s_waitcnt vmcnt(0)
    v_lshlrev_b32 v36, 16, v172
    v_and_b32 v37, 0xffff0000, v172
    v_fmac_f32 v40, v36, v235
    v_fmac_f32 v41, v37, v235
    v_lshlrev_b32 v36, 16, v173
    v_and_b32 v37, 0xffff0000, v173
    v_fmac_f32 v42, v36, v235
    v_fmac_f32 v43, v37, v235
    v_lshlrev_b32 v36, 16, v174
    v_and_b32 v37, 0xffff0000, v174
    v_fmac_f32 v44, v36, v235
    v_fmac_f32 v45, v37, v235
    v_lshlrev_b32 v36, 16, v175
    v_and_b32 v37, 0xffff0000, v175
    v_fmac_f32 v46, v36, v235
    v_fmac_f32 v47, v37, v235
    s_nop 1
    v_add_f32_dpp v40, v40, v40 row_ror:4 row_mask:0xf bank_mask:0xf
    s_nop 1
    v_add_f32_dpp v40, v40, v40 row_ror:8 row_mask:0xf bank_mask:0xf
    v_mov_b32 v48, v40
    s_nop 1
    v_permlane16_swap_b32 v40, v48
    v_add_f32 v40, v40, v48
    v_mov_b32 v48, v40
    s_nop 1
    v_permlane32_swap_b32 v40, v48
    v_add_f32 v40, v40, v48
    s_nop 1
    v_add_f32_dpp v41, v41, v41 row_ror:4 row_mask:0xf bank_mask:0xf
    s_nop 1
    v_add_f32_dpp v41, v41, v41 row_ror:8 row_mask:0xf bank_mask:0xf
    v_mov_b32 v48, v41
    s_nop 1
    v_permlane16_swap_b32 v41, v48
    v_add_f32 v41, v41, v48
    v_mov_b32 v48, v41
    s_nop 1
    v_permlane32_swap_b32 v41, v48
    v_add_f32 v41, v41, v48
    s_nop 1
    v_add_f32_dpp v42, v42, v42 row_ror:4 row_mask:0xf bank_mask:0xf
    s_nop 1
    v_add_f32_dpp v42, v42, v42 row_ror:8 row_mask:0xf bank_mask:0xf
    v_mov_b32 v48, v42
    s_nop 1
    v_permlane16_swap_b32 v42, v48
    v_add_f32 v42, v42, v48
    v_mov_b32 v48, v42
    s_nop 1
    v_permlane32_swap_b32 v42, v48
    v_add_f32 v42, v42, v48
    s_nop 1
    v_add_f32_dpp v43, v43, v43 row_ror:4 row_mask:0xf bank_mask:0xf
    s_nop 1
    v_add_f32_dpp v43, v43, v43 row_ror:8 row_mask:0xf bank_mask:0xf
    v_mov_b32 v48, v43
    s_nop 1
    v_permlane16_swap_b32 v43, v48
    v_add_f32 v43, v43, v48
    v_mov_b32 v48, v43
    s_nop 1
    v_permlane32_swap_b32 v43, v48
    v_add_f32 v43, v43, v48
    s_nop 1
    v_add_f32_dpp v44, v44, v44 row_ror:4 row_mask:0xf bank_mask:0xf
    s_nop 1
    v_add_f32_dpp v44, v44, v44 row_ror:8 row_mask:0xf bank_mask:0xf
    v_mov_b32 v48, v44
    s_nop 1
    v_permlane16_swap_b32 v44, v48
    v_add_f32 v44, v44, v48
    v_mov_b32 v48, v44
    s_nop 1
    v_permlane32_swap_b32 v44, v48
    v_add_f32 v44, v44, v48
    s_nop 1
    v_add_f32_dpp v45, v45, v45 row_ror:4 row_mask:0xf bank_mask:0xf
    s_nop 1
    v_add_f32_dpp v45, v45, v45 row_ror:8 row_mask:0xf bank_mask:0xf
    v_mov_b32 v48, v45
    s_nop 1
    v_permlane16_swap_b32 v45, v48
    v_add_f32 v45, v45, v48
    v_mov_b32 v48, v45
    s_nop 1
    v_permlane32_swap_b32 v45, v48
    v_add_f32 v45, v45, v48
    s_nop 1
    v_add_f32_dpp v46, v46, v46 row_ror:4 row_mask:0xf bank_mask:0xf
    s_nop 1
    v_add_f32_dpp v46, v46, v46 row_ror:8 row_mask:0xf bank_mask:0xf
    v_mov_b32 v48, v46
    s_nop 1
    v_permlane16_swap_b32 v46, v48
    v_add_f32 v46, v46, v48
    v_mov_b32 v48, v46
    s_nop 1
    v_permlane32_swap_b32 v46, v48
    v_add_f32 v46, v46, v48
    s_nop 1
    v_add_f32_dpp v47, v47, v47 row_ror:4 row_mask:0xf bank_mask:0xf
    s_nop 1
    v_add_f32_dpp v47, v47, v47 row_ror:8 row_mask:0xf bank_mask:0xf
    v_mov_b32 v48, v47
    s_nop 1
    v_permlane16_swap_b32 v47, v48
    v_add_f32 v47, v47, v48
    v_mov_b32 v48, v47
    s_nop 1
    v_permlane32_swap_b32 v47, v48
    v_add_f32 v47, v47, v48
    v_cvt_pk_bf16_f32 v40, v40, v40
    v_lshlrev_b32 v40, 16, v40
    v_cvt_pk_bf16_f32 v41, v41, v41
    v_lshlrev_b32 v41, 16, v41
    v_cvt_pk_bf16_f32 v42, v42, v42
    v_lshlrev_b32 v42, 16, v42
    v_cvt_pk_bf16_f32 v43, v43, v43
    v_lshlrev_b32 v43, 16, v43
    v_cvt_pk_bf16_f32 v44, v44, v44
    v_lshlrev_b32 v44, 16, v44
    v_cvt_pk_bf16_f32 v45, v45, v45
    v_lshlrev_b32 v45, 16, v45
    v_cvt_pk_bf16_f32 v46, v46, v46
    v_lshlrev_b32 v46, 16, v46
    v_cvt_pk_bf16_f32 v47, v47, v47
    v_lshlrev_b32 v47, 16, v47
    v_lshlrev_b32 v50, 5, v30
    s_lshl_b32 s38, s37, 7
    s_add_u32 s38, s38, 16515072
    s_mov_b64 exec, 0xf
    buffer_store_dwordx4 v[40:43], v50, s[16:19], s38 offen sc1
    buffer_store_dwordx4 v[44:47], v50, s[16:19], s38 offen offset:16 sc1
    s_mov_b64 exec, -1
    s_waitcnt vmcnt(0)
    v_mov_b32 v58, 0
    s_mov_b32 s38, 0
Lm_gn_7:
    buffer_load_dwordx2 v[56:57], v58, s[48:51], 0 offen sc1
    s_waitcnt vmcnt(0)
    v_readfirstlane_b32 s40, v56
    v_readfirstlane_b32 s97, v57
    s_nop 3
    s_and_b32 s41, s40, s97
    s_and_b32 s41, s41, 0x80808080
    s_cmp_eq_u32 s41, 0x80808080
    s_cbranch_scc1 Lm_gn_7_ok
    s_sleep 1
    s_add_u32 s38, s38, 1
    s_cmp_lt_u32 s38, 400000
    s_cbranch_scc1 Lm_gn_7
Lm_gn_7_ok:
    s_lshr_b32 s40, s40, 3
    s_and_b32 s40, s40, 0x0f0f0f0f
    s_lshl_b32 s97, s97, 1
    s_and_b32 s97, s97, 0xf0f0f0f0
    s_or_b32 s97, s97, s40
    s_or_b32 s97, s97, 0x100
    s_and_b32 s97, s97, 0xfffffdff
    s_lshl_b32 s38, s37, 2
    s_add_u32 s38, s38, 100192256
    v_mov_b32 v53, s97
    v_mov_b32 v54, 0
    s_mov_b64 exec, 1
    buffer_store_dword v53, v54, s[16:19], s38 offen sc1
    s_mov_b64 exec, -1
Lm_nomod:
    s_cmp_eq_u32 s25, 0
    s_cbranch_scc1 Lm_noB0
    s_cmp_lt_u32 s20, 16
    s_cbranch_scc0 Lm_BU0
    v_lshlrev_b32 v22, 13, v20
    v_lshlrev_b32 v23, 4, v21
    v_add_u32 v22, v22, v23
    s_lshl_b32 s35, s24, 18
    s_lshl_b32 s33, s23, 9
    s_add_u32 s35, s35, s33
    buffer_load_dwordx4 v[64:67], v22, s[12:15], s35 offen offset:0
    buffer_load_dwordx4 v[68:71], v22, s[12:15], s35 offen offset:32
    buffer_load_dwordx4 v[72:75], v22, s[12:15], s35 offen offset:64
    buffer_load_dwordx4 v[76:79], v22, s[12:15], s35 offen offset:96
    buffer_load_dwordx4 v[80:83], v22, s[12:15], s35 offen offset:128
    buffer_load_dwordx4 v[84:87], v22, s[12:15], s35 offen offset:160
    buffer_load_dwordx4 v[88:91], v22, s[12:15], s35 offen offset:192
    buffer_load_dwordx4 v[92:95], v22, s[12:15], s35 offen offset:224
    buffer_load_dwordx4 v[96:99], v22, s[12:15], s35 offen offset:256
    buffer_load_dwordx4 v[100:103], v22, s[12:15], s35 offen offset:288
    buffer_load_dwordx4 v[104:107], v22, s[12:15], s35 offen offset:320
    buffer_load_dwordx4 v[108:111], v22, s[12:15], s35 offen offset:352
    buffer_load_dwordx4 v[112:115], v22, s[12:15], s35 offen offset:384
    buffer_load_dwordx4 v[116:119], v22, s[12:15], s35 offen offset:416
    buffer_load_dwordx4 v[120:123], v22, s[12:15], s35 offen offset:448
    buffer_load_dwordx4 v[124:127], v22, s[12:15], s35 offen offset:480
    s_branch Lm_noB0
Lm_BU0:
    v_lshrrev_b32 v24, 2, v1
    v_and_b32 v25, 3, v1
    v_mul_u32_u24 v26, 896, v24
    v_lshlrev_b32 v27, 4, v25
    v_add_u32 v26, v26, v27
    v_mul_u32_u24 v28, 64, v24
    v_add_u32 v28, v28, v27
    s_mul_i32 s36, s22, 8192
    s_add_u32 s36, s36, 114688
    v_add_u32 v28, s36, v28
    s_mul_i32 s35, s23, 229376
    s_lshl_b32 s33, s24, 6
    s_add_u32 s35, s35, s33
    buffer_load_dwordx4 v[128:131], v26, s[12:15], s35 offen
    s_add_u32 s35, s35, 14336
    buffer_load_dwordx4 v[132:135], v26, s[12:15], s35 offen
    s_add_u32 s35, s35, 14336
    buffer_load_dwordx4 v[136:139], v26, s[12:15], s35 offen
    s_add_u32 s35, s35, 14336
    buffer_load_dwordx4 v[140:143], v26, s[12:15], s35 offen
    s_add_u32 s35, s35, 14336
    buffer_load_dwordx4 v[144:147], v26, s[12:15], s35 offen
    s_add_u32 s35, s35, 14336
    buffer_load_dwordx4 v[148:151], v26, s[12:15], s35 offen
    s_add_u32 s35, s35, 14336
    buffer_load_dwordx4 v[152:155], v26, s[12:15], s35 offen
    s_add_u32 s35, s35, 14336
    buffer_load_dwordx4 v[156:159], v26, s[12:15], s35 offen
    s_add_u32 s35, s35, 14336
    buffer_load_dwordx4 v[160:163], v26, s[12:15], s35 offen
    s_add_u32 s35, s35, 14336
    buffer_load_dwordx4 v[164:167], v26, s[12:15], s35 offen
    s_add_u32 s35, s35, 14336
    buffer_load_dwordx4 v[168:171], v26, s[12:15], s35 offen
    s_add_u32 s35, s35, 14336
    buffer_load_dwordx4 v[172:175], v26, s[12:15], s35 offen
    s_add_u32 s35, s35, 14336
    buffer_load_dwordx4 v[176:179], v26, s[12:15], s35 offen
    s_add_u32 s35, s35, 14336
    buffer_load_dwordx4 v[180:183], v26, s[12:15], s35 offen
    s_add_u32 s35, s35, 14336
    buffer_load_dwordx4 v[184:187], v26, s[12:15], s35 offen
    s_add_u32 s35, s35, 14336
    buffer_load_dwordx4 v[188:191], v26, s[12:15], s35 offen
    s_add_u32 s35, s35, 14336
Lm_noB0:
    s_lshr_b32 s28, s22, 1
    s_lshl_b32 s28, s28, 5
    s_and_b32 s29, s22, 1
    s_lshl_b32 s30, s29, 1
    s_add_u32 s28, s28, s30
    s_lshl_b32 s29, s29, 3
    v_add_u32 v24, 0, v21
    v_add_u32 v24, s28, v24
    v_lshlrev_b32 v24, 13, v24
    v_add_u32 v25, 0, v21
    v_add_u32 v25, s29, v25
    v_xor_b32 v25, v25, v20
    v_lshlrev_b32 v25, 4, v25
    v_add_u32 v8, v24, v25
    v_add_u32 v24, 8, v21
    v_add_u32 v24, s28, v24
    v_lshlrev_b32 v24, 13, v24
    v_add_u32 v25, 2, v21
    v_add_u32 v25, s29, v25
    v_xor_b32 v25, v25, v20
    v_lshlrev_b32 v25, 4, v25
    v_add_u32 v9, v24, v25
    v_add_u32 v24, 4, v21
    v_add_u32 v24, s28, v24
    v_lshlrev_b32 v24, 13, v24
    v_add_u32 v25, 4, v21
    v_add_u32 v25, s29, v25
    v_xor_b32 v25, v25, v20
    v_lshlrev_b32 v25, 4, v25
    v_add_u32 v10, v24, v25
    v_add_u32 v24, 12, v21
    v_add_u32 v24, s28, v24
    v_lshlrev_b32 v24, 13, v24
    v_add_u32 v25, 6, v21
    v_add_u32 v25, s29, v25
    v_xor_b32 v25, v25, v20
    v_lshlrev_b32 v25, 4, v25
    v_add_u32 v11, v24, v25
    s_lshl_b32 s28, s27, 1
    s_add_u32 s28, s28, 0
    s_cmp_ge_u32 s28, 7
    s_cselect_b32 s29, 7, 0
    s_sub_u32 s28, s28, s29
    s_lshl_b32 s52, s28, 6
    s_mul_i32 s29, s26, 7
    s_add_u32 s28, s28, s29
    s_lshr_b32 s29, s28, 1
    s_lshl_b32 s29, s29, 6
    s_and_b32 s30, s28, 1
    s_lshl_b32 s30, s30, 4
    s_add_u32 s29, s29, s30
    s_lshl_b32 s29, s29, 13
    s_lshl_b32 s30, s23, 9
    s_add_u32 s32, s29, s30
    s_lshl_b32 s31, s22, 12
    s_add_u32 s31, s31, 0
    s_cmp_eq_u32 s25, 0
    s_cbranch_scc1 Lm_da_8
    s_mov_b32 m0, s31
    s_add_u32 s31, s31, 1024
    buffer_load_dwordx4 v8, s[8:11], s32 offen  lds
    s_mov_b32 m0, s31
    s_add_u32 s31, s31, 1024
    buffer_load_dwordx4 v9, s[8:11], s32 offen  lds
    s_mov_b32 m0, s31
    s_add_u32 s31, s31, 1024
    buffer_load_dwordx4 v10, s[8:11], s32 offen  lds
    s_mov_b32 m0, s31
    s_add_u32 s31, s31, 1024
    buffer_load_dwordx4 v11, s[8:11], s32 offen  lds
    s_cmp_eq_u32 s27, 3
    s_cbranch_scc0 Lm_da_8
    s_add_u32 s31, s31, 4096
    s_add_u32 s32, s32, 262144
    s_mov_b32 m0, s31
    s_add_u32 s31, s31, 1024
    buffer_load_dwordx4 v8, s[8:11], s32 offen  lds
    s_mov_b32 m0, s31
    s_add_u32 s31, s31, 1024
    buffer_load_dwordx4 v9, s[8:11], s32 offen  lds
    s_mov_b32 m0, s31
    s_add_u32 s31, s31, 1024
    buffer_load_dwordx4 v10, s[8:11], s32 offen  lds
    s_mov_b32 m0, s31
    s_add_u32 s31, s31, 1024
    buffer_load_dwordx4 v11, s[8:11], s32 offen  lds
Lm_da_8:
    s_lshl_b32 s28, s27, 1
    s_add_u32 s28, s28, 1
    s_cmp_ge_u32 s28, 7
    s_cselect_b32 s29, 7, 0
    s_sub_u32 s28, s28, s29
    s_lshl_b32 s53, s28, 6
    s_mul_i32 s29, s26, 7
    s_add_u32 s28, s28, s29
    s_lshr_b32 s29, s28, 1
    s_lshl_b32 s29, s29, 6
    s_and_b32 s30, s28, 1
    s_lshl_b32 s30, s30, 4
    s_add_u32 s29, s29, s30
    s_lshl_b32 s29, s29, 13
    s_lshl_b32 s30, s23, 9
    s_add_u32 s32, s29, s30
    s_lshl_b32 s31, s22, 12
    s_add_u32 s31, s31, 16384
    s_cmp_eq_u32 s25, 0
    s_cbranch_scc1 Lm_da_9
    s_mov_b32 m0, s31
    s_add_u32 s31, s31, 1024
    buffer_load_dwordx4 v8, s[8:11], s32 offen  lds
    s_mov_b32 m0, s31
    s_add_u32 s31, s31, 1024
    buffer_load_dwordx4 v9, s[8:11], s32 offen  lds
    s_mov_b32 m0, s31
    s_add_u32 s31, s31, 1024
    buffer_load_dwordx4 v10, s[8:11], s32 offen  lds
    s_mov_b32 m0, s31
    s_add_u32 s31, s31, 1024
    buffer_load_dwordx4 v11, s[8:11], s32 offen  lds
    s_cmp_eq_u32 s27, 3
    s_cbranch_scc0 Lm_da_9
    s_add_u32 s31, s31, 4096
    s_add_u32 s32, s32, 262144
    s_mov_b32 m0, s31
    s_add_u32 s31, s31, 1024
    buffer_load_dwordx4 v8, s[8:11], s32 offen  lds
    s_mov_b32 m0, s31
    s_add_u32 s31, s31, 1024
    buffer_load_dwordx4 v9, s[8:11], s32 offen  lds
    s_mov_b32 m0, s31
    s_add_u32 s31, s31, 1024
    buffer_load_dwordx4 v10, s[8:11], s32 offen  lds
    s_mov_b32 m0, s31
    s_add_u32 s31, s31, 1024
    buffer_load_dwordx4 v11, s[8:11], s32 offen  lds
Lm_da_9:
    s_lshl_b32 s28, s27, 1
    s_add_u32 s28, s28, 2
    s_cmp_ge_u32 s28, 7
    s_cselect_b32 s29, 7, 0
    s_sub_u32 s28, s28, s29
    s_lshl_b32 s54, s28, 6
    s_mul_i32 s29, s26, 7
    s_add_u32 s28, s28, s29
    s_lshr_b32 s29, s28, 1
    s_lshl_b32 s29, s29, 6
    s_and_b32 s30, s28, 1
    s_lshl_b32 s30, s30, 4
    s_add_u32 s29, s29, s30
    s_lshl_b32 s29, s29, 13
    s_lshl_b32 s30, s23, 9
    s_add_u32 s32, s29, s30
    s_lshl_b32 s31, s22, 12
    s_add_u32 s31, s31, 32768
    s_cmp_eq_u32 s25, 0
    s_cbranch_scc1 Lm_da_10
    s_mov_b32 m0, s31
    s_add_u32 s31, s31, 1024
    buffer_load_dwordx4 v8, s[8:11], s32 offen  lds
    s_mov_b32 m0, s31
    s_add_u32 s31, s31, 1024
    buffer_load_dwordx4 v9, s[8:11], s32 offen  lds
    s_mov_b32 m0, s31
    s_add_u32 s31, s31, 1024
    buffer_load_dwordx4 v10, s[8:11], s32 offen  lds
    s_mov_b32 m0, s31
    s_add_u32 s31, s31, 1024
    buffer_load_dwordx4 v11, s[8:11], s32 offen  lds
    s_cmp_eq_u32 s27, 3
    s_cbranch_scc0 Lm_da_10
    s_add_u32 s31, s31, 4096
    s_add_u32 s32, s32, 262144
    s_mov_b32 m0, s31
    s_add_u32 s31, s31, 1024
    buffer_load_dwordx4 v8, s[8:11], s32 offen  lds
    s_mov_b32 m0, s31
    s_add_u32 s31, s31, 1024
    buffer_load_dwordx4 v9, s[8:11], s32 offen  lds
    s_mov_b32 m0, s31
    s_add_u32 s31, s31, 1024
    buffer_load_dwordx4 v10, s[8:11], s32 offen  lds
    s_mov_b32 m0, s31
    s_add_u32 s31, s31, 1024
    buffer_load_dwordx4 v11, s[8:11], s32 offen  lds
Lm_da_10:
    s_lshl_b32 s28, s27, 1
    s_add_u32 s28, s28, 3
    s_cmp_ge_u32 s28, 7
    s_cselect_b32 s29, 7, 0
    s_sub_u32 s28, s28, s29
    s_lshl_b32 s55, s28, 6
    s_mul_i32 s29, s26, 7
    s_add_u32 s28, s28, s29
    s_lshr_b32 s29, s28, 1
    s_lshl_b32 s29, s29, 6
    s_and_b32 s30, s28, 1
    s_lshl_b32 s30, s30, 4
    s_add_u32 s29, s29, s30
    s_lshl_b32 s29, s29, 13
    s_lshl_b32 s30, s23, 9
    s_add_u32 s32, s29, s30
    s_lshl_b32 s31, s22, 12
    s_add_u32 s31, s31, 49152
    s_cmp_eq_u32 s25, 0
    s_cbranch_scc1 Lm_da_11
    s_mov_b32 m0, s31
    s_add_u32 s31, s31, 1024
    buffer_load_dwordx4 v8, s[8:11], s32 offen  lds
    s_mov_b32 m0, s31
    s_add_u32 s31, s31, 1024
    buffer_load_dwordx4 v9, s[8:11], s32 offen  lds
    s_mov_b32 m0, s31
    s_add_u32 s31, s31, 1024
    buffer_load_dwordx4 v10, s[8:11], s32 offen  lds
    s_mov_b32 m0, s31
    s_add_u32 s31, s31, 1024
    buffer_load_dwordx4 v11, s[8:11], s32 offen  lds
    s_cmp_eq_u32 s27, 3
    s_cbranch_scc0 Lm_da_11
    s_add_u32 s31, s31, 4096
    s_add_u32 s32, s32, 262144
    s_mov_b32 m0, s31
    s_add_u32 s31, s31, 1024
    buffer_load_dwordx4 v8, s[8:11], s32 offen  lds
    s_mov_b32 m0, s31
    s_add_u32 s31, s31, 1024
    buffer_load_dwordx4 v9, s[8:11], s32 offen  lds
    s_mov_b32 m0, s31
    s_add_u32 s31, s31, 1024
    buffer_load_dwordx4 v10, s[8:11], s32 offen  lds
    s_mov_b32 m0, s31
    s_add_u32 s31, s31, 1024
    buffer_load_dwordx4 v11, s[8:11], s32 offen  lds
Lm_da_11:
    s_lshl_b32 s28, s27, 1
    s_add_u32 s28, s28, 4
    s_cmp_ge_u32 s28, 7
    s_cselect_b32 s29, 7, 0
    s_sub_u32 s28, s28, s29
    s_lshl_b32 s56, s28, 6
    s_mul_i32 s29, s26, 7
    s_add_u32 s28, s28, s29
    s_lshr_b32 s29, s28, 1
    s_lshl_b32 s29, s29, 6
    s_and_b32 s30, s28, 1
    s_lshl_b32 s30, s30, 4
    s_add_u32 s29, s29, s30
    s_lshl_b32 s29, s29, 13
    s_lshl_b32 s30, s23, 9
    s_add_u32 s32, s29, s30
    s_lshl_b32 s31, s22, 12
    s_add_u32 s31, s31, 65536
    s_cmp_eq_u32 s25, 0
    s_cbranch_scc1 Lm_da_12
    s_mov_b32 m0, s31
    s_add_u32 s31, s31, 1024
    buffer_load_dwordx4 v8, s[8:11], s32 offen  lds
    s_mov_b32 m0, s31
    s_add_u32 s31, s31, 1024
    buffer_load_dwordx4 v9, s[8:11], s32 offen  lds
    s_mov_b32 m0, s31
    s_add_u32 s31, s31, 1024
    buffer_load_dwordx4 v10, s[8:11], s32 offen  lds
    s_mov_b32 m0, s31
    s_add_u32 s31, s31, 1024
    buffer_load_dwordx4 v11, s[8:11], s32 offen  lds
    s_cmp_eq_u32 s27, 3
    s_cbranch_scc0 Lm_da_12
    s_add_u32 s31, s31, 4096
    s_add_u32 s32, s32, 262144
    s_mov_b32 m0, s31
    s_add_u32 s31, s31, 1024
    buffer_load_dwordx4 v8, s[8:11], s32 offen  lds
    s_mov_b32 m0, s31
    s_add_u32 s31, s31, 1024
    buffer_load_dwordx4 v9, s[8:11], s32 offen  lds
    s_mov_b32 m0, s31
    s_add_u32 s31, s31, 1024
    buffer_load_dwordx4 v10, s[8:11], s32 offen  lds
    s_mov_b32 m0, s31
    s_add_u32 s31, s31, 1024
    buffer_load_dwordx4 v11, s[8:11], s32 offen  lds
Lm_da_12:
    s_lshl_b32 s28, s27, 1
    s_add_u32 s28, s28, 5
    s_cmp_ge_u32 s28, 7
    s_cselect_b32 s29, 7, 0
    s_sub_u32 s28, s28, s29
    s_lshl_b32 s57, s28, 6
    s_mul_i32 s29, s26, 7
    s_add_u32 s28, s28, s29
    s_lshr_b32 s29, s28, 1
    s_lshl_b32 s29, s29, 6
    s_and_b32 s30, s28, 1
    s_lshl_b32 s30, s30, 4
    s_add_u32 s29, s29, s30
    s_lshl_b32 s29, s29, 13
    s_lshl_b32 s30, s23, 9
    s_add_u32 s32, s29, s30
    s_lshl_b32 s31, s22, 12
    s_add_u32 s31, s31, 81920
    s_cmp_eq_u32 s25, 0
    s_cbranch_scc1 Lm_da_13
    s_mov_b32 m0, s31
    s_add_u32 s31, s31, 1024
    buffer_load_dwordx4 v8, s[8:11], s32 offen  lds
    s_mov_b32 m0, s31
    s_add_u32 s31, s31, 1024
    buffer_load_dwordx4 v9, s[8:11], s32 offen  lds
    s_mov_b32 m0, s31
    s_add_u32 s31, s31, 1024
    buffer_load_dwordx4 v10, s[8:11], s32 offen  lds
    s_mov_b32 m0, s31
    s_add_u32 s31, s31, 1024
    buffer_load_dwordx4 v11, s[8:11], s32 offen  lds
    s_cmp_eq_u32 s27, 3
    s_cbranch_scc0 Lm_da_13
    s_add_u32 s31, s31, 4096
    s_add_u32 s32, s32, 262144
    s_mov_b32 m0, s31
    s_add_u32 s31, s31, 1024
    buffer_load_dwordx4 v8, s[8:11], s32 offen  lds
    s_mov_b32 m0, s31
    s_add_u32 s31, s31, 1024
    buffer_load_dwordx4 v9, s[8:11], s32 offen  lds
    s_mov_b32 m0, s31
    s_add_u32 s31, s31, 1024
    buffer_load_dwordx4 v10, s[8:11], s32 offen  lds
    s_mov_b32 m0, s31
    s_add_u32 s31, s31, 1024
    buffer_load_dwordx4 v11, s[8:11], s32 offen  lds
Lm_da_13:
    s_lshl_b32 s28, s27, 1
    s_add_u32 s28, s28, 6
    s_cmp_ge_u32 s28, 7
    s_cselect_b32 s29, 7, 0
    s_sub_u32 s28, s28, s29
    s_lshl_b32 s58, s28, 6
    s_mul_i32 s29, s26, 7
    s_add_u32 s28, s28, s29
    s_lshr_b32 s29, s28, 1
    s_lshl_b32 s29, s29, 6
    s_and_b32 s30, s28, 1
    s_lshl_b32 s30, s30, 4
    s_add_u32 s29, s29, s30
    s_lshl_b32 s29, s29, 13
    s_lshl_b32 s30, s23, 9
    s_add_u32 s32, s29, s30
    s_lshl_b32 s31, s22, 12
    s_add_u32 s31, s31, 98304
    s_cmp_eq_u32 s25, 0
    s_cbranch_scc1 Lm_da_14
    s_mov_b32 m0, s31
    s_add_u32 s31, s31, 1024
    buffer_load_dwordx4 v8, s[8:11], s32 offen  lds
    s_mov_b32 m0, s31
    s_add_u32 s31, s31, 1024
    buffer_load_dwordx4 v9, s[8:11], s32 offen  lds
    s_mov_b32 m0, s31
    s_add_u32 s31, s31, 1024
    buffer_load_dwordx4 v10, s[8:11], s32 offen  lds
    s_mov_b32 m0, s31
    s_add_u32 s31, s31, 1024
    buffer_load_dwordx4 v11, s[8:11], s32 offen  lds
    s_cmp_eq_u32 s27, 3
    s_cbranch_scc0 Lm_da_14
    s_add_u32 s31, s31, 4096
    s_add_u32 s32, s32, 262144
    s_mov_b32 m0, s31
    s_add_u32 s31, s31, 1024
    buffer_load_dwordx4 v8, s[8:11], s32 offen  lds
    s_mov_b32 m0, s31
    s_add_u32 s31, s31, 1024
    buffer_load_dwordx4 v9, s[8:11], s32 offen  lds
    s_mov_b32 m0, s31
    s_add_u32 s31, s31, 1024
    buffer_load_dwordx4 v10, s[8:11], s32 offen  lds
    s_mov_b32 m0, s31
    s_add_u32 s31, s31, 1024
    buffer_load_dwordx4 v11, s[8:11], s32 offen  lds
Lm_da_14:
    v_lshlrev_b32 v12, 4, v0
    s_cmp_eq_u32 s25, 0
    s_cbranch_scc1 Lm_noB
    s_cmp_lt_u32 s20, 16
    s_cbranch_scc1 Lm_noB
    v_and_b32 v24, 15, v1
    v_lshrrev_b32 v25, 2, v24
    v_lshlrev_b32 v27, 3, v21
    v_add_u32 v25, v25, v27
    v_mul_u32_u24 v29, 64, v25
    v_and_b32 v25, 3, v24
    v_lshlrev_b32 v25, 3, v25
    v_add_u32 v29, v29, v25
    v_bfe_u32 v25, v1, 4, 1
    v_lshlrev_b32 v25, 5, v25
    v_add_u32 v29, v29, v25
    v_add_u32 v29, s36, v29
    s_cmp_eq_u32 s27, 3
    s_cbranch_scc1 Lm_uw_15
    s_waitcnt vmcnt(43)
    s_branch Lm_uw_15_e
Lm_uw_15:
    s_waitcnt vmcnt(63)
Lm_uw_15_e:
    ds_write_b128 v28, v[128:131] offset:0
    s_cmp_eq_u32 s27, 3
    s_cbranch_scc1 Lm_uw_16
    s_waitcnt vmcnt(42)
    s_branch Lm_uw_16_e
Lm_uw_16:
    s_waitcnt vmcnt(63)
Lm_uw_16_e:
    ds_write_b128 v28, v[132:135] offset:1024
    s_cmp_eq_u32 s27, 3
    s_cbranch_scc1 Lm_uw_17
    s_waitcnt vmcnt(41)
    s_branch Lm_uw_17_e
Lm_uw_17:
    s_waitcnt vmcnt(63)
Lm_uw_17_e:
    ds_write_b128 v28, v[136:139] offset:2048
    s_cmp_eq_u32 s27, 3
    s_cbranch_scc1 Lm_uw_18
    s_waitcnt vmcnt(40)
    s_branch Lm_uw_18_e
Lm_uw_18:
    s_waitcnt vmcnt(63)
Lm_uw_18_e:
    ds_write_b128 v28, v[140:143] offset:3072
    s_cmp_eq_u32 s27, 3
    s_cbranch_scc1 Lm_uw_19
    s_waitcnt vmcnt(39)
    s_branch Lm_uw_19_e
Lm_uw_19:
    s_waitcnt vmcnt(63)
Lm_uw_19_e:
    ds_write_b128 v28, v[144:147] offset:4096
    s_cmp_eq_u32 s27, 3
    s_cbranch_scc1 Lm_uw_20
    s_waitcnt vmcnt(38)
    s_branch Lm_uw_20_e
Lm_uw_20:
    s_waitcnt vmcnt(63)
Lm_uw_20_e:
    ds_write_b128 v28, v[148:151] offset:5120
    s_cmp_eq_u32 s27, 3
    s_cbranch_scc1 Lm_uw_21
    s_waitcnt vmcnt(37)
    s_branch Lm_uw_21_e
Lm_uw_21:
    s_waitcnt vmcnt(63)
Lm_uw_21_e:
    ds_write_b128 v28, v[152:155] offset:6144
    s_cmp_eq_u32 s27, 3
    s_cbranch_scc1 Lm_uw_22
    s_waitcnt vmcnt(36)
    s_branch Lm_uw_22_e
Lm_uw_22:
    s_waitcnt vmcnt(63)
Lm_uw_22_e:
    ds_write_b128 v28, v[156:159] offset:7168
    s_waitcnt lgkmcnt(0)
    ds_read_b64_tr_b16 v[64:65], v29 offset:0
    ds_read_b64_tr_b16 v[66:67], v29 offset:256
    ds_read_b64_tr_b16 v[68:69], v29 offset:1024
    ds_read_b64_tr_b16 v[70:71], v29 offset:1280
    ds_read_b64_tr_b16 v[72:73], v29 offset:2048
    ds_read_b64_tr_b16 v[74:75], v29 offset:2304
    ds_read_b64_tr_b16 v[76:77], v29 offset:3072
    ds_read_b64_tr_b16 v[78:79], v29 offset:3328
    ds_read_b64_tr_b16 v[80:81], v29 offset:4096
    ds_read_b64_tr_b16 v[82:83], v29 offset:4352
    ds_read_b64_tr_b16 v[84:85], v29 offset:5120
    ds_read_b64_tr_b16 v[86:87], v29 offset:5376
    ds_read_b64_tr_b16 v[88:89], v29 offset:6144
    ds_read_b64_tr_b16 v[90:91], v29 offset:6400
    ds_read_b64_tr_b16 v[92:93], v29 offset:7168
    ds_read_b64_tr_b16 v[94:95], v29 offset:7424
    s_waitcnt lgkmcnt(0)
    s_cmp_eq_u32 s27, 3
    s_cbranch_scc1 Lm_uw_23
    s_waitcnt vmcnt(35)
    s_branch Lm_uw_23_e
Lm_uw_23:
    s_waitcnt vmcnt(63)
Lm_uw_23_e:
    ds_write_b128 v28, v[160:163] offset:0
    s_cmp_eq_u32 s27, 3
    s_cbranch_scc1 Lm_uw_24
    s_waitcnt vmcnt(34)
    s_branch Lm_uw_24_e
Lm_uw_24:
    s_waitcnt vmcnt(62)
Lm_uw_24_e:
    ds_write_b128 v28, v[164:167] offset:1024
    s_cmp_eq_u32 s27, 3
    s_cbranch_scc1 Lm_uw_25
    s_waitcnt vmcnt(33)
    s_branch Lm_uw_25_e
Lm_uw_25:
    s_waitcnt vmcnt(61)
Lm_uw_25_e:
    ds_write_b128 v28, v[168:171] offset:2048
    s_cmp_eq_u32 s27, 3
    s_cbranch_scc1 Lm_uw_26
    s_waitcnt vmcnt(32)
    s_branch Lm_uw_26_e
Lm_uw_26:
    s_waitcnt vmcnt(60)
Lm_uw_26_e:
    ds_write_b128 v28, v[172:175] offset:3072
    s_cmp_eq_u32 s27, 3
    s_cbranch_scc1 Lm_uw_27
    s_waitcnt vmcnt(31)
    s_branch Lm_uw_27_e
Lm_uw_27:
    s_waitcnt vmcnt(59)
Lm_uw_27_e:
    ds_write_b128 v28, v[176:179] offset:4096
    s_cmp_eq_u32 s27, 3
    s_cbranch_scc1 Lm_uw_28
    s_waitcnt vmcnt(30)
    s_branch Lm_uw_28_e
Lm_uw_28:
    s_waitcnt vmcnt(58)
Lm_uw_28_e:
    ds_write_b128 v28, v[180:183] offset:5120
    s_cmp_eq_u32 s27, 3
    s_cbranch_scc1 Lm_uw_29
    s_waitcnt vmcnt(29)
    s_branch Lm_uw_29_e
Lm_uw_29:
    s_waitcnt vmcnt(57)
Lm_uw_29_e:
    ds_write_b128 v28, v[184:187] offset:6144
    s_cmp_eq_u32 s27, 3
    s_cbranch_scc1 Lm_uw_30
    s_waitcnt vmcnt(28)
    s_branch Lm_uw_30_e
Lm_uw_30:
    s_waitcnt vmcnt(56)
Lm_uw_30_e:
    ds_write_b128 v28, v[188:191] offset:7168
    s_waitcnt lgkmcnt(0)
    ds_read_b64_tr_b16 v[96:97], v29 offset:0
    ds_read_b64_tr_b16 v[98:99], v29 offset:256
    ds_read_b64_tr_b16 v[100:101], v29 offset:1024
    ds_read_b64_tr_b16 v[102:103], v29 offset:1280
    ds_read_b64_tr_b16 v[104:105], v29 offset:2048
    ds_read_b64_tr_b16 v[106:107], v29 offset:2304
    ds_read_b64_tr_b16 v[108:109], v29 offset:3072
    ds_read_b64_tr_b16 v[110:111], v29 offset:3328
    ds_read_b64_tr_b16 v[112:113], v29 offset:4096
    ds_read_b64_tr_b16 v[114:115], v29 offset:4352
    ds_read_b64_tr_b16 v[116:117], v29 offset:5120
    ds_read_b64_tr_b16 v[118:119], v29 offset:5376
    ds_read_b64_tr_b16 v[120:121], v29 offset:6144
    ds_read_b64_tr_b16 v[122:123], v29 offset:6400
    ds_read_b64_tr_b16 v[124:125], v29 offset:7168
    ds_read_b64_tr_b16 v[126:127], v29 offset:7424
    s_waitcnt lgkmcnt(0)
Lm_noB:
    v_and_b32 v22, 15, v20
    v_lshlrev_b32 v23, 9, v20
    v_add_u32 v24, 0, v21
    v_xor_b32 v24, v24, v22
    v_lshlrev_b32 v24, 4, v24
    v_add_u32 v32, v23, v24
    v_add_u32 v24, 2, v21
    v_xor_b32 v24, v24, v22
    v_lshlrev_b32 v24, 4, v24
    v_add_u32 v33, v23, v24
    v_add_u32 v24, 4, v21
    v_xor_b32 v24, v24, v22
    v_lshlrev_b32 v24, 4, v24
    v_add_u32 v34, v23, v24
    v_add_u32 v24, 6, v21
    v_xor_b32 v24, v24, v22
    v_lshlrev_b32 v24, 4, v24
    v_add_u32 v35, v23, v24
    v_add_u32 v24, 8, v21
    v_xor_b32 v24, v24, v22
    v_lshlrev_b32 v24, 4, v24
    v_add_u32 v36, v23, v24
    v_add_u32 v24, 10, v21
    v_xor_b32 v24, v24, v22
    v_lshlrev_b32 v24, 4, v24
    v_add_u32 v37, v23, v24
    v_add_u32 v24, 12, v21
    v_xor_b32 v24, v24, v22
    v_lshlrev_b32 v24, 4, v24
    v_add_u32 v38, v23, v24
    v_add_u32 v24, 14, v21
    v_xor_b32 v24, v24, v22
    v_lshlrev_b32 v24, 4, v24
    v_add_u32 v39, v23, v24
    s_cmp_lt_u32 s20, 16
    s_cselect_b32 s38, 0x3db8aa3b, 1.0
    s_cselect_b32 s39, 0, 7168
    s_mul_i32 s33, s23, 448
    s_add_u32 s39, s39, s33
    s_lshl_b32 s33, s24, 5
    s_add_u32 s39, s39, s33
    s_mul_i32 s39, s39, 896
    s_add_u32 s39, s39, 0
    s_mul_i32 s33, s26, 448
    s_add_u32 s39, s39, s33
    s_lshl_b32 s34, s22, 11
    s_add_u32 s34, s34, 147456
    v_lshlrev_b32 v56, 6, v20
    v_lshlrev_b32 v24, 5, v21
    v_add_u32 v56, v56, v24
    v_add_u32 v56, s34, v56
    v_lshlrev_b32 v57, 4, v1
    v_add_u32 v57, s34, v57
    v_lshrrev_b32 v58, 2, v1
    v_mul_u32_u24 v58, 896, v58
    v_and_b32 v24, 3, v1
    v_lshlrev_b32 v24, 4, v24
    v_add_u32 v58, v58, v24
    v_mov_b32 v128, 0
    v_mov_b32 v129, 0
    v_mov_b32 v130, 0
    v_mov_b32 v131, 0
    v_mov_b32 v132, 0
    v_mov_b32 v133, 0
    v_mov_b32 v134, 0
    v_mov_b32 v135, 0
    v_mov_b32 v136, 0
    v_mov_b32 v137, 0
    v_mov_b32 v138, 0
    v_mov_b32 v139, 0
    v_mov_b32 v140, 0
    v_mov_b32 v141, 0
    v_mov_b32 v142, 0
    v_mov_b32 v143, 0
    v_mov_b32 v144, 0
    v_mov_b32 v145, 0
    v_mov_b32 v146, 0
    v_mov_b32 v147, 0
    v_mov_b32 v148, 0
    v_mov_b32 v149, 0
    v_mov_b32 v150, 0
    v_mov_b32 v151, 0
    v_mov_b32 v152, 0
    v_mov_b32 v153, 0
    v_mov_b32 v154, 0
    v_mov_b32 v155, 0
    v_mov_b32 v156, 0
    v_mov_b32 v157, 0
    v_mov_b32 v158, 0
    v_mov_b32 v159, 0
    s_cmp_eq_u32 s25, 0
    s_cbranch_scc1 Lm_idle
    v_add_u32 v176, 16384, v32
    v_add_u32 v177, 16384, v33
    v_add_u32 v178, 16384, v34
    v_add_u32 v179, 16384, v35
    v_add_u32 v180, 16384, v36
    v_add_u32 v181, 16384, v37
    v_add_u32 v182, 16384, v38
    v_add_u32 v183, 16384, v39
    s_cmp_eq_u32 s27, 3
    s_cbranch_scc1 Lm_sw_31
    s_waitcnt vmcnt(24)
    s_branch Lm_sw_31_e
Lm_sw_31:
    s_waitcnt vmcnt(48)
Lm_sw_31_e:
    s_barrier
    ds_read_b128 v[40:43], v32 offset:0
    ds_read_b128 v[44:47], v33 offset:0
    ds_read_b128 v[48:51], v34 offset:0
    ds_read_b128 v[52:55], v35 offset:0
    s_waitcnt lgkmcnt(3)
    v_mfma_f32_32x32x16_bf16 v[128:143], v[40:43], v[64:67], v[128:143]
    ds_read_b128 v[40:43], v36 offset:0
    s_waitcnt lgkmcnt(3)
    v_mfma_f32_32x32x16_bf16 v[128:143], v[44:47], v[68:71], v[128:143]
    ds_read_b128 v[44:47], v37 offset:0
    s_waitcnt lgkmcnt(3)
    v_mfma_f32_32x32x16_bf16 v[128:143], v[48:51], v[72:75], v[128:143]
    ds_read_b128 v[48:51], v38 offset:0
    s_waitcnt lgkmcnt(3)
    v_mfma_f32_32x32x16_bf16 v[128:143], v[52:55], v[76:79], v[128:143]
    ds_read_b128 v[52:55], v39 offset:0
    s_waitcnt lgkmcnt(3)
    v_mfma_f32_32x32x16_bf16 v[128:143], v[40:43], v[80:83], v[128:143]
    ds_read_b128 v[40:43], v32 offset:256
    s_waitcnt lgkmcnt(3)
    v_mfma_f32_32x32x16_bf16 v[128:143], v[44:47], v[84:87], v[128:143]
    ds_read_b128 v[44:47], v33 offset:256
    s_waitcnt lgkmcnt(3)
    v_mfma_f32_32x32x16_bf16 v[128:143], v[48:51], v[88:91], v[128:143]
    ds_read_b128 v[48:51], v34 offset:256
    s_waitcnt lgkmcnt(3)
    v_mfma_f32_32x32x16_bf16 v[128:143], v[52:55], v[92:95], v[128:143]
    ds_read_b128 v[52:55], v35 offset:256
    s_waitcnt lgkmcnt(3)
    v_mfma_f32_32x32x16_bf16 v[128:143], v[40:43], v[96:99], v[128:143]
    ds_read_b128 v[40:43], v36 offset:256
    s_waitcnt lgkmcnt(3)
    v_mfma_f32_32x32x16_bf16 v[128:143], v[44:47], v[100:103], v[128:143]
    ds_read_b128 v[44:47], v37 offset:256
    s_waitcnt lgkmcnt(3)
    v_mfma_f32_32x32x16_bf16 v[128:143], v[48:51], v[104:107], v[128:143]
    ds_read_b128 v[48:51], v38 offset:256
    s_waitcnt lgkmcnt(3)
    v_mfma_f32_32x32x16_bf16 v[128:143], v[52:55], v[108:111], v[128:143]
    ds_read_b128 v[52:55], v39 offset:256
    s_waitcnt lgkmcnt(3)
    v_mfma_f32_32x32x16_bf16 v[128:143], v[40:43], v[112:115], v[128:143]
    v_add_u32 v32, 32768, v32
    v_add_u32 v33, 32768, v33
    v_add_u32 v34, 32768, v34
    s_cmp_eq_u32 s27, 3
    s_cbranch_scc1 Lm_sw_32
    s_waitcnt vmcnt(20)
    s_branch Lm_sw_32_e
Lm_sw_32:
    s_waitcnt vmcnt(40)
Lm_sw_32_e:
    s_barrier
    ds_read_b128 v[40:43], v176 offset:0
    s_waitcnt lgkmcnt(3)
    v_mfma_f32_32x32x16_bf16 v[128:143], v[44:47], v[116:119], v[128:143]
    v_add_u32 v35, 32768, v35
    v_add_u32 v36, 32768, v36
    v_add_u32 v37, 32768, v37
    ds_read_b128 v[44:47], v177 offset:0
    s_waitcnt lgkmcnt(3)
    v_mfma_f32_32x32x16_bf16 v[128:143], v[48:51], v[120:123], v[128:143]
    v_add_u32 v38, 32768, v38
    v_add_u32 v39, 32768, v39
    ds_read_b128 v[48:51], v178 offset:0
    s_waitcnt lgkmcnt(3)
    v_mfma_f32_32x32x16_bf16 v[128:143], v[52:55], v[124:127], v[128:143]
    ds_read_b128 v[52:55], v179 offset:0
    s_waitcnt lgkmcnt(3)
    v_mfma_f32_32x32x16_bf16 v[144:159], v[40:43], v[64:67], v[144:159]
    ds_read_b128 v[40:43], v180 offset:0
    s_waitcnt lgkmcnt(3)
    v_mfma_f32_32x32x16_bf16 v[144:159], v[44:47], v[68:71], v[144:159]
    ds_read_b128 v[44:47], v181 offset:0
    s_waitcnt lgkmcnt(3)
    v_mfma_f32_32x32x16_bf16 v[144:159], v[48:51], v[72:75], v[144:159]
    ds_read_b128 v[48:51], v182 offset:0
    s_waitcnt lgkmcnt(3)
    v_mfma_f32_32x32x16_bf16 v[144:159], v[52:55], v[76:79], v[144:159]
    ds_read_b128 v[52:55], v183 offset:0
    s_waitcnt lgkmcnt(3)
    v_mfma_f32_32x32x16_bf16 v[144:159], v[40:43], v[80:83], v[144:159]
    v_pk_mul_f32 v[128:129], v[128:129], s[38:39] op_sel_hi:[1,0]
    v_pk_mul_f32 v[130:131], v[130:131], s[38:39] op_sel_hi:[1,0]
    v_pk_mul_f32 v[132:133], v[132:133], s[38:39] op_sel_hi:[1,0]
    ds_read_b128 v[40:43], v176 offset:256
    s_waitcnt lgkmcnt(3)
    v_mfma_f32_32x32x16_bf16 v[144:159], v[44:47], v[84:87], v[144:159]
    v_pk_mul_f32 v[134:135], v[134:135], s[38:39] op_sel_hi:[1,0]
    v_pk_mul_f32 v[136:137], v[136:137], s[38:39] op_sel_hi:[1,0]
    v_pk_mul_f32 v[138:139], v[138:139], s[38:39] op_sel_hi:[1,0]
    ds_read_b128 v[44:47], v177 offset:256
    s_waitcnt lgkmcnt(3)
    v_mfma_f32_32x32x16_bf16 v[144:159], v[48:51], v[88:91], v[144:159]
    v_pk_mul_f32 v[140:141], v[140:141], s[38:39] op_sel_hi:[1,0]
    v_pk_mul_f32 v[142:143], v[142:143], s[38:39] op_sel_hi:[1,0]
    v_cvt_pk_bf16_f32 v160, v128, v129
    ds_read_b128 v[48:51], v178 offset:256
    s_waitcnt lgkmcnt(3)
    v_mfma_f32_32x32x16_bf16 v[144:159], v[52:55], v[92:95], v[144:159]
    v_cvt_pk_bf16_f32 v161, v130, v131
    v_cvt_pk_bf16_f32 v162, v132, v133
    v_cvt_pk_bf16_f32 v163, v134, v135
    ds_read_b128 v[52:55], v179 offset:256
    s_waitcnt lgkmcnt(3)
    v_mfma_f32_32x32x16_bf16 v[144:159], v[40:43], v[96:99], v[144:159]
    v_cvt_pk_bf16_f32 v164, v136, v137
    v_cvt_pk_bf16_f32 v165, v138, v139
    v_cvt_pk_bf16_f32 v166, v140, v141
    ds_read_b128 v[40:43], v180 offset:256
    s_waitcnt lgkmcnt(3)
    v_mfma_f32_32x32x16_bf16 v[144:159], v[44:47], v[100:103], v[144:159]
    v_cvt_pk_bf16_f32 v167, v142, v143
    ds_write_b128 v56, v[160:163]
    ds_write_b128 v56, v[164:167] offset:16
    ds_read_b128 v[44:47], v181 offset:256
    s_waitcnt lgkmcnt(5)
    v_mfma_f32_32x32x16_bf16 v[144:159], v[48:51], v[104:107], v[144:159]
    v_mov_b32 v128, 0
    v_mov_b32 v129, 0
    v_mov_b32 v130, 0
    ds_read_b128 v[48:51], v182 offset:256
    s_waitcnt lgkmcnt(5)
    v_mfma_f32_32x32x16_bf16 v[144:159], v[52:55], v[108:111], v[144:159]
    v_mov_b32 v131, 0
    v_mov_b32 v132, 0
    v_mov_b32 v133, 0
    ds_read_b128 v[52:55], v183 offset:256
    s_waitcnt lgkmcnt(5)
    v_mfma_f32_32x32x16_bf16 v[144:159], v[40:43], v[112:115], v[144:159]
    v_mov_b32 v134, 0
    v_mov_b32 v135, 0
    v_mov_b32 v136, 0
    s_cmp_eq_u32 s27, 3
    s_cbranch_scc1 Lm_sw_33
    s_waitcnt vmcnt(16)
    s_branch Lm_sw_33_e
Lm_sw_33:
    s_waitcnt vmcnt(32)
Lm_sw_33_e:
    s_barrier
    ds_read_b128 v[40:43], v32 offset:0
    s_waitcnt lgkmcnt(3)
    v_mfma_f32_32x32x16_bf16 v[144:159], v[44:47], v[116:119], v[144:159]
    v_mov_b32 v137, 0
    v_mov_b32 v138, 0
    v_mov_b32 v139, 0
    ds_read_b128 v[44:47], v33 offset:0
    s_waitcnt lgkmcnt(3)
    v_mfma_f32_32x32x16_bf16 v[144:159], v[48:51], v[120:123], v[144:159]
    v_mov_b32 v140, 0
    v_mov_b32 v141, 0
    v_mov_b32 v142, 0
    ds_read_b128 v[48:51], v34 offset:0
    s_waitcnt lgkmcnt(3)
    v_mfma_f32_32x32x16_bf16 v[144:159], v[52:55], v[124:127], v[144:159]
    v_mov_b32 v143, 0
    ds_read_b128 v[168:171], v57
    ds_read_b128 v[172:175], v57 offset:1024
    ds_read_b128 v[52:55], v35 offset:0
    s_waitcnt lgkmcnt(5)
    v_mfma_f32_32x32x16_bf16 v[128:143], v[40:43], v[64:67], v[128:143]
    s_waitcnt lgkmcnt(1)
    s_add_u32 s40, s39, s52
    s_add_u32 s41, s40, 14336
    buffer_store_dwordx4 v[168:171], v58, s[16:19], s40 offen sc1
    buffer_store_dwordx4 v[172:175], v58, s[16:19], s41 offen sc1
    ds_read_b128 v[40:43], v36 offset:0
    s_waitcnt lgkmcnt(5)
    v_mfma_f32_32x32x16_bf16 v[128:143], v[44:47], v[68:71], v[128:143]
    v_add_u32 v176, 32768, v176
    v_add_u32 v177, 32768, v177
    v_add_u32 v178, 32768, v178
    ds_read_b128 v[44:47], v37 offset:0
    s_waitcnt lgkmcnt(5)
    v_mfma_f32_32x32x16_bf16 v[128:143], v[48:51], v[72:75], v[128:143]
    v_add_u32 v179, 32768, v179
    v_add_u32 v180, 32768, v180
    v_add_u32 v181, 32768, v181
    ds_read_b128 v[48:51], v38 offset:0
    s_waitcnt lgkmcnt(3)
    v_mfma_f32_32x32x16_bf16 v[128:143], v[52:55], v[76:79], v[128:143]
    v_add_u32 v182, 32768, v182
    v_add_u32 v183, 32768, v183
    ds_read_b128 v[52:55], v39 offset:0
    s_waitcnt lgkmcnt(3)
    v_mfma_f32_32x32x16_bf16 v[128:143], v[40:43], v[80:83], v[128:143]
    v_pk_mul_f32 v[144:145], v[144:145], s[38:39] op_sel_hi:[1,0]
    v_pk_mul_f32 v[146:147], v[146:147], s[38:39] op_sel_hi:[1,0]
    v_pk_mul_f32 v[148:149], v[148:149], s[38:39] op_sel_hi:[1,0]
    ds_read_b128 v[40:43], v32 offset:256
    s_waitcnt lgkmcnt(3)
    v_mfma_f32_32x32x16_bf16 v[128:143], v[44:47], v[84:87], v[128:143]
    v_pk_mul_f32 v[150:151], v[150:151], s[38:39] op_sel_hi:[1,0]
    v_pk_mul_f32 v[152:153], v[152:153], s[38:39] op_sel_hi:[1,0]
    v_pk_mul_f32 v[154:155], v[154:155], s[38:39] op_sel_hi:[1,0]
    ds_read_b128 v[44:47], v33 offset:256
    s_waitcnt lgkmcnt(3)
    v_mfma_f32_32x32x16_bf16 v[128:143], v[48:51], v[88:91], v[128:143]
    v_pk_mul_f32 v[156:157], v[156:157], s[38:39] op_sel_hi:[1,0]
    v_pk_mul_f32 v[158:159], v[158:159], s[38:39] op_sel_hi:[1,0]
    v_cvt_pk_bf16_f32 v160, v144, v145
    ds_read_b128 v[48:51], v34 offset:256
    s_waitcnt lgkmcnt(3)
    v_mfma_f32_32x32x16_bf16 v[128:143], v[52:55], v[92:95], v[128:143]
    v_cvt_pk_bf16_f32 v161, v146, v147
    v_cvt_pk_bf16_f32 v162, v148, v149
    v_cvt_pk_bf16_f32 v163, v150, v151
    ds_read_b128 v[52:55], v35 offset:256
    s_waitcnt lgkmcnt(3)
    v_mfma_f32_32x32x16_bf16 v[128:143], v[40:43], v[96:99], v[128:143]
    v_cvt_pk_bf16_f32 v164, v152, v153
    v_cvt_pk_bf16_f32 v165, v154, v155
    v_cvt_pk_bf16_f32 v166, v156, v157
    ds_read_b128 v[40:43], v36 offset:256
    s_waitcnt lgkmcnt(3)
    v_mfma_f32_32x32x16_bf16 v[128:143], v[44:47], v[100:103], v[128:143]
    v_cvt_pk_bf16_f32 v167, v158, v159
    ds_write_b128 v56, v[160:163]
    ds_write_b128 v56, v[164:167] offset:16
    ds_read_b128 v[44:47], v37 offset:256
    s_waitcnt lgkmcnt(5)
    v_mfma_f32_32x32x16_bf16 v[128:143], v[48:51], v[104:107], v[128:143]
    v_mov_b32 v144, 0
    v_mov_b32 v145, 0
    v_mov_b32 v146, 0
    ds_read_b128 v[48:51], v38 offset:256
    s_waitcnt lgkmcnt(5)
    v_mfma_f32_32x32x16_bf16 v[128:143], v[52:55], v[108:111], v[128:143]
    v_mov_b32 v147, 0
    v_mov_b32 v148, 0
    v_mov_b32 v149, 0
    ds_read_b128 v[52:55], v39 offset:256
    s_waitcnt lgkmcnt(5)
    v_mfma_f32_32x32x16_bf16 v[128:143], v[40:43], v[112:115], v[128:143]
    v_mov_b32 v150, 0
    v_mov_b32 v151, 0
    v_mov_b32 v152, 0
    s_cmp_eq_u32 s27, 3
    s_cbranch_scc1 Lm_sw_34
    s_waitcnt vmcnt(14)
    s_branch Lm_sw_34_e
Lm_sw_34:
    s_waitcnt vmcnt(26)
Lm_sw_34_e:
    s_barrier
    ds_read_b128 v[40:43], v176 offset:0
    s_waitcnt lgkmcnt(3)
    v_mfma_f32_32x32x16_bf16 v[128:143], v[44:47], v[116:119], v[128:143]
    v_mov_b32 v153, 0
    v_mov_b32 v154, 0
    v_mov_b32 v155, 0
    ds_read_b128 v[44:47], v177 offset:0
    s_waitcnt lgkmcnt(3)
    v_mfma_f32_32x32x16_bf16 v[128:143], v[48:51], v[120:123], v[128:143]
    v_mov_b32 v156, 0
    v_mov_b32 v157, 0
    v_mov_b32 v158, 0
    ds_read_b128 v[48:51], v178 offset:0
    s_waitcnt lgkmcnt(3)
    v_mfma_f32_32x32x16_bf16 v[128:143], v[52:55], v[124:127], v[128:143]
    v_mov_b32 v159, 0
    ds_read_b128 v[168:171], v57
    ds_read_b128 v[172:175], v57 offset:1024
    ds_read_b128 v[52:55], v179 offset:0
    s_waitcnt lgkmcnt(5)
    v_mfma_f32_32x32x16_bf16 v[144:159], v[40:43], v[64:67], v[144:159]
    s_waitcnt lgkmcnt(1)
    s_add_u32 s40, s39, s53
    s_add_u32 s41, s40, 14336
    buffer_store_dwordx4 v[168:171], v58, s[16:19], s40 offen sc1
    buffer_store_dwordx4 v[172:175], v58, s[16:19], s41 offen sc1
    ds_read_b128 v[40:43], v180 offset:0
    s_waitcnt lgkmcnt(5)
    v_mfma_f32_32x32x16_bf16 v[144:159], v[44:47], v[68:71], v[144:159]
    v_add_u32 v32, 32768, v32
    v_add_u32 v33, 32768, v33
    v_add_u32 v34, 32768, v34
    ds_read_b128 v[44:47], v181 offset:0
    s_waitcnt lgkmcnt(5)
    v_mfma_f32_32x32x16_bf16 v[144:159], v[48:51], v[72:75], v[144:159]
    v_add_u32 v35, 32768, v35
    v_add_u32 v36, 32768, v36
    v_add_u32 v37, 32768, v37
    ds_read_b128 v[48:51], v182 offset:0
    s_waitcnt lgkmcnt(3)
    v_mfma_f32_32x32x16_bf16 v[144:159], v[52:55], v[76:79], v[144:159]
    v_add_u32 v38, 32768, v38
    v_add_u32 v39, 32768, v39
    ds_read_b128 v[52:55], v183 offset:0
    s_waitcnt lgkmcnt(3)
    v_mfma_f32_32x32x16_bf16 v[144:159], v[40:43], v[80:83], v[144:159]
    v_pk_mul_f32 v[128:129], v[128:129], s[38:39] op_sel_hi:[1,0]
    v_pk_mul_f32 v[130:131], v[130:131], s[38:39] op_sel_hi:[1,0]
    v_pk_mul_f32 v[132:133], v[132:133], s[38:39] op_sel_hi:[1,0]
    ds_read_b128 v[40:43], v176 offset:256
    s_waitcnt lgkmcnt(3)
    v_mfma_f32_32x32x16_bf16 v[144:159], v[44:47], v[84:87], v[144:159]
    v_pk_mul_f32 v[134:135], v[134:135], s[38:39] op_sel_hi:[1,0]
    v_pk_mul_f32 v[136:137], v[136:137], s[38:39] op_sel_hi:[1,0]
    v_pk_mul_f32 v[138:139], v[138:139], s[38:39] op_sel_hi:[1,0]
    ds_read_b128 v[44:47], v177 offset:256
    s_waitcnt lgkmcnt(3)
    v_mfma_f32_32x32x16_bf16 v[144:159], v[48:51], v[88:91], v[144:159]
    v_pk_mul_f32 v[140:141], v[140:141], s[38:39] op_sel_hi:[1,0]
    v_pk_mul_f32 v[142:143], v[142:143], s[38:39] op_sel_hi:[1,0]
    v_cvt_pk_bf16_f32 v160, v128, v129
    ds_read_b128 v[48:51], v178 offset:256
    s_waitcnt lgkmcnt(3)
    v_mfma_f32_32x32x16_bf16 v[144:159], v[52:55], v[92:95], v[144:159]
    v_cvt_pk_bf16_f32 v161, v130, v131
    v_cvt_pk_bf16_f32 v162, v132, v133
    v_cvt_pk_bf16_f32 v163, v134, v135
    ds_read_b128 v[52:55], v179 offset:256
    s_waitcnt lgkmcnt(3)
    v_mfma_f32_32x32x16_bf16 v[144:159], v[40:43], v[96:99], v[144:159]
    v_cvt_pk_bf16_f32 v164, v136, v137
    v_cvt_pk_bf16_f32 v165, v138, v139
    v_cvt_pk_bf16_f32 v166, v140, v141
    ds_read_b128 v[40:43], v180 offset:256
    s_waitcnt lgkmcnt(3)
    v_mfma_f32_32x32x16_bf16 v[144:159], v[44:47], v[100:103], v[144:159]
    v_cvt_pk_bf16_f32 v167, v142, v143
    ds_write_b128 v56, v[160:163]
    ds_write_b128 v56, v[164:167] offset:16
    ds_read_b128 v[44:47], v181 offset:256
    s_waitcnt lgkmcnt(5)
    v_mfma_f32_32x32x16_bf16 v[144:159], v[48:51], v[104:107], v[144:159]
    v_mov_b32 v128, 0
    v_mov_b32 v129, 0
    v_mov_b32 v130, 0
    ds_read_b128 v[48:51], v182 offset:256
    s_waitcnt lgkmcnt(5)
    v_mfma_f32_32x32x16_bf16 v[144:159], v[52:55], v[108:111], v[144:159]
    v_mov_b32 v131, 0
    v_mov_b32 v132, 0
    v_mov_b32 v133, 0
    ds_read_b128 v[52:55], v183 offset:256
    s_waitcnt lgkmcnt(5)
    v_mfma_f32_32x32x16_bf16 v[144:159], v[40:43], v[112:115], v[144:159]
    v_mov_b32 v134, 0
    v_mov_b32 v135, 0
    v_mov_b32 v136, 0
    s_cmp_eq_u32 s27, 3
    s_cbranch_scc1 Lm_sw_35
    s_waitcnt vmcnt(12)
    s_branch Lm_sw_35_e
Lm_sw_35:
    s_waitcnt vmcnt(20)
Lm_sw_35_e:
    s_barrier
    ds_read_b128 v[40:43], v32 offset:0
    s_waitcnt lgkmcnt(3)
    v_mfma_f32_32x32x16_bf16 v[144:159], v[44:47], v[116:119], v[144:159]
    v_mov_b32 v137, 0
    v_mov_b32 v138, 0
    v_mov_b32 v139, 0
    ds_read_b128 v[44:47], v33 offset:0
    s_waitcnt lgkmcnt(3)
    v_mfma_f32_32x32x16_bf16 v[144:159], v[48:51], v[120:123], v[144:159]
    v_mov_b32 v140, 0
    v_mov_b32 v141, 0
    v_mov_b32 v142, 0
    ds_read_b128 v[48:51], v34 offset:0
    s_waitcnt lgkmcnt(3)
    v_mfma_f32_32x32x16_bf16 v[144:159], v[52:55], v[124:127], v[144:159]
    v_mov_b32 v143, 0
    ds_read_b128 v[168:171], v57
    ds_read_b128 v[172:175], v57 offset:1024
    ds_read_b128 v[52:55], v35 offset:0
    s_waitcnt lgkmcnt(5)
    v_mfma_f32_32x32x16_bf16 v[128:143], v[40:43], v[64:67], v[128:143]
    s_waitcnt lgkmcnt(1)
    s_add_u32 s40, s39, s54
    s_add_u32 s41, s40, 14336
    buffer_store_dwordx4 v[168:171], v58, s[16:19], s40 offen sc1
    buffer_store_dwordx4 v[172:175], v58, s[16:19], s41 offen sc1
    ds_read_b128 v[40:43], v36 offset:0
    s_waitcnt lgkmcnt(5)
    v_mfma_f32_32x32x16_bf16 v[128:143], v[44:47], v[68:71], v[128:143]
    v_add_u32 v176, 32768, v176
    v_add_u32 v177, 32768, v177
    v_add_u32 v178, 32768, v178
    ds_read_b128 v[44:47], v37 offset:0
    s_waitcnt lgkmcnt(5)
    v_mfma_f32_32x32x16_bf16 v[128:143], v[48:51], v[72:75], v[128:143]
    v_add_u32 v179, 32768, v179
    v_add_u32 v180, 32768, v180
    v_add_u32 v181, 32768, v181
    ds_read_b128 v[48:51], v38 offset:0
    s_waitcnt lgkmcnt(3)
    v_mfma_f32_32x32x16_bf16 v[128:143], v[52:55], v[76:79], v[128:143]
    v_add_u32 v182, 32768, v182
    v_add_u32 v183, 32768, v183
    ds_read_b128 v[52:55], v39 offset:0
    s_waitcnt lgkmcnt(3)
    v_mfma_f32_32x32x16_bf16 v[128:143], v[40:43], v[80:83], v[128:143]
    v_pk_mul_f32 v[144:145], v[144:145], s[38:39] op_sel_hi:[1,0]
    v_pk_mul_f32 v[146:147], v[146:147], s[38:39] op_sel_hi:[1,0]
    v_pk_mul_f32 v[148:149], v[148:149], s[38:39] op_sel_hi:[1,0]
    ds_read_b128 v[40:43], v32 offset:256
    s_waitcnt lgkmcnt(3)
    v_mfma_f32_32x32x16_bf16 v[128:143], v[44:47], v[84:87], v[128:143]
    v_pk_mul_f32 v[150:151], v[150:151], s[38:39] op_sel_hi:[1,0]
    v_pk_mul_f32 v[152:153], v[152:153], s[38:39] op_sel_hi:[1,0]
    v_pk_mul_f32 v[154:155], v[154:155], s[38:39] op_sel_hi:[1,0]
    ds_read_b128 v[44:47], v33 offset:256
    s_waitcnt lgkmcnt(3)
    v_mfma_f32_32x32x16_bf16 v[128:143], v[48:51], v[88:91], v[128:143]
    v_pk_mul_f32 v[156:157], v[156:157], s[38:39] op_sel_hi:[1,0]
    v_pk_mul_f32 v[158:159], v[158:159], s[38:39] op_sel_hi:[1,0]
    v_cvt_pk_bf16_f32 v160, v144, v145
    ds_read_b128 v[48:51], v34 offset:256
    s_waitcnt lgkmcnt(3)
    v_mfma_f32_32x32x16_bf16 v[128:143], v[52:55], v[92:95], v[128:143]
    v_cvt_pk_bf16_f32 v161, v146, v147
    v_cvt_pk_bf16_f32 v162, v148, v149
    v_cvt_pk_bf16_f32 v163, v150, v151
    ds_read_b128 v[52:55], v35 offset:256
    s_waitcnt lgkmcnt(3)
    v_mfma_f32_32x32x16_bf16 v[128:143], v[40:43], v[96:99], v[128:143]
    v_cvt_pk_bf16_f32 v164, v152, v153
    v_cvt_pk_bf16_f32 v165, v154, v155
    v_cvt_pk_bf16_f32 v166, v156, v157
    ds_read_b128 v[40:43], v36 offset:256
    s_waitcnt lgkmcnt(3)
    v_mfma_f32_32x32x16_bf16 v[128:143], v[44:47], v[100:103], v[128:143]
    v_cvt_pk_bf16_f32 v167, v158, v159
    ds_write_b128 v56, v[160:163]
    ds_write_b128 v56, v[164:167] offset:16
    ds_read_b128 v[44:47], v37 offset:256
    s_waitcnt lgkmcnt(5)
    v_mfma_f32_32x32x16_bf16 v[128:143], v[48:51], v[104:107], v[128:143]
    v_mov_b32 v144, 0
    v_mov_b32 v145, 0
    v_mov_b32 v146, 0
    ds_read_b128 v[48:51], v38 offset:256
    s_waitcnt lgkmcnt(5)
    v_mfma_f32_32x32x16_bf16 v[128:143], v[52:55], v[108:111], v[128:143]
    v_mov_b32 v147, 0
    v_mov_b32 v148, 0
    v_mov_b32 v149, 0
    ds_read_b128 v[52:55], v39 offset:256
    s_waitcnt lgkmcnt(5)
    v_mfma_f32_32x32x16_bf16 v[128:143], v[40:43], v[112:115], v[128:143]
    v_mov_b32 v150, 0
    v_mov_b32 v151, 0
    v_mov_b32 v152, 0
    s_cmp_eq_u32 s27, 3
    s_cbranch_scc1 Lm_sw_36
    s_waitcnt vmcnt(10)
    s_branch Lm_sw_36_e
Lm_sw_36:
    s_waitcnt vmcnt(14)
Lm_sw_36_e:
    s_barrier
    ds_read_b128 v[40:43], v176 offset:0
    s_waitcnt lgkmcnt(3)
    v_mfma_f32_32x32x16_bf16 v[128:143], v[44:47], v[116:119], v[128:143]
    v_mov_b32 v153, 0
    v_mov_b32 v154, 0
    v_mov_b32 v155, 0
    ds_read_b128 v[44:47], v177 offset:0
    s_waitcnt lgkmcnt(3)
    v_mfma_f32_32x32x16_bf16 v[128:143], v[48:51], v[120:123], v[128:143]
    v_mov_b32 v156, 0
    v_mov_b32 v157, 0
    v_mov_b32 v158, 0
    ds_read_b128 v[48:51], v178 offset:0
    s_waitcnt lgkmcnt(3)
    v_mfma_f32_32x32x16_bf16 v[128:143], v[52:55], v[124:127], v[128:143]
    v_mov_b32 v159, 0
    ds_read_b128 v[168:171], v57
    ds_read_b128 v[172:175], v57 offset:1024
    ds_read_b128 v[52:55], v179 offset:0
    s_waitcnt lgkmcnt(5)
    v_mfma_f32_32x32x16_bf16 v[144:159], v[40:43], v[64:67], v[144:159]
    s_waitcnt lgkmcnt(1)
    s_add_u32 s40, s39, s55
    s_add_u32 s41, s40, 14336
    buffer_store_dwordx4 v[168:171], v58, s[16:19], s40 offen sc1
    buffer_store_dwordx4 v[172:175], v58, s[16:19], s41 offen sc1
    ds_read_b128 v[40:43], v180 offset:0
    s_waitcnt lgkmcnt(5)
    v_mfma_f32_32x32x16_bf16 v[144:159], v[44:47], v[68:71], v[144:159]
    v_add_u32 v32, 32768, v32
    v_add_u32 v33, 32768, v33
    v_add_u32 v34, 32768, v34
    ds_read_b128 v[44:47], v181 offset:0
    s_waitcnt lgkmcnt(5)
    v_mfma_f32_32x32x16_bf16 v[144:159], v[48:51], v[72:75], v[144:159]
    v_add_u32 v35, 32768, v35
    v_add_u32 v36, 32768, v36
    v_add_u32 v37, 32768, v37
    ds_read_b128 v[48:51], v182 offset:0
    s_waitcnt lgkmcnt(3)
    v_mfma_f32_32x32x16_bf16 v[144:159], v[52:55], v[76:79], v[144:159]
    v_add_u32 v38, 32768, v38
    v_add_u32 v39, 32768, v39
    ds_read_b128 v[52:55], v183 offset:0
    s_waitcnt lgkmcnt(3)
    v_mfma_f32_32x32x16_bf16 v[144:159], v[40:43], v[80:83], v[144:159]
    v_pk_mul_f32 v[128:129], v[128:129], s[38:39] op_sel_hi:[1,0]
    v_pk_mul_f32 v[130:131], v[130:131], s[38:39] op_sel_hi:[1,0]
    v_pk_mul_f32 v[132:133], v[132:133], s[38:39] op_sel_hi:[1,0]
    ds_read_b128 v[40:43], v176 offset:256
    s_waitcnt lgkmcnt(3)
    v_mfma_f32_32x32x16_bf16 v[144:159], v[44:47], v[84:87], v[144:159]
    v_pk_mul_f32 v[134:135], v[134:135], s[38:39] op_sel_hi:[1,0]
    v_pk_mul_f32 v[136:137], v[136:137], s[38:39] op_sel_hi:[1,0]
    v_pk_mul_f32 v[138:139], v[138:139], s[38:39] op_sel_hi:[1,0]
    ds_read_b128 v[44:47], v177 offset:256
    s_waitcnt lgkmcnt(3)
    v_mfma_f32_32x32x16_bf16 v[144:159], v[48:51], v[88:91], v[144:159]
    v_pk_mul_f32 v[140:141], v[140:141], s[38:39] op_sel_hi:[1,0]
    v_pk_mul_f32 v[142:143], v[142:143], s[38:39] op_sel_hi:[1,0]
    v_cvt_pk_bf16_f32 v160, v128, v129
    ds_read_b128 v[48:51], v178 offset:256
    s_waitcnt lgkmcnt(3)
    v_mfma_f32_32x32x16_bf16 v[144:159], v[52:55], v[92:95], v[144:159]
    v_cvt_pk_bf16_f32 v161, v130, v131
    v_cvt_pk_bf16_f32 v162, v132, v133
    v_cvt_pk_bf16_f32 v163, v134, v135
    ds_read_b128 v[52:55], v179 offset:256
    s_waitcnt lgkmcnt(3)
    v_mfma_f32_32x32x16_bf16 v[144:159], v[40:43], v[96:99], v[144:159]
    v_cvt_pk_bf16_f32 v164, v136, v137
    v_cvt_pk_bf16_f32 v165, v138, v139
    v_cvt_pk_bf16_f32 v166, v140, v141
    ds_read_b128 v[40:43], v180 offset:256
    s_waitcnt lgkmcnt(3)
    v_mfma_f32_32x32x16_bf16 v[144:159], v[44:47], v[100:103], v[144:159]
    v_cvt_pk_bf16_f32 v167, v142, v143
    ds_write_b128 v56, v[160:163]
    ds_write_b128 v56, v[164:167] offset:16
    ds_read_b128 v[44:47], v181 offset:256
    s_waitcnt lgkmcnt(5)
    v_mfma_f32_32x32x16_bf16 v[144:159], v[48:51], v[104:107], v[144:159]
    v_mov_b32 v128, 0
    v_mov_b32 v129, 0
    v_mov_b32 v130, 0
    ds_read_b128 v[48:51], v182 offset:256
    s_waitcnt lgkmcnt(5)
    v_mfma_f32_32x32x16_bf16 v[144:159], v[52:55], v[108:111], v[144:159]
    v_mov_b32 v131, 0
    v_mov_b32 v132, 0
    v_mov_b32 v133, 0
    ds_read_b128 v[52:55], v183 offset:256
    s_waitcnt lgkmcnt(5)
    v_mfma_f32_32x32x16_bf16 v[144:159], v[40:43], v[112:115], v[144:159]
    v_mov_b32 v134, 0
    v_mov_b32 v135, 0
    v_mov_b32 v136, 0
    s_cmp_eq_u32 s27, 3
    s_cbranch_scc1 Lm_sw_37
    s_waitcnt vmcnt(8)
    s_branch Lm_sw_37_e
Lm_sw_37:
    s_waitcnt vmcnt(8)
Lm_sw_37_e:
    s_barrier
    ds_read_b128 v[40:43], v32 offset:0
    s_waitcnt lgkmcnt(3)
    v_mfma_f32_32x32x16_bf16 v[144:159], v[44:47], v[116:119], v[144:159]
    v_mov_b32 v137, 0
    v_mov_b32 v138, 0
    v_mov_b32 v139, 0
    ds_read_b128 v[44:47], v33 offset:0
    s_waitcnt lgkmcnt(3)
    v_mfma_f32_32x32x16_bf16 v[144:159], v[48:51], v[120:123], v[144:159]
    v_mov_b32 v140, 0
    v_mov_b32 v141, 0
    v_mov_b32 v142, 0
    ds_read_b128 v[48:51], v34 offset:0
    s_waitcnt lgkmcnt(3)
    v_mfma_f32_32x32x16_bf16 v[144:159], v[52:55], v[124:127], v[144:159]
    v_mov_b32 v143, 0
    ds_read_b128 v[168:171], v57
    ds_read_b128 v[172:175], v57 offset:1024
    ds_read_b128 v[52:55], v35 offset:0
    s_waitcnt lgkmcnt(5)
    v_mfma_f32_32x32x16_bf16 v[128:143], v[40:43], v[64:67], v[128:143]
    s_waitcnt lgkmcnt(1)
    s_add_u32 s40, s39, s56
    s_add_u32 s41, s40, 14336
    buffer_store_dwordx4 v[168:171], v58, s[16:19], s40 offen sc1
    buffer_store_dwordx4 v[172:175], v58, s[16:19], s41 offen sc1
    ds_read_b128 v[40:43], v36 offset:0
    s_waitcnt lgkmcnt(5)
    v_mfma_f32_32x32x16_bf16 v[128:143], v[44:47], v[68:71], v[128:143]
    ds_read_b128 v[44:47], v37 offset:0
    s_waitcnt lgkmcnt(5)
    v_mfma_f32_32x32x16_bf16 v[128:143], v[48:51], v[72:75], v[128:143]
    ds_read_b128 v[48:51], v38 offset:0
    s_waitcnt lgkmcnt(3)
    v_mfma_f32_32x32x16_bf16 v[128:143], v[52:55], v[76:79], v[128:143]
    ds_read_b128 v[52:55], v39 offset:0
    s_waitcnt lgkmcnt(3)
    v_mfma_f32_32x32x16_bf16 v[128:143], v[40:43], v[80:83], v[128:143]
    v_pk_mul_f32 v[144:145], v[144:145], s[38:39] op_sel_hi:[1,0]
    v_pk_mul_f32 v[146:147], v[146:147], s[38:39] op_sel_hi:[1,0]
    v_pk_mul_f32 v[148:149], v[148:149], s[38:39] op_sel_hi:[1,0]
    ds_read_b128 v[40:43], v32 offset:256
    s_waitcnt lgkmcnt(3)
    v_mfma_f32_32x32x16_bf16 v[128:143], v[44:47], v[84:87], v[128:143]
    v_pk_mul_f32 v[150:151], v[150:151], s[38:39] op_sel_hi:[1,0]
    v_pk_mul_f32 v[152:153], v[152:153], s[38:39] op_sel_hi:[1,0]
    v_pk_mul_f32 v[154:155], v[154:155], s[38:39] op_sel_hi:[1,0]
    ds_read_b128 v[44:47], v33 offset:256
    s_waitcnt lgkmcnt(3)
    v_mfma_f32_32x32x16_bf16 v[128:143], v[48:51], v[88:91], v[128:143]
    v_pk_mul_f32 v[156:157], v[156:157], s[38:39] op_sel_hi:[1,0]
    v_pk_mul_f32 v[158:159], v[158:159], s[38:39] op_sel_hi:[1,0]
    v_cvt_pk_bf16_f32 v160, v144, v145
    ds_read_b128 v[48:51], v34 offset:256
    s_waitcnt lgkmcnt(3)
    v_mfma_f32_32x32x16_bf16 v[128:143], v[52:55], v[92:95], v[128:143]
    v_cvt_pk_bf16_f32 v161, v146, v147
    v_cvt_pk_bf16_f32 v162, v148, v149
    v_cvt_pk_bf16_f32 v163, v150, v151
    ds_read_b128 v[52:55], v35 offset:256
    s_waitcnt lgkmcnt(3)
    v_mfma_f32_32x32x16_bf16 v[128:143], v[40:43], v[96:99], v[128:143]
    v_cvt_pk_bf16_f32 v164, v152, v153
    v_cvt_pk_bf16_f32 v165, v154, v155
    v_cvt_pk_bf16_f32 v166, v156, v157
    ds_read_b128 v[40:43], v36 offset:256
    s_waitcnt lgkmcnt(3)
    v_mfma_f32_32x32x16_bf16 v[128:143], v[44:47], v[100:103], v[128:143]
    v_cvt_pk_bf16_f32 v167, v158, v159
    ds_write_b128 v56, v[160:163]
    ds_write_b128 v56, v[164:167] offset:16
    ds_read_b128 v[44:47], v37 offset:256
    s_waitcnt lgkmcnt(5)
    v_mfma_f32_32x32x16_bf16 v[128:143], v[48:51], v[104:107], v[128:143]
    v_mov_b32 v144, 0
    v_mov_b32 v145, 0
    v_mov_b32 v146, 0
    ds_read_b128 v[48:51], v38 offset:256
    s_waitcnt lgkmcnt(5)
    v_mfma_f32_32x32x16_bf16 v[128:143], v[52:55], v[108:111], v[128:143]
    v_mov_b32 v147, 0
    v_mov_b32 v148, 0
    v_mov_b32 v149, 0
    ds_read_b128 v[52:55], v39 offset:256
    s_waitcnt lgkmcnt(5)
    v_mfma_f32_32x32x16_bf16 v[128:143], v[40:43], v[112:115], v[128:143]
    v_mov_b32 v150, 0
    v_mov_b32 v151, 0
    v_mov_b32 v152, 0
    s_waitcnt lgkmcnt(2)
    v_mfma_f32_32x32x16_bf16 v[128:143], v[44:47], v[116:119], v[128:143]
    v_mov_b32 v153, 0
    v_mov_b32 v154, 0
    v_mov_b32 v155, 0
    s_waitcnt lgkmcnt(1)
    v_mfma_f32_32x32x16_bf16 v[128:143], v[48:51], v[120:123], v[128:143]
    v_mov_b32 v156, 0
    v_mov_b32 v157, 0
    v_mov_b32 v158, 0
    s_waitcnt lgkmcnt(0)
    v_mfma_f32_32x32x16_bf16 v[128:143], v[52:55], v[124:127], v[128:143]
    v_mov_b32 v159, 0
    ds_read_b128 v[168:171], v57
    ds_read_b128 v[172:175], v57 offset:1024
    s_waitcnt lgkmcnt(0)
    s_add_u32 s40, s39, s57
    s_add_u32 s41, s40, 14336
    buffer_store_dwordx4 v[168:171], v58, s[16:19], s40 offen sc1
    buffer_store_dwordx4 v[172:175], v58, s[16:19], s41 offen sc1
    s_nop 15
    v_pk_mul_f32 v[128:129], v[128:129], s[38:39] op_sel_hi:[1,0]
    v_pk_mul_f32 v[130:131], v[130:131], s[38:39] op_sel_hi:[1,0]
    v_pk_mul_f32 v[132:133], v[132:133], s[38:39] op_sel_hi:[1,0]
    v_pk_mul_f32 v[134:135], v[134:135], s[38:39] op_sel_hi:[1,0]
    v_pk_mul_f32 v[136:137], v[136:137], s[38:39] op_sel_hi:[1,0]
    v_pk_mul_f32 v[138:139], v[138:139], s[38:39] op_sel_hi:[1,0]
    v_pk_mul_f32 v[140:141], v[140:141], s[38:39] op_sel_hi:[1,0]
    v_pk_mul_f32 v[142:143], v[142:143], s[38:39] op_sel_hi:[1,0]
    v_cvt_pk_bf16_f32 v160, v128, v129
    v_cvt_pk_bf16_f32 v161, v130, v131
    v_cvt_pk_bf16_f32 v162, v132, v133
    v_cvt_pk_bf16_f32 v163, v134, v135
    v_cvt_pk_bf16_f32 v164, v136, v137
    v_cvt_pk_bf16_f32 v165, v138, v139
    v_cvt_pk_bf16_f32 v166, v140, v141
    v_cvt_pk_bf16_f32 v167, v142, v143
    ds_write_b128 v56, v[160:163]
    ds_write_b128 v56, v[164:167] offset:16
    v_mov_b32 v128, 0
    v_mov_b32 v129, 0
    v_mov_b32 v130, 0
    v_mov_b32 v131, 0
    v_mov_b32 v132, 0
    v_mov_b32 v133, 0
    v_mov_b32 v134, 0
    v_mov_b32 v135, 0
    v_mov_b32 v136, 0
    v_mov_b32 v137, 0
    v_mov_b32 v138, 0
    v_mov_b32 v139, 0
    v_mov_b32 v140, 0
    v_mov_b32 v141, 0
    v_mov_b32 v142, 0
    v_mov_b32 v143, 0
    ds_read_b128 v[168:171], v57
    ds_read_b128 v[172:175], v57 offset:1024
    s_waitcnt lgkmcnt(0)
    s_add_u32 s40, s39, s58
    s_add_u32 s41, s40, 14336
    buffer_store_dwordx4 v[168:171], v58, s[16:19], s40 offen sc1
    buffer_store_dwordx4 v[172:175], v58, s[16:19], s41 offen sc1
    s_waitcnt vmcnt(0)
    v_mov_b32 v3, 155648
    v_mov_b32 v4, 1
    s_mov_b64 exec, 1
    ds_add_rtn_u32 v5, v3, v4
    s_waitcnt lgkmcnt(0)
    s_mov_b64 exec, -1
    v_readfirstlane_b32 s28, v5
    s_cmp_eq_u32 s27, 3
    s_cselect_b32 s29, 1, 3
    s_cmp_eq_u32 s28, s29
    s_cbranch_scc0 Lm_gw_38
    v_mov_b32 v8, 0
    s_mov_b32 s30, 0
Lm_gn_39:
    buffer_load_dwordx2 v[6:7], v8, s[48:51], 0 offen sc1
    s_waitcnt vmcnt(0)
    v_readfirstlane_b32 s40, v6
    v_readfirstlane_b32 s97, v7
    s_nop 3
    s_and_b32 s41, s40, s97
    s_and_b32 s41, s41, 0x80808080
    s_cmp_eq_u32 s41, 0x80808080
    s_cbranch_scc1 Lm_gn_39_ok
    s_sleep 1
    s_add_u32 s30, s30, 1
    s_cmp_lt_u32 s30, 400000
    s_cbranch_scc1 Lm_gn_39
Lm_gn_39_ok:
    s_lshr_b32 s40, s40, 3
    s_and_b32 s40, s40, 0x0f0f0f0f
    s_lshl_b32 s97, s97, 1
    s_and_b32 s97, s97, 0xf0f0f0f0
    s_or_b32 s97, s97, s40
    s_or_b32 s97, s97, 0x100
    s_and_b32 s97, s97, 0xfffffdff
    s_lshl_b32 s28, s20, 3
    s_add_u32 s28, s28, s21
    s_lshl_b32 s28, s28, 2
    s_add_u32 s28, s28, 100196352
    v_mov_b32 v4, s97
    v_mov_b32 v3, 0
    s_mov_b64 exec, 1
    buffer_store_dword v4, v3, s[16:19], s28 offen sc1
    s_mov_b64 exec, -1
Lm_gw_38:
    s_branch Lm_ln
Lm_idle:
    s_barrier
    s_barrier
    s_barrier
    s_barrier
    s_barrier
    s_barrier
    s_barrier
Lm_ln:
    s_cmp_eq_u32 s22, 3
    s_cbranch_scc0 Lm_fill
    v_mov_b32 v8, 0
    s_mov_b32 s30, 0
Lm_gn_40:
    buffer_load_dwordx2 v[6:7], v8, s[48:51], 0 offen sc1
    s_waitcnt vmcnt(0)
    v_readfirstlane_b32 s40, v6
    v_readfirstlane_b32 s97, v7
    s_nop 3
    s_and_b32 s41, s40, s97
    s_and_b32 s41, s41, 0x80808080
    s_cmp_eq_u32 s41, 0x80808080
    s_cbranch_scc1 Lm_gn_40_ok
    s_sleep 1
    s_add_u32 s30, s30, 1
    s_cmp_lt_u32 s30, 400000
    s_cbranch_scc1 Lm_gn_40
Lm_gn_40_ok:
    s_lshr_b32 s40, s40, 3
    s_and_b32 s40, s40, 0x0f0f0f0f
    s_lshl_b32 s97, s97, 1
    s_and_b32 s97, s97, 0xf0f0f0f0
    s_or_b32 s97, s97, s40
    s_or_b32 s97, s97, 0x100
    s_and_b32 s97, s97, 0xfffffdff
    s_mov_b32 s33, 100192256
    v_mov_b32 v9, v1
    v_min_u32 v9, 41, v9
    v_lshlrev_b32 v9, 3, v9
    s_mov_b32 s30, 0
Lm_wf_41:
    buffer_load_dwordx2 v[10:11], v9, s[16:19], s33 offen sc1
    s_waitcnt vmcnt(0)
    v_xor_b32 v10, s97, v10
    v_xor_b32 v11, s97, v11
    v_or_b32 v10, v10, v11
    v_cmp_ne_u32 vcc, 0, v10
    s_cbranch_vccz Lm_wf_41_ok
    s_sleep 2
    s_add_u32 s30, s30, 1
    s_cmp_lt_u32 s30, 400000
    s_cbranch_scc1 Lm_wf_41
Lm_wf_41_ok:
    v_and_b32 v3, 7, v1
    v_lshrrev_b32 v4, 3, v1
    s_and_b32 s28, s2, 3
    s_lshl_b32 s28, s28, 3
    v_add_u32 v5, s28, v3
    s_lshr_b32 s29, s2, 2
    s_mul_i32 s29, s29, 28672
    v_lshlrev_b32 v8, 5, v4
    s_mov_b32 s31, 16515072
    s_mov_b32 s32, 16516864
    buffer_load_dwordx4 v[128:131], v8, s[16:19], s31 offen offset:0 sc1
    buffer_load_dwordx4 v[132:135], v8, s[16:19], s31 offen offset:16 sc1
    buffer_load_dwordx4 v[192:195], v8, s[16:19], s32 offen offset:0 sc1
    buffer_load_dwordx4 v[196:199], v8, s[16:19], s32 offen offset:16 sc1
    buffer_load_dwordx4 v[136:139], v8, s[16:19], s31 offen offset:256 sc1
    buffer_load_dwordx4 v[140:143], v8, s[16:19], s31 offen offset:272 sc1
    buffer_load_dwordx4 v[200:203], v8, s[16:19], s32 offen offset:256 sc1
    buffer_load_dwordx4 v[204:207], v8, s[16:19], s32 offen offset:272 sc1
    buffer_load_dwordx4 v[144:147], v8, s[16:19], s31 offen offset:512 sc1
    buffer_load_dwordx4 v[148:151], v8, s[16:19], s31 offen offset:528 sc1
    buffer_load_dwordx4 v[208:211], v8, s[16:19], s32 offen offset:512 sc1
    buffer_load_dwordx4 v[212:215], v8, s[16:19], s32 offen offset:528 sc1
    buffer_load_dwordx4 v[152:155], v8, s[16:19], s31 offen offset:768 sc1
    buffer_load_dwordx4 v[156:159], v8, s[16:19], s31 offen offset:784 sc1
    buffer_load_dwordx4 v[216:219], v8, s[16:19], s32 offen offset:768 sc1
    buffer_load_dwordx4 v[220:223], v8, s[16:19], s32 offen offset:784 sc1
    buffer_load_dwordx4 v[160:163], v8, s[16:19], s31 offen offset:1024 sc1
    buffer_load_dwordx4 v[164:167], v8, s[16:19], s31 offen offset:1040 sc1
    buffer_load_dwordx4 v[224:227], v8, s[16:19], s32 offen offset:1024 sc1
    buffer_load_dwordx4 v[228:231], v8, s[16:19], s32 offen offset:1040 sc1
    buffer_load_dwordx4 v[168:171], v8, s[16:19], s31 offen offset:1280 sc1
    buffer_load_dwordx4 v[172:175], v8, s[16:19], s31 offen offset:1296 sc1
    buffer_load_dwordx4 v[232:235], v8, s[16:19], s32 offen offset:1280 sc1
    buffer_load_dwordx4 v[236:239], v8, s[16:19], s32 offen offset:1296 sc1
    buffer_load_dwordx4 v[176:179], v8, s[16:19], s31 offen offset:1536 sc1
    buffer_load_dwordx4 v[180:183], v8, s[16:19], s31 offen offset:1552 sc1
    buffer_load_dwordx4 v[240:243], v8, s[16:19], s32 offen offset:1536 sc1
    buffer_load_dwordx4 v[244:247], v8, s[16:19], s32 offen offset:1552 sc1
    v_accvgpr_read_b32 v32, a0
    v_accvgpr_read_b32 v33, a1
    v_accvgpr_read_b32 v34, a2
    v_accvgpr_read_b32 v35, a3
    v_accvgpr_read_b32 v36, a4
    v_accvgpr_read_b32 v37, a5
    v_accvgpr_read_b32 v38, a6
    v_accvgpr_read_b32 v39, a7
    v_accvgpr_read_b32 v40, a8
    v_accvgpr_read_b32 v41, a9
    v_accvgpr_read_b32 v42, a10
    v_accvgpr_read_b32 v43, a11
    v_accvgpr_read_b32 v44, a12
    v_accvgpr_read_b32 v45, a13
    v_accvgpr_read_b32 v46, a14
    v_accvgpr_read_b32 v47, a15
    v_accvgpr_read_b32 v48, a16
    v_accvgpr_read_b32 v49, a17
    v_accvgpr_read_b32 v50, a18
    v_accvgpr_read_b32 v51, a19
    v_accvgpr_read_b32 v52, a20
    v_accvgpr_read_b32 v53, a21
    v_accvgpr_read_b32 v54, a22
    v_accvgpr_read_b32 v55, a23
    v_accvgpr_read_b32 v56, a24
    v_accvgpr_read_b32 v57, a25
    v_accvgpr_read_b32 v58, a26
    v_accvgpr_read_b32 v59, a27
    v_lshlrev_b32 v64, 16, v32
    v_and_b32 v65, 0xffff0000, v32
    v_lshlrev_b32 v66, 16, v33
    v_and_b32 v67, 0xffff0000, v33
    v_lshlrev_b32 v68, 16, v34
    v_and_b32 v69, 0xffff0000, v34
    v_lshlrev_b32 v70, 16, v35
    v_and_b32 v71, 0xffff0000, v35
    v_lshlrev_b32 v72, 16, v36
    v_and_b32 v73, 0xffff0000, v36
    v_lshlrev_b32 v74, 16, v37
    v_and_b32 v75, 0xffff0000, v37
    v_lshlrev_b32 v76, 16, v38
    v_and_b32 v77, 0xffff0000, v38
    v_lshlrev_b32 v78, 16, v39
    v_and_b32 v79, 0xffff0000, v39
    v_lshlrev_b32 v80, 16, v40
    v_and_b32 v81, 0xffff0000, v40
    v_lshlrev_b32 v82, 16, v41
    v_and_b32 v83, 0xffff0000, v41
    v_lshlrev_b32 v84, 16, v42
    v_and_b32 v85, 0xffff0000, v42
    v_lshlrev_b32 v86, 16, v43
    v_and_b32 v87, 0xffff0000, v43
    v_lshlrev_b32 v88, 16, v44
    v_and_b32 v89, 0xffff0000, v44
    v_lshlrev_b32 v90, 16, v45
    v_and_b32 v91, 0xffff0000, v45
    v_lshlrev_b32 v92, 16, v46
    v_and_b32 v93, 0xffff0000, v46
    v_lshlrev_b32 v94, 16, v47
    v_and_b32 v95, 0xffff0000, v47
    v_lshlrev_b32 v96, 16, v48
    v_and_b32 v97, 0xffff0000, v48
    v_lshlrev_b32 v98, 16, v49
    v_and_b32 v99, 0xffff0000, v49
    v_lshlrev_b32 v100, 16, v50
    v_and_b32 v101, 0xffff0000, v50
    v_lshlrev_b32 v102, 16, v51
    v_and_b32 v103, 0xffff0000, v51
    v_lshlrev_b32 v104, 16, v52
    v_and_b32 v105, 0xffff0000, v52
    v_lshlrev_b32 v106, 16, v53
    v_and_b32 v107, 0xffff0000, v53
    v_lshlrev_b32 v108, 16, v54
    v_and_b32 v109, 0xffff0000, v54
    v_lshlrev_b32 v110, 16, v55
    v_and_b32 v111, 0xffff0000, v55
    v_lshlrev_b32 v112, 16, v56
    v_and_b32 v113, 0xffff0000, v56
    v_lshlrev_b32 v114, 16, v57
    v_and_b32 v115, 0xffff0000, v57
    v_lshlrev_b32 v116, 16, v58
    v_and_b32 v117, 0xffff0000, v58
    v_lshlrev_b32 v118, 16, v59
    v_and_b32 v119, 0xffff0000, v59
    v_add_f32 v10, v64, v65
    v_add_f32 v10, v10, v66
    v_add_f32 v10, v10, v67
    v_add_f32 v10, v10, v68
    v_add_f32 v10, v10, v69
    v_add_f32 v10, v10, v70
    v_add_f32 v10, v10, v71
    v_add_f32 v10, v10, v72
    v_add_f32 v10, v10, v73
    v_add_f32 v10, v10, v74
    v_add_f32 v10, v10, v75
    v_add_f32 v10, v10, v76
    v_add_f32 v10, v10, v77
    v_add_f32 v10, v10, v78
    v_add_f32 v10, v10, v79
    v_add_f32 v10, v10, v80
    v_add_f32 v10, v10, v81
    v_add_f32 v10, v10, v82
    v_add_f32 v10, v10, v83
    v_add_f32 v10, v10, v84
    v_add_f32 v10, v10, v85
    v_add_f32 v10, v10, v86
    v_add_f32 v10, v10, v87
    v_add_f32 v10, v10, v88
    v_add_f32 v10, v10, v89
    v_add_f32 v10, v10, v90
    v_add_f32 v10, v10, v91
    v_add_f32 v10, v10, v92
    v_add_f32 v10, v10, v93
    v_add_f32 v10, v10, v94
    v_add_f32 v10, v10, v95
    v_add_f32 v10, v10, v96
    v_add_f32 v10, v10, v97
    v_add_f32 v10, v10, v98
    v_add_f32 v10, v10, v99
    v_add_f32 v10, v10, v100
    v_add_f32 v10, v10, v101
    v_add_f32 v10, v10, v102
    v_add_f32 v10, v10, v103
    v_add_f32 v10, v10, v104
    v_add_f32 v10, v10, v105
    v_add_f32 v10, v10, v106
    v_add_f32 v10, v10, v107
    v_add_f32 v10, v10, v108
    v_add_f32 v10, v10, v109
    v_add_f32 v10, v10, v110
    v_add_f32 v10, v10, v111
    v_add_f32 v10, v10, v112
    v_add_f32 v10, v10, v113
    v_add_f32 v10, v10, v114
    v_add_f32 v10, v10, v115
    v_add_f32 v10, v10, v116
    v_add_f32 v10, v10, v117
    v_add_f32 v10, v10, v118
    v_add_f32 v10, v10, v119
    s_nop 1
    v_add_f32_dpp v10, v10, v10 row_ror:8 row_mask:0xf bank_mask:0xf
    v_mov_b32 v12, v10
    s_nop 1
    v_permlane16_swap_b32 v10, v12
    v_add_f32 v10, v10, v12
    v_mov_b32 v12, v10
    s_nop 1
    v_permlane32_swap_b32 v10, v12
    v_add_f32 v10, v10, v12
    v_mul_f32 v10, 0x3b124925, v10
    v_sub_f32 v64, v64, v10
    v_sub_f32 v65, v65, v10
    v_sub_f32 v66, v66, v10
    v_sub_f32 v67, v67, v10
    v_sub_f32 v68, v68, v10
    v_sub_f32 v69, v69, v10
    v_sub_f32 v70, v70, v10
    v_sub_f32 v71, v71, v10
    v_sub_f32 v72, v72, v10
    v_sub_f32 v73, v73, v10
    v_sub_f32 v74, v74, v10
    v_sub_f32 v75, v75, v10
    v_sub_f32 v76, v76, v10
    v_sub_f32 v77, v77, v10
    v_sub_f32 v78, v78, v10
    v_sub_f32 v79, v79, v10
    v_sub_f32 v80, v80, v10
    v_sub_f32 v81, v81, v10
    v_sub_f32 v82, v82, v10
    v_sub_f32 v83, v83, v10
    v_sub_f32 v84, v84, v10
    v_sub_f32 v85, v85, v10
    v_sub_f32 v86, v86, v10
    v_sub_f32 v87, v87, v10
    v_sub_f32 v88, v88, v10
    v_sub_f32 v89, v89, v10
    v_sub_f32 v90, v90, v10
    v_sub_f32 v91, v91, v10
    v_sub_f32 v92, v92, v10
    v_sub_f32 v93, v93, v10
    v_sub_f32 v94, v94, v10
    v_sub_f32 v95, v95, v10
    v_sub_f32 v96, v96, v10
    v_sub_f32 v97, v97, v10
    v_sub_f32 v98, v98, v10
    v_sub_f32 v99, v99, v10
    v_sub_f32 v100, v100, v10
    v_sub_f32 v101, v101, v10
    v_sub_f32 v102, v102, v10
    v_sub_f32 v103, v103, v10
    v_sub_f32 v104, v104, v10
    v_sub_f32 v105, v105, v10
    v_sub_f32 v106, v106, v10
    v_sub_f32 v107, v107, v10
    v_sub_f32 v108, v108, v10
    v_sub_f32 v109, v109, v10
    v_sub_f32 v110, v110, v10
    v_sub_f32 v111, v111, v10
    v_sub_f32 v112, v112, v10
    v_sub_f32 v113, v113, v10
    v_sub_f32 v114, v114, v10
    v_sub_f32 v115, v115, v10
    v_sub_f32 v116, v116, v10
    v_sub_f32 v117, v117, v10
    v_sub_f32 v118, v118, v10
    v_sub_f32 v119, v119, v10
    v_mul_f32 v11, v64, v64
    v_fmac_f32 v11, v65, v65
    v_fmac_f32 v11, v66, v66
    v_fmac_f32 v11, v67, v67
    v_fmac_f32 v11, v68, v68
    v_fmac_f32 v11, v69, v69
    v_fmac_f32 v11, v70, v70
    v_fmac_f32 v11, v71, v71
    v_fmac_f32 v11, v72, v72
    v_fmac_f32 v11, v73, v73
    v_fmac_f32 v11, v74, v74
    v_fmac_f32 v11, v75, v75
    v_fmac_f32 v11, v76, v76
    v_fmac_f32 v11, v77, v77
    v_fmac_f32 v11, v78, v78
    v_fmac_f32 v11, v79, v79
    v_fmac_f32 v11, v80, v80
    v_fmac_f32 v11, v81, v81
    v_fmac_f32 v11, v82, v82
    v_fmac_f32 v11, v83, v83
    v_fmac_f32 v11, v84, v84
    v_fmac_f32 v11, v85, v85
    v_fmac_f32 v11, v86, v86
    v_fmac_f32 v11, v87, v87
    v_fmac_f32 v11, v88, v88
    v_fmac_f32 v11, v89, v89
    v_fmac_f32 v11, v90, v90
    v_fmac_f32 v11, v91, v91
    v_fmac_f32 v11, v92, v92
    v_fmac_f32 v11, v93, v93
    v_fmac_f32 v11, v94, v94
    v_fmac_f32 v11, v95, v95
    v_fmac_f32 v11, v96, v96
    v_fmac_f32 v11, v97, v97
    v_fmac_f32 v11, v98, v98
    v_fmac_f32 v11, v99, v99
    v_fmac_f32 v11, v100, v100
    v_fmac_f32 v11, v101, v101
    v_fmac_f32 v11, v102, v102
    v_fmac_f32 v11, v103, v103
    v_fmac_f32 v11, v104, v104
    v_fmac_f32 v11, v105, v105
    v_fmac_f32 v11, v106, v106
    v_fmac_f32 v11, v107, v107
    v_fmac_f32 v11, v108, v108
    v_fmac_f32 v11, v109, v109
    v_fmac_f32 v11, v110, v110
    v_fmac_f32 v11, v111, v111
    v_fmac_f32 v11, v112, v112
    v_fmac_f32 v11, v113, v113
    v_fmac_f32 v11, v114, v114
    v_fmac_f32 v11, v115, v115
    v_fmac_f32 v11, v116, v116
    v_fmac_f32 v11, v117, v117
    v_fmac_f32 v11, v118, v118
    v_fmac_f32 v11, v119, v119
    s_nop 1
    v_add_f32_dpp v11, v11, v11 row_ror:8 row_mask:0xf bank_mask:0xf
    v_mov_b32 v12, v11
    s_nop 1
    v_permlane16_swap_b32 v11, v12
    v_add_f32 v11, v11, v12
    v_mov_b32 v12, v11
    s_nop 1
    v_permlane32_swap_b32 v11, v12
    v_add_f32 v11, v11, v12
    v_mov_b32 v12, 0x3727c5ac
    v_fmac_f32 v12, 0x3b124925, v11
    v_rsq_f32 v11, v12
    s_nop 0
    s_waitcnt vmcnt(0)
    v_mul_f32 v64, v64, v11
    v_add_f32 v192, 1.0, v192
    v_fma_f32 v64, v64, v192, v128
    v_mul_f32 v65, v65, v11
    v_add_f32 v193, 1.0, v193
    v_fma_f32 v65, v65, v193, v129
    v_mul_f32 v66, v66, v11
    v_add_f32 v194, 1.0, v194
    v_fma_f32 v66, v66, v194, v130
    v_mul_f32 v67, v67, v11
    v_add_f32 v195, 1.0, v195
    v_fma_f32 v67, v67, v195, v131
    v_mul_f32 v68, v68, v11
    v_add_f32 v196, 1.0, v196
    v_fma_f32 v68, v68, v196, v132
    v_mul_f32 v69, v69, v11
    v_add_f32 v197, 1.0, v197
    v_fma_f32 v69, v69, v197, v133
    v_mul_f32 v70, v70, v11
    v_add_f32 v198, 1.0, v198
    v_fma_f32 v70, v70, v198, v134
    v_mul_f32 v71, v71, v11
    v_add_f32 v199, 1.0, v199
    v_fma_f32 v71, v71, v199, v135
    v_mul_f32 v72, v72, v11
    v_add_f32 v200, 1.0, v200
    v_fma_f32 v72, v72, v200, v136
    v_mul_f32 v73, v73, v11
    v_add_f32 v201, 1.0, v201
    v_fma_f32 v73, v73, v201, v137
    v_mul_f32 v74, v74, v11
    v_add_f32 v202, 1.0, v202
    v_fma_f32 v74, v74, v202, v138
    v_mul_f32 v75, v75, v11
    v_add_f32 v203, 1.0, v203
    v_fma_f32 v75, v75, v203, v139
    v_mul_f32 v76, v76, v11
    v_add_f32 v204, 1.0, v204
    v_fma_f32 v76, v76, v204, v140
    v_mul_f32 v77, v77, v11
    v_add_f32 v205, 1.0, v205
    v_fma_f32 v77, v77, v205, v141
    v_mul_f32 v78, v78, v11
    v_add_f32 v206, 1.0, v206
    v_fma_f32 v78, v78, v206, v142
    v_mul_f32 v79, v79, v11
    v_add_f32 v207, 1.0, v207
    v_fma_f32 v79, v79, v207, v143
    v_mul_f32 v80, v80, v11
    v_add_f32 v208, 1.0, v208
    v_fma_f32 v80, v80, v208, v144
    v_mul_f32 v81, v81, v11
    v_add_f32 v209, 1.0, v209
    v_fma_f32 v81, v81, v209, v145
    v_mul_f32 v82, v82, v11
    v_add_f32 v210, 1.0, v210
    v_fma_f32 v82, v82, v210, v146
    v_mul_f32 v83, v83, v11
    v_add_f32 v211, 1.0, v211
    v_fma_f32 v83, v83, v211, v147
    v_mul_f32 v84, v84, v11
    v_add_f32 v212, 1.0, v212
    v_fma_f32 v84, v84, v212, v148
    v_mul_f32 v85, v85, v11
    v_add_f32 v213, 1.0, v213
    v_fma_f32 v85, v85, v213, v149
    v_mul_f32 v86, v86, v11
    v_add_f32 v214, 1.0, v214
    v_fma_f32 v86, v86, v214, v150
    v_mul_f32 v87, v87, v11
    v_add_f32 v215, 1.0, v215
    v_fma_f32 v87, v87, v215, v151
    v_mul_f32 v88, v88, v11
    v_add_f32 v216, 1.0, v216
    v_fma_f32 v88, v88, v216, v152
    v_mul_f32 v89, v89, v11
    v_add_f32 v217, 1.0, v217
    v_fma_f32 v89, v89, v217, v153
    v_mul_f32 v90, v90, v11
    v_add_f32 v218, 1.0, v218
    v_fma_f32 v90, v90, v218, v154
    v_mul_f32 v91, v91, v11
    v_add_f32 v219, 1.0, v219
    v_fma_f32 v91, v91, v219, v155
    v_mul_f32 v92, v92, v11
    v_add_f32 v220, 1.0, v220
    v_fma_f32 v92, v92, v220, v156
    v_mul_f32 v93, v93, v11
    v_add_f32 v221, 1.0, v221
    v_fma_f32 v93, v93, v221, v157
    v_mul_f32 v94, v94, v11
    v_add_f32 v222, 1.0, v222
    v_fma_f32 v94, v94, v222, v158
    v_mul_f32 v95, v95, v11
    v_add_f32 v223, 1.0, v223
    v_fma_f32 v95, v95, v223, v159
    v_mul_f32 v96, v96, v11
    v_add_f32 v224, 1.0, v224
    v_fma_f32 v96, v96, v224, v160
    v_mul_f32 v97, v97, v11
    v_add_f32 v225, 1.0, v225
    v_fma_f32 v97, v97, v225, v161
    v_mul_f32 v98, v98, v11
    v_add_f32 v226, 1.0, v226
    v_fma_f32 v98, v98, v226, v162
    v_mul_f32 v99, v99, v11
    v_add_f32 v227, 1.0, v227
    v_fma_f32 v99, v99, v227, v163
    v_mul_f32 v100, v100, v11
    v_add_f32 v228, 1.0, v228
    v_fma_f32 v100, v100, v228, v164
    v_mul_f32 v101, v101, v11
    v_add_f32 v229, 1.0, v229
    v_fma_f32 v101, v101, v229, v165
    v_mul_f32 v102, v102, v11
    v_add_f32 v230, 1.0, v230
    v_fma_f32 v102, v102, v230, v166
    v_mul_f32 v103, v103, v11
    v_add_f32 v231, 1.0, v231
    v_fma_f32 v103, v103, v231, v167
    v_mul_f32 v104, v104, v11
    v_add_f32 v232, 1.0, v232
    v_fma_f32 v104, v104, v232, v168
    v_mul_f32 v105, v105, v11
    v_add_f32 v233, 1.0, v233
    v_fma_f32 v105, v105, v233, v169
    v_mul_f32 v106, v106, v11
    v_add_f32 v234, 1.0, v234
    v_fma_f32 v106, v106, v234, v170
    v_mul_f32 v107, v107, v11
    v_add_f32 v235, 1.0, v235
    v_fma_f32 v107, v107, v235, v171
    v_mul_f32 v108, v108, v11
    v_add_f32 v236, 1.0, v236
    v_fma_f32 v108, v108, v236, v172
    v_mul_f32 v109, v109, v11
    v_add_f32 v237, 1.0, v237
    v_fma_f32 v109, v109, v237, v173
    v_mul_f32 v110, v110, v11
    v_add_f32 v238, 1.0, v238
    v_fma_f32 v110, v110, v238, v174
    v_mul_f32 v111, v111, v11
    v_add_f32 v239, 1.0, v239
    v_fma_f32 v111, v111, v239, v175
    v_mul_f32 v112, v112, v11
    v_add_f32 v240, 1.0, v240
    v_fma_f32 v112, v112, v240, v176
    v_mul_f32 v113, v113, v11
    v_add_f32 v241, 1.0, v241
    v_fma_f32 v113, v113, v241, v177
    v_mul_f32 v114, v114, v11
    v_add_f32 v242, 1.0, v242
    v_fma_f32 v114, v114, v242, v178
    v_mul_f32 v115, v115, v11
    v_add_f32 v243, 1.0, v243
    v_fma_f32 v115, v115, v243, v179
    v_mul_f32 v116, v116, v11
    v_add_f32 v244, 1.0, v244
    v_fma_f32 v116, v116, v244, v180
    v_mul_f32 v117, v117, v11
    v_add_f32 v245, 1.0, v245
    v_fma_f32 v117, v117, v245, v181
    v_mul_f32 v118, v118, v11
    v_add_f32 v246, 1.0, v246
    v_fma_f32 v118, v118, v246, v182
    v_mul_f32 v119, v119, v11
    v_add_f32 v247, 1.0, v247
    v_fma_f32 v119, v119, v247, v183
    v_cvt_pk_bf16_f32 v32, v64, v65
    v_cvt_pk_bf16_f32 v33, v66, v67
    v_cvt_pk_bf16_f32 v34, v68, v69
    v_cvt_pk_bf16_f32 v35, v70, v71
    v_cvt_pk_bf16_f32 v36, v72, v73
    v_cvt_pk_bf16_f32 v37, v74, v75
    v_cvt_pk_bf16_f32 v38, v76, v77
    v_cvt_pk_bf16_f32 v39, v78, v79
    v_cvt_pk_bf16_f32 v40, v80, v81
    v_cvt_pk_bf16_f32 v41, v82, v83
    v_cvt_pk_bf16_f32 v42, v84, v85
    v_cvt_pk_bf16_f32 v43, v86, v87
    v_cvt_pk_bf16_f32 v44, v88, v89
    v_cvt_pk_bf16_f32 v45, v90, v91
    v_cvt_pk_bf16_f32 v46, v92, v93
    v_cvt_pk_bf16_f32 v47, v94, v95
    v_cvt_pk_bf16_f32 v48, v96, v97
    v_cvt_pk_bf16_f32 v49, v98, v99
    v_cvt_pk_bf16_f32 v50, v100, v101
    v_cvt_pk_bf16_f32 v51, v102, v103
    v_cvt_pk_bf16_f32 v52, v104, v105
    v_cvt_pk_bf16_f32 v53, v106, v107
    v_cvt_pk_bf16_f32 v54, v108, v109
    v_cvt_pk_bf16_f32 v55, v110, v111
    v_cvt_pk_bf16_f32 v56, v112, v113
    v_cvt_pk_bf16_f32 v57, v114, v115
    v_cvt_pk_bf16_f32 v58, v116, v117
    v_cvt_pk_bf16_f32 v59, v118, v119
    v_lshlrev_b32 v14, 9, v4
    v_lshlrev_b32 v15, 4, v5
    v_add_u32 v14, v14, v15
    s_add_u32 s33, s29, 12845056
    buffer_store_dwordx4 v[32:35], v14, s[16:19], s33 offen sc1
    s_add_u32 s33, s33, 4096
    buffer_store_dwordx4 v[36:39], v14, s[16:19], s33 offen sc1
    s_add_u32 s33, s33, 4096
    buffer_store_dwordx4 v[40:43], v14, s[16:19], s33 offen sc1
    s_add_u32 s33, s33, 4096
    buffer_store_dwordx4 v[44:47], v14, s[16:19], s33 offen sc1
    s_add_u32 s33, s33, 4096
    buffer_store_dwordx4 v[48:51], v14, s[16:19], s33 offen sc1
    s_add_u32 s33, s33, 4096
    buffer_store_dwordx4 v[52:55], v14, s[16:19], s33 offen sc1
    s_add_u32 s33, s33, 4096
    buffer_store_dwordx4 v[56:59], v14, s[16:19], s33 offen sc1
    s_add_u32 s33, s33, 4096
    v_lshrrev_b32 v16, 2, v4
    v_lshlrev_b32 v16, 9, v16
    v_bfe_u32 v17, v4, 1, 1
    v_lshlrev_b32 v17, 11, v17
    v_add_u32 v16, v16, v17
    v_and_b32 v17, 1, v4
    v_lshlrev_b32 v18, 10, v17
    v_add_u32 v16, v16, v18
    v_add_u32 v16, v16, v15
    v_cmp_eq_u32 vcc, 1, v17
    s_add_u32 s33, s29, 14680064
    v_cndmask_b32 v64, v34, v32, vcc
    v_cndmask_b32 v65, v35, v33, vcc
    v_cndmask_b32 v66, v32, v34, vcc
    v_cndmask_b32 v67, v33, v35, vcc
    v_mov_b32_dpp v68, v64 row_ror:8 row_mask:0xf bank_mask:0xf
    v_mov_b32_dpp v69, v65 row_ror:8 row_mask:0xf bank_mask:0xf
    v_cndmask_b32 v32, v66, v68, vcc
    v_cndmask_b32 v33, v68, v66, vcc
    v_cndmask_b32 v34, v67, v69, vcc
    v_cndmask_b32 v35, v69, v67, vcc
    v_cndmask_b32 v72, v38, v36, vcc
    v_cndmask_b32 v73, v39, v37, vcc
    v_cndmask_b32 v74, v36, v38, vcc
    v_cndmask_b32 v75, v37, v39, vcc
    v_mov_b32_dpp v76, v72 row_ror:8 row_mask:0xf bank_mask:0xf
    v_mov_b32_dpp v77, v73 row_ror:8 row_mask:0xf bank_mask:0xf
    v_cndmask_b32 v36, v74, v76, vcc
    v_cndmask_b32 v37, v76, v74, vcc
    v_cndmask_b32 v38, v75, v77, vcc
    v_cndmask_b32 v39, v77, v75, vcc
    v_cndmask_b32 v80, v42, v40, vcc
    v_cndmask_b32 v81, v43, v41, vcc
    v_cndmask_b32 v82, v40, v42, vcc
    v_cndmask_b32 v83, v41, v43, vcc
    v_mov_b32_dpp v84, v80 row_ror:8 row_mask:0xf bank_mask:0xf
    v_mov_b32_dpp v85, v81 row_ror:8 row_mask:0xf bank_mask:0xf
    v_cndmask_b32 v40, v82, v84, vcc
    v_cndmask_b32 v41, v84, v82, vcc
    v_cndmask_b32 v42, v83, v85, vcc
    v_cndmask_b32 v43, v85, v83, vcc
    v_cndmask_b32 v88, v46, v44, vcc
    v_cndmask_b32 v89, v47, v45, vcc
    v_cndmask_b32 v90, v44, v46, vcc
    v_cndmask_b32 v91, v45, v47, vcc
    v_mov_b32_dpp v92, v88 row_ror:8 row_mask:0xf bank_mask:0xf
    v_mov_b32_dpp v93, v89 row_ror:8 row_mask:0xf bank_mask:0xf
    v_cndmask_b32 v44, v90, v92, vcc
    v_cndmask_b32 v45, v92, v90, vcc
    v_cndmask_b32 v46, v91, v93, vcc
    v_cndmask_b32 v47, v93, v91, vcc
    v_cndmask_b32 v96, v50, v48, vcc
    v_cndmask_b32 v97, v51, v49, vcc
    v_cndmask_b32 v98, v48, v50, vcc
    v_cndmask_b32 v99, v49, v51, vcc
    v_mov_b32_dpp v100, v96 row_ror:8 row_mask:0xf bank_mask:0xf
    v_mov_b32_dpp v101, v97 row_ror:8 row_mask:0xf bank_mask:0xf
    v_cndmask_b32 v48, v98, v100, vcc
    v_cndmask_b32 v49, v100, v98, vcc
    v_cndmask_b32 v50, v99, v101, vcc
    v_cndmask_b32 v51, v101, v99, vcc
    v_cndmask_b32 v104, v54, v52, vcc
    v_cndmask_b32 v105, v55, v53, vcc
    v_cndmask_b32 v106, v52, v54, vcc
    v_cndmask_b32 v107, v53, v55, vcc
    v_mov_b32_dpp v108, v104 row_ror:8 row_mask:0xf bank_mask:0xf
    v_mov_b32_dpp v109, v105 row_ror:8 row_mask:0xf bank_mask:0xf
    v_cndmask_b32 v52, v106, v108, vcc
    v_cndmask_b32 v53, v108, v106, vcc
    v_cndmask_b32 v54, v107, v109, vcc
    v_cndmask_b32 v55, v109, v107, vcc
    v_cndmask_b32 v112, v58, v56, vcc
    v_cndmask_b32 v113, v59, v57, vcc
    v_cndmask_b32 v114, v56, v58, vcc
    v_cndmask_b32 v115, v57, v59, vcc
    v_mov_b32_dpp v116, v112 row_ror:8 row_mask:0xf bank_mask:0xf
    v_mov_b32_dpp v117, v113 row_ror:8 row_mask:0xf bank_mask:0xf
    v_cndmask_b32 v56, v114, v116, vcc
    v_cndmask_b32 v57, v116, v114, vcc
    v_cndmask_b32 v58, v115, v117, vcc
    v_cndmask_b32 v59, v117, v115, vcc
    buffer_store_dwordx4 v[32:35], v16, s[16:19], s33 offen sc1
    s_add_u32 s33, s33, 4096
    buffer_store_dwordx4 v[36:39], v16, s[16:19], s33 offen sc1
    s_add_u32 s33, s33, 4096
    buffer_store_dwordx4 v[40:43], v16, s[16:19], s33 offen sc1
    s_add_u32 s33, s33, 4096
    buffer_store_dwordx4 v[44:47], v16, s[16:19], s33 offen sc1
    s_add_u32 s33, s33, 4096
    buffer_store_dwordx4 v[48:51], v16, s[16:19], s33 offen sc1
    s_add_u32 s33, s33, 4096
    buffer_store_dwordx4 v[52:55], v16, s[16:19], s33 offen sc1
    s_add_u32 s33, s33, 4096
    buffer_store_dwordx4 v[56:59], v16, s[16:19], s33 offen sc1
    s_add_u32 s33, s33, 4096
Lm_fill:
    v_lshlrev_b32 v12, 4, v0
    s_cmp_eq_u32 s22, 3
    s_cbranch_scc0 Lm_ls_42
    s_waitcnt vmcnt(0)
    s_lshl_b32 s28, s2, 2
    s_add_u32 s28, s28, 100198400
    v_mov_b32 v4, s97
    v_mov_b32 v3, 0
    s_mov_b64 exec, 1
    buffer_store_dword v4, v3, s[16:19], s28 offen sc1
    s_mov_b64 exec, -1
Lm_ls_42:
    s_waitcnt vmcnt(0)
    s_barrier
    s_load_dwordx2 s[16:17], s[0:1], 128
    s_load_dwordx2 s[18:19], s[0:1], 120
    v_lshrrev_b32 v2, 6, v0
    v_and_b32 v1, 63, v0
    s_waitcnt lgkmcnt(0)
    s_mov_b32 s4, s16
    s_and_b32 s5, s17, 0xffff
    s_mov_b32 s6, 268435456
    s_mov_b32 s7, 0x20000
    s_mov_b32 s8, s18
    s_and_b32 s9, s19, 0xffff
    s_mov_b32 s10, 256
    s_mov_b32 s11, 0x20000
    v_readfirstlane_b32 s12, v2
    s_mov_b32 s20, s98
    v_mov_b32 v10, 0
    s_mov_b32 s21, 0
Lm_gn_43:
    buffer_load_dwordx2 v[8:9], v10, s[8:11], 0 offen sc1
    s_waitcnt vmcnt(0)
    v_readfirstlane_b32 s24, v8
    v_readfirstlane_b32 s97, v9
    s_nop 3
    s_and_b32 s25, s24, s97
    s_and_b32 s25, s25, 0x80808080
    s_cmp_eq_u32 s25, 0x80808080
    s_cbranch_scc1 Lm_gn_43_ok
    s_sleep 1
    s_add_u32 s21, s21, 1
    s_cmp_lt_u32 s21, 400000
    s_cbranch_scc1 Lm_gn_43
Lm_gn_43_ok:
    s_lshr_b32 s24, s24, 3
    s_and_b32 s24, s24, 0x0f0f0f0f
    s_lshl_b32 s97, s97, 1
    s_and_b32 s97, s97, 0xf0f0f0f0
    s_or_b32 s97, s97, s24
    s_or_b32 s97, s97, 0x100
    s_and_b32 s97, s97, 0xfffffdff
    v_lshlrev_b32 v7, 2, v1
    s_mov_b32 s21, 0
Lm_dw:
    buffer_load_dword v9, v7, s[8:11], 0 offen sc1
    s_waitcnt vmcnt(0)
    v_and_b32 v10, 0x80808080, v9
    v_cmp_ne_u32 vcc, 0x80808080, v10
    s_cbranch_vccz Lm_dall
    s_sleep 1
    s_add_u32 s21, s21, 1
    s_cmp_lt_u32 s21, 400000
    s_cbranch_scc1 Lm_dw
Lm_dall:
    v_bfe_u32 v10, v9, 0, 3
    v_cmp_eq_u32 s[60:61], 0, v10
    v_bfe_u32 v10, v9, 8, 3
    v_cmp_eq_u32 s[62:63], 0, v10
    v_bfe_u32 v10, v9, 16, 3
    v_cmp_eq_u32 s[64:65], 0, v10
    v_bfe_u32 v10, v9, 24, 3
    v_cmp_eq_u32 s[66:67], 0, v10
    s_nop 3
    s_mov_b32 s24, 0
    s_mov_b32 s25, 0
    s_lshr_b32 s26, s2, 2
    s_and_b32 s27, s2, 3
    s_bfm_b64 s[70:71], s26, 0
    s_bcnt1_i32_b64 s28, s[60:61]
    s_add_u32 s24, s24, s28
    s_and_b64 s[72:73], s[60:61], s[70:71]
    s_bcnt1_i32_b64 s28, s[72:73]
    s_add_u32 s25, s25, s28
    s_lshr_b64 s[72:73], s[60:61], s26
    s_and_b32 s28, s72, 1
    s_cmp_gt_u32 s27, 0
    s_cselect_b32 s28, s28, 0
    s_add_u32 s25, s25, s28
    s_bcnt1_i32_b64 s28, s[62:63]
    s_add_u32 s24, s24, s28
    s_and_b64 s[72:73], s[62:63], s[70:71]
    s_bcnt1_i32_b64 s28, s[72:73]
    s_add_u32 s25, s25, s28
    s_lshr_b64 s[72:73], s[62:63], s26
    s_and_b32 s28, s72, 1
    s_cmp_gt_u32 s27, 1
    s_cselect_b32 s28, s28, 0
    s_add_u32 s25, s25, s28
    s_bcnt1_i32_b64 s28, s[64:65]
    s_add_u32 s24, s24, s28
    s_and_b64 s[72:73], s[64:65], s[70:71]
    s_bcnt1_i32_b64 s28, s[72:73]
    s_add_u32 s25, s25, s28
    s_lshr_b64 s[72:73], s[64:65], s26
    s_and_b32 s28, s72, 1
    s_cmp_gt_u32 s27, 2
    s_cselect_b32 s28, s28, 0
    s_add_u32 s25, s25, s28
    s_bcnt1_i32_b64 s28, s[66:67]
    s_add_u32 s24, s24, s28
    s_and_b64 s[72:73], s[66:67], s[70:71]
    s_bcnt1_i32_b64 s28, s[72:73]
    s_add_u32 s25, s25, s28
    s_lshr_b64 s[72:73], s[66:67], s26
    s_and_b32 s28, s72, 1
    s_cmp_gt_u32 s27, 3
    s_cselect_b32 s28, s28, 0
    s_add_u32 s25, s25, s28
    s_cmp_ge_u32 s24, 32
    s_cselect_b32 s28, 0, 1
    s_cmp_eq_u32 s28, 0
    s_cbranch_scc0 Lm_dslow
    s_cmp_eq_u32 s20, 0
    s_cselect_b32 s30, 1, 0
    s_cmp_lt_u32 s25, 32
    s_cselect_b32 s30, s30, 0
    s_min_u32 s31, s25, 32
    s_cmp_eq_u32 s30, 1
    s_cbranch_scc0 Lm_dw2
    s_mov_b32 s13, s25
    s_branch Lm_dfin
Lm_dw2:
    s_sub_u32 s29, s2, s31
    s_add_u32 s13, s29, 64
    s_branch Lm_dfin
Lm_dslow:
    s_cmp_lt_u32 s2, 32
    s_cbranch_scc0 Lm_ds2
    s_mov_b32 s13, s2
    s_branch Lm_dfin
Lm_ds2:
    s_add_u32 s13, s2, 32
Lm_dfin:
    s_mov_b32 s42, s28
    s_mov_b32 s22, 0
    s_cmp_ge_u32 s13, 64
    s_cbranch_scc1 Lm_worker
    s_cmp_lt_u32 s13, 16
    s_cbranch_scc0 Lm_tw_44
    s_lshl_b32 s99, s13, 5
    s_add_u32 s99, s99, 100196352
    v_mov_b32 v8, v1
    v_min_u32 v8, 7, v8
    v_lshlrev_b32 v8, 2, v8
    s_mov_b32 s21, 0
Lm_wf_45:
    buffer_load_dword v10, v8, s[4:7], s99 offen sc1
    s_waitcnt vmcnt(0)
    v_xor_b32 v10, s97, v10
    v_cmp_ne_u32 vcc, 0, v10
    s_cbranch_vccz Lm_wf_45_ok
    s_sleep 1
    s_add_u32 s21, s21, 1
    s_cmp_lt_u32 s21, 400000
    s_cbranch_scc1 Lm_wf_45
Lm_wf_45_ok:
    s_branch Lm_tw_44_e
Lm_tw_44:
    s_mov_b32 s99, 100196864
    v_mov_b32 v8, v1
    v_min_u32 v8, 63, v8
    v_lshlrev_b32 v8, 3, v8
    s_mov_b32 s21, 0
Lm_wf_46:
    buffer_load_dwordx2 v[10:11], v8, s[4:7], s99 offen sc1
    s_waitcnt vmcnt(0)
    v_xor_b32 v10, s97, v10
    v_xor_b32 v11, s97, v11
    v_or_b32 v10, v10, v11
    v_cmp_ne_u32 vcc, 0, v10
    s_cbranch_vccz Lm_wf_46_ok
    s_sleep 1
    s_add_u32 s21, s21, 1
    s_cmp_lt_u32 s21, 400000
    s_cbranch_scc1 Lm_wf_46
Lm_wf_46_ok:
Lm_tw_44_e:
    v_lshlrev_b32 v4, 4, v0
    v_add_u32 v5, 4096, v4
    v_mov_b32 v2, 536870912
    v_cmp_gt_u32 vcc, 192, v0
    s_nop 1
    v_cndmask_b32 v5, v2, v5, vcc
    v_lshlrev_b32 v6, 4, v1
    v_and_b32 v2, 8, v1
    v_cmp_eq_u32 vcc, 0, v2
    v_mov_b32 v3, 0xeeee
    v_mov_b32 v2, 0x4444
    s_nop 0
    v_cndmask_b32 v3, v3, v2, vcc
    s_cmp_ge_u32 s13, 30
    s_cbranch_scc1 Lm_pref
    s_cmp_eq_u32 s42, 0
    s_cbranch_scc0 Lm_slowteam
    s_cmp_ge_u32 s13, 16
    s_cbranch_scc1 Lm_value_f
    v_and_b32 v16, 15, v1
    v_lshrrev_b32 v17, 4, v1
    v_and_b32 v18, 12, v16
    v_and_b32 v19, 1, v16
    v_lshlrev_b32 v19, 1, v19
    v_bfe_u32 v20, v16, 1, 1
    v_or_b32 v18, v18, v19
    v_or_b32 v18, v18, v20
    v_mul_u32_u24 v21, 896, v18
    v_lshlrev_b32 v22, 5, v17
    v_add_u32 v21, v21, v22
    s_mul_i32 s32, s13, 401408
    s_mul_i32 s33, s12, 100352
    s_add_u32 s32, s32, s33
    s_add_u32 s32, s32, 0
    buffer_load_dwordx4 a[0:3], v21, s[4:7], s32 offen offset:0
    buffer_load_dwordx4 a[4:7], v21, s[4:7], s32 offen offset:16
    buffer_load_dwordx4 a[8:11], v21, s[4:7], s32 offen offset:128
    buffer_load_dwordx4 a[12:15], v21, s[4:7], s32 offen offset:144
    buffer_load_dwordx4 a[16:19], v21, s[4:7], s32 offen offset:256
    buffer_load_dwordx4 a[20:23], v21, s[4:7], s32 offen offset:272
    buffer_load_dwordx4 a[24:27], v21, s[4:7], s32 offen offset:384
    buffer_load_dwordx4 a[28:31], v21, s[4:7], s32 offen offset:400
    buffer_load_dwordx4 a[32:35], v21, s[4:7], s32 offen offset:512
    buffer_load_dwordx4 a[36:39], v21, s[4:7], s32 offen offset:528
    buffer_load_dwordx4 a[40:43], v21, s[4:7], s32 offen offset:640
    buffer_load_dwordx4 a[44:47], v21, s[4:7], s32 offen offset:656
    buffer_load_dwordx4 a[48:51], v21, s[4:7], s32 offen offset:768
    buffer_load_dwordx4 a[52:55], v21, s[4:7], s32 offen offset:784
    s_add_u32 s32, s32, 14336
    buffer_load_dwordx4 a[56:59], v21, s[4:7], s32 offen offset:0
    buffer_load_dwordx4 a[60:63], v21, s[4:7], s32 offen offset:16
    buffer_load_dwordx4 a[64:67], v21, s[4:7], s32 offen offset:128
    buffer_load_dwordx4 a[68:71], v21, s[4:7], s32 offen offset:144
    buffer_load_dwordx4 a[72:75], v21, s[4:7], s32 offen offset:256
    buffer_load_dwordx4 a[76:79], v21, s[4:7], s32 offen offset:272
    buffer_load_dwordx4 a[80:83], v21, s[4:7], s32 offen offset:384
    buffer_load_dwordx4 a[84:87], v21, s[4:7], s32 offen offset:400
    buffer_load_dwordx4 a[88:91], v21, s[4:7], s32 offen offset:512
    buffer_load_dwordx4 a[92:95], v21, s[4:7], s32 offen offset:528
    buffer_load_dwordx4 a[96:99], v21, s[4:7], s32 offen offset:640
    buffer_load_dwordx4 a[100:103], v21, s[4:7], s32 offen offset:656
    buffer_load_dwordx4 a[104:107], v21, s[4:7], s32 offen offset:768
    buffer_load_dwordx4 a[108:111], v21, s[4:7], s32 offen offset:784
    s_add_u32 s32, s32, 14336
    buffer_load_dwordx4 a[112:115], v21, s[4:7], s32 offen offset:0
    buffer_load_dwordx4 a[116:119], v21, s[4:7], s32 offen offset:16
    buffer_load_dwordx4 a[120:123], v21, s[4:7], s32 offen offset:128
    buffer_load_dwordx4 a[124:127], v21, s[4:7], s32 offen offset:144
    s_waitcnt vmcnt(24)
    buffer_load_dwordx4 a[128:131], v21, s[4:7], s32 offen offset:256
    buffer_load_dwordx4 a[132:135], v21, s[4:7], s32 offen offset:272
    buffer_load_dwordx4 a[136:139], v21, s[4:7], s32 offen offset:384
    buffer_load_dwordx4 a[140:143], v21, s[4:7], s32 offen offset:400
    buffer_load_dwordx4 a[144:147], v21, s[4:7], s32 offen offset:512
    buffer_load_dwordx4 a[148:151], v21, s[4:7], s32 offen offset:528
    buffer_load_dwordx4 a[152:155], v21, s[4:7], s32 offen offset:640
    buffer_load_dwordx4 a[156:159], v21, s[4:7], s32 offen offset:656
    buffer_load_dwordx4 a[160:163], v21, s[4:7], s32 offen offset:768
    buffer_load_dwordx4 a[164:167], v21, s[4:7], s32 offen offset:784
    s_add_u32 s32, s32, 14336
    buffer_load_dwordx4 a[168:171], v21, s[4:7], s32 offen offset:0
    buffer_load_dwordx4 a[172:175], v21, s[4:7], s32 offen offset:16
    buffer_load_dwordx4 a[176:179], v21, s[4:7], s32 offen offset:128
    buffer_load_dwordx4 a[180:183], v21, s[4:7], s32 offen offset:144
    buffer_load_dwordx4 a[184:187], v21, s[4:7], s32 offen offset:256
    buffer_load_dwordx4 a[188:191], v21, s[4:7], s32 offen offset:272
    buffer_load_dwordx4 a[192:195], v21, s[4:7], s32 offen offset:384
    buffer_load_dwordx4 a[196:199], v21, s[4:7], s32 offen offset:400
    buffer_load_dwordx4 a[200:203], v21, s[4:7], s32 offen offset:512
    buffer_load_dwordx4 a[204:207], v21, s[4:7], s32 offen offset:528
    buffer_load_dwordx4 a[208:211], v21, s[4:7], s32 offen offset:640
    buffer_load_dwordx4 a[212:215], v21, s[4:7], s32 offen offset:656
    buffer_load_dwordx4 a[216:219], v21, s[4:7], s32 offen offset:768
    buffer_load_dwordx4 a[220:223], v21, s[4:7], s32 offen offset:784
    s_add_u32 s32, s32, 14336
    buffer_load_dwordx4 a[224:227], v21, s[4:7], s32 offen offset:0
    buffer_load_dwordx4 a[228:231], v21, s[4:7], s32 offen offset:16
    buffer_load_dwordx4 a[232:235], v21, s[4:7], s32 offen offset:128
    buffer_load_dwordx4 a[236:239], v21, s[4:7], s32 offen offset:144
    buffer_load_dwordx4 a[240:243], v21, s[4:7], s32 offen offset:256
    buffer_load_dwordx4 a[244:247], v21, s[4:7], s32 offen offset:272
    buffer_load_dwordx4 a[248:251], v21, s[4:7], s32 offen offset:384
    buffer_load_dwordx4 a[252:255], v21, s[4:7], s32 offen offset:400
    s_waitcnt vmcnt(24)
    buffer_load_dwordx4 v[120:123], v21, s[4:7], s32 offen offset:512
    buffer_load_dwordx4 v[124:127], v21, s[4:7], s32 offen offset:528
    buffer_load_dwordx4 v[128:131], v21, s[4:7], s32 offen offset:640
    buffer_load_dwordx4 v[132:135], v21, s[4:7], s32 offen offset:656
    buffer_load_dwordx4 v[136:139], v21, s[4:7], s32 offen offset:768
    buffer_load_dwordx4 v[140:143], v21, s[4:7], s32 offen offset:784
    s_add_u32 s32, s32, 14336
    buffer_load_dwordx4 v[144:147], v21, s[4:7], s32 offen offset:0
    buffer_load_dwordx4 v[148:151], v21, s[4:7], s32 offen offset:16
    buffer_load_dwordx4 v[152:155], v21, s[4:7], s32 offen offset:128
    buffer_load_dwordx4 v[156:159], v21, s[4:7], s32 offen offset:144
    buffer_load_dwordx4 v[160:163], v21, s[4:7], s32 offen offset:256
    buffer_load_dwordx4 v[164:167], v21, s[4:7], s32 offen offset:272
    buffer_load_dwordx4 v[168:171], v21, s[4:7], s32 offen offset:384
    buffer_load_dwordx4 v[172:175], v21, s[4:7], s32 offen offset:400
    buffer_load_dwordx4 v[176:179], v21, s[4:7], s32 offen offset:512
    buffer_load_dwordx4 v[180:183], v21, s[4:7], s32 offen offset:528
    buffer_load_dwordx4 v[184:187], v21, s[4:7], s32 offen offset:640
    buffer_load_dwordx4 v[188:191], v21, s[4:7], s32 offen offset:656
    buffer_load_dwordx4 v[192:195], v21, s[4:7], s32 offen offset:768
    buffer_load_dwordx4 v[196:199], v21, s[4:7], s32 offen offset:784
    s_add_u32 s32, s32, 14336
    buffer_load_dwordx4 v[200:203], v21, s[4:7], s32 offen offset:0
    buffer_load_dwordx4 v[204:207], v21, s[4:7], s32 offen offset:16
    buffer_load_dwordx4 v[208:211], v21, s[4:7], s32 offen offset:128
    buffer_load_dwordx4 v[212:215], v21, s[4:7], s32 offen offset:144
    buffer_load_dwordx4 v[216:219], v21, s[4:7], s32 offen offset:256
    buffer_load_dwordx4 v[220:223], v21, s[4:7], s32 offen offset:272
    buffer_load_dwordx4 v[224:227], v21, s[4:7], s32 offen offset:384
    buffer_load_dwordx4 v[228:231], v21, s[4:7], s32 offen offset:400
    buffer_load_dwordx4 v[232:235], v21, s[4:7], s32 offen offset:512
    buffer_load_dwordx4 v[236:239], v21, s[4:7], s32 offen offset:528
    buffer_load_dwordx4 v[240:243], v21, s[4:7], s32 offen offset:640
    buffer_load_dwordx4 v[244:247], v21, s[4:7], s32 offen offset:656
    s_waitcnt vmcnt(24)
    buffer_load_dwordx4 v[248:251], v21, s[4:7], s32 offen offset:768
    buffer_load_dwordx4 v[252:255], v21, s[4:7], s32 offen offset:784
    s_add_u32 s32, s32, 14336
    v_lshlrev_b32 v7, 4, v16
    v_and_b32 v22, 1, v17
    v_lshlrev_b32 v22, 3, v22
    v_add_u32 v7, v7, v22
    s_mul_i32 s33, s12, 1792
    s_add_u32 s33, s33, 8192
    v_add_u32 v8, s33, v7
    v_lshrrev_b32 v22, 5, v1
    v_lshlrev_b32 v22, 8, v22
    v_add_u32 v7, v8, v22
    v_lshlrev_b32 v9, 8, v17
    v_lshlrev_b32 v22, 3, v16
    v_add_u32 v9, v9, v22
    v_add_u32 v9, 8192, v9
    v_lshlrev_b32 v10, 9, v17
    v_lshlrev_b32 v22, 4, v16
    v_add_u32 v10, v10, v22
    s_lshl_b32 s33, s12, 8
    s_add_u32 s33, s33, 20480
    v_add_u32 v10, s33, v10
    v_lshlrev_b32 v23, 7, v17
    v_and_b32 v22, 7, v16
    v_lshlrev_b32 v22, 4, v22
    v_add_u32 v23, v23, v22
    s_cmp_eq_u32 s12, 2
    s_cselect_b64 vcc, -1, 0
    s_nop 1
    v_cndmask_b32 v10, v10, v23, vcc
    v_and_b32 v22, 1, v17
    v_lshlrev_b32 v22, 2, v22
    v_lshrrev_b32 v23, 5, v1
    v_add_u32 v22, v22, v23
    v_mul_u32_u24 v11, 192, v22
    v_lshlrev_b32 v22, 2, v16
    v_add_u32 v11, v11, v22
    s_lshl_b32 s33, s12, 6
    s_add_u32 s33, s33, 15360
    v_add_u32 v11, s33, v11
    v_and_b32 v22, 7, v1
    v_lshrrev_b32 v23, 3, v1
    v_mul_u32_u24 v12, 192, v23
    v_add_u32 v12, 15360, v12
    v_lshlrev_b32 v24, 2, v22
    v_add_u32 v13, v12, v24
    v_add_u32 v13, 128, v13
    v_lshlrev_b32 v24, 4, v22
    v_add_u32 v12, v12, v24
    v_lshrrev_b32 v24, 1, v22
    v_lshlrev_b32 v24, 3, v24
    v_add_u32 v24, v24, v23
    v_lshlrev_b32 v14, 4, v24
    v_and_b32 v24, 1, v22
    v_lshlrev_b32 v24, 3, v24
    v_add_u32 v14, v14, v24
    v_lshlrev_b32 v15, 4, v23
    v_lshlrev_b32 v24, 1, v22
    v_add_u32 v15, v15, v24
    s_mov_b32 s14, 0
    s_mov_b32 s15, 16527360
    s_lshl_b32 s26, s13, 9
    s_add_u32 s26, s26, 16994304
    s_lshl_b32 s27, s13, 7
    s_add_u32 s27, s27, 17518592
    s_mov_b32 s28, 12845056
    s_waitcnt vmcnt(0)
    s_mov_b32 s99, 100196352
    v_lshrrev_b32 v80, 4, v6
    v_min_u32 v80, 63, v80
    v_lshlrev_b32 v80, 4, v80
    s_mov_b32 s21, 0
Lm_wf_47:
    buffer_load_dwordx4 v[84:87], v80, s[4:7], s99 offen sc1
    s_waitcnt vmcnt(0)
    v_xor_b32 v84, s97, v84
    v_xor_b32 v85, s97, v85
    v_xor_b32 v86, s97, v86
    v_xor_b32 v87, s97, v87
    v_or_b32 v84, v84, v85
    v_or_b32 v84, v84, v86
    v_or_b32 v84, v84, v87
    v_cmp_ne_u32 vcc, 0, v84
    s_cbranch_vccz Lm_wf_47_ok
    s_sleep 1
    s_add_u32 s21, s21, 1
    s_cmp_lt_u32 s21, 400000
    s_cbranch_scc1 Lm_wf_47
Lm_wf_47_ok:
    s_mov_b32 s99, 100198400
    v_lshrrev_b32 v80, 4, v6
    v_min_u32 v80, 63, v80
    v_lshlrev_b32 v80, 4, v80
    s_mov_b32 s21, 0
Lm_wf_48:
    buffer_load_dwordx4 v[84:87], v80, s[4:7], s99 offen sc1
    s_waitcnt vmcnt(0)
    v_xor_b32 v84, s97, v84
    v_xor_b32 v85, s97, v85
    v_xor_b32 v86, s97, v86
    v_xor_b32 v87, s97, v87
    v_or_b32 v84, v84, v85
    v_or_b32 v84, v84, v86
    v_or_b32 v84, v84, v87
    v_cmp_ne_u32 vcc, 0, v84
    s_cbranch_vccz Lm_wf_48_ok
    s_sleep 1
    s_add_u32 s21, s21, 1
    s_cmp_lt_u32 s21, 400000
    s_cbranch_scc1 Lm_wf_48
Lm_wf_48_ok:
    s_mul_i32 s32, s12, 7168
    s_add_u32 s33, s32, s28
    s_add_u32 s32, s32, 20480
    s_mov_b32 m0, s32
    s_nop 0
    buffer_load_dwordx4 v6, s[4:7], s33 offen offset:0 lds
    buffer_load_dwordx4 v6, s[4:7], s33 offen offset:1024 lds
    buffer_load_dwordx4 v6, s[4:7], s33 offen offset:2048 lds
    buffer_load_dwordx4 v6, s[4:7], s33 offen offset:3072 lds
    s_add_u32 s32, s32, 4096
    s_add_u32 s33, s33, 4096
    s_mov_b32 m0, s32
    s_nop 0
    buffer_load_dwordx4 v6, s[4:7], s33 offen offset:0 lds
    buffer_load_dwordx4 v6, s[4:7], s33 offen offset:1024 lds
    buffer_load_dwordx4 v6, s[4:7], s33 offen offset:2048 lds
    s_waitcnt vmcnt(0)
Lm_sstep_f:
    v_mov_b32 v44, 0
    v_mov_b32 v45, 0
    v_mov_b32 v46, 0
    v_mov_b32 v47, 0
    v_mov_b32 v48, 0
    v_mov_b32 v49, 0
    v_mov_b32 v50, 0
    v_mov_b32 v51, 0
    v_mov_b32 v52, 0
    v_mov_b32 v53, 0
    v_mov_b32 v54, 0
    v_mov_b32 v55, 0
    v_mov_b32 v56, 0
    v_mov_b32 v57, 0
    v_mov_b32 v58, 0
    v_mov_b32 v59, 0
    v_mov_b32 v60, 0
    v_mov_b32 v61, 0
    v_mov_b32 v62, 0
    v_mov_b32 v63, 0
    v_mov_b32 v64, 0
    v_mov_b32 v65, 0
    v_mov_b32 v66, 0
    v_mov_b32 v67, 0
    v_mov_b32 v68, 0
    v_mov_b32 v69, 0
    v_mov_b32 v70, 0
    v_mov_b32 v71, 0
    s_sleep 14
    s_mov_b32 s21, 0
    buffer_load_dwordx4 v[72:75], v4, s[4:7], s15 offen sc1
    buffer_load_dwordx4 v[76:79], v5, s[4:7], s15 offen sc1
    s_sleep 2
    buffer_load_dwordx4 v[84:87], v4, s[4:7], s15 offen sc1
    buffer_load_dwordx4 v[88:91], v5, s[4:7], s15 offen sc1
Lm_p2_49:
    s_waitcnt vmcnt(2)
    v_max3_u32 v80, v72, v73, v74
    v_max3_u32 v81, v75, v76, v77
    v_max3_u32 v80, v80, v78, v79
    v_max_u32 v80, v80, v81
    v_cmp_eq_u32 vcc, -1, v80
    s_cbranch_vccz Lm_p2_49_ok0
    buffer_load_dwordx4 v[72:75], v4, s[4:7], s15 offen sc1
    buffer_load_dwordx4 v[76:79], v5, s[4:7], s15 offen sc1
    s_waitcnt vmcnt(2)
    v_max3_u32 v80, v84, v85, v86
    v_max3_u32 v81, v87, v88, v89
    v_max3_u32 v80, v80, v90, v91
    v_max_u32 v80, v80, v81
    v_cmp_eq_u32 vcc, -1, v80
    s_cbranch_vccz Lm_p2_49_ok1
    buffer_load_dwordx4 v[84:87], v4, s[4:7], s15 offen sc1
    buffer_load_dwordx4 v[88:91], v5, s[4:7], s15 offen sc1
    s_add_u32 s21, s21, 1
    s_cmp_lt_u32 s21, 400000
    s_cbranch_scc1 Lm_p2_49
    s_mov_b32 s22, 1
Lm_p2_49_ok0:
    ds_write_b128 v4, v[72:75] offset:0
    ds_write_b128 v4, v[76:79] offset:4096
    s_branch Lm_p2_49_done
Lm_p2_49_ok1:
    ds_write_b128 v4, v[84:87] offset:0
    ds_write_b128 v4, v[88:91] offset:4096
Lm_p2_49_done:
    s_waitcnt lgkmcnt(0)
    s_barrier
    ds_read_b128 v[16:19], v6 offset:0
    ds_read_b128 v[20:23], v6 offset:1024
    ds_read_b128 v[24:27], v6 offset:2048
    ds_read_b128 v[28:31], v6 offset:3072
    ds_read_b128 v[32:35], v6 offset:4096
    ds_read_b128 v[36:39], v6 offset:5120
    ds_read_b128 v[40:43], v6 offset:6144
    s_cmp_eq_u32 s12, 2
    s_cbranch_scc1 Lm_t2_50
    s_waitcnt lgkmcnt(6)
    v_smfmac_f32_16x16x64_bf16 v[44:47], v[16:19], a[0:7], v3
    s_waitcnt lgkmcnt(5)
    v_smfmac_f32_16x16x64_bf16 v[44:47], v[20:23], a[8:15], v3
    s_waitcnt lgkmcnt(4)
    v_smfmac_f32_16x16x64_bf16 v[44:47], v[24:27], a[16:23], v3
    s_waitcnt lgkmcnt(3)
    v_smfmac_f32_16x16x64_bf16 v[44:47], v[28:31], a[24:31], v3
    s_waitcnt lgkmcnt(2)
    v_smfmac_f32_16x16x64_bf16 v[44:47], v[32:35], a[32:39], v3
    s_waitcnt lgkmcnt(1)
    v_smfmac_f32_16x16x64_bf16 v[44:47], v[36:39], a[40:47], v3
    s_waitcnt lgkmcnt(0)
    v_smfmac_f32_16x16x64_bf16 v[44:47], v[40:43], a[48:55], v3
    v_smfmac_f32_16x16x64_bf16 v[48:51], v[16:19], a[56:63], v3
    s_waitcnt vmcnt(0)
    v_smfmac_f32_16x16x64_bf16 v[48:51], v[20:23], a[64:71], v3
    ds_read_b128 v[72:75], v10 offset:0
    ds_read_b128 v[76:79], v10 offset:2048
    v_smfmac_f32_16x16x64_bf16 v[48:51], v[24:27], a[72:79], v3
    v_smfmac_f32_16x16x64_bf16 v[48:51], v[28:31], a[80:87], v3
    ds_read_b128 v[80:83], v10 offset:4096
    ds_read_b128 v[84:87], v10 offset:6144
    v_smfmac_f32_16x16x64_bf16 v[48:51], v[32:35], a[88:95], v3
    v_smfmac_f32_16x16x64_bf16 v[48:51], v[36:39], a[96:103], v3
    ds_read_b128 v[88:91], v10 offset:8192
    ds_read_b128 v[92:95], v10 offset:10240
    v_smfmac_f32_16x16x64_bf16 v[48:51], v[40:43], a[104:111], v3
    v_smfmac_f32_16x16x64_bf16 v[52:55], v[16:19], a[112:119], v3
    ds_read_b128 v[96:99], v10 offset:12288
    ds_read_b128 v[100:103], v10 offset:14336
    v_smfmac_f32_16x16x64_bf16 v[52:55], v[20:23], a[120:127], v3
    v_smfmac_f32_16x16x64_bf16 v[52:55], v[24:27], a[128:135], v3
    ds_read_b128 v[104:107], v10 offset:16384
    ds_read_b128 v[108:111], v10 offset:18432
    v_smfmac_f32_16x16x64_bf16 v[52:55], v[28:31], a[136:143], v3
    v_smfmac_f32_16x16x64_bf16 v[52:55], v[32:35], a[144:151], v3
    ds_read_b128 v[112:115], v10 offset:20480
    ds_read_b128 v[116:119], v10 offset:22528
    v_smfmac_f32_16x16x64_bf16 v[52:55], v[36:39], a[152:159], v3
    v_smfmac_f32_16x16x64_bf16 v[52:55], v[40:43], a[160:167], v3
    v_smfmac_f32_16x16x64_bf16 v[56:59], v[16:19], a[168:175], v3
    v_smfmac_f32_16x16x64_bf16 v[56:59], v[20:23], a[176:183], v3
    v_permlane32_swap_b32 v44, v48
    v_permlane32_swap_b32 v45, v49
    v_permlane32_swap_b32 v46, v50
    v_smfmac_f32_16x16x64_bf16 v[56:59], v[24:27], a[184:191], v3
    v_permlane32_swap_b32 v47, v51
    v_add_f32 v44, v44, v48
    v_add_f32 v45, v45, v49
    v_smfmac_f32_16x16x64_bf16 v[56:59], v[28:31], a[192:199], v3
    v_add_f32 v46, v46, v50
    v_add_f32 v47, v47, v51
    v_cvt_pk_bf16_f32 v48, v44, v45
    v_smfmac_f32_16x16x64_bf16 v[56:59], v[32:35], a[200:207], v3
    v_cvt_pk_bf16_f32 v49, v46, v47
    ds_write_b64 v7, v[48:49] offset:0
    v_smfmac_f32_16x16x64_bf16 v[56:59], v[36:39], a[208:215], v3
    v_smfmac_f32_16x16x64_bf16 v[56:59], v[40:43], a[216:223], v3
    v_smfmac_f32_16x16x64_bf16 v[60:63], v[16:19], a[224:231], v3
    v_smfmac_f32_16x16x64_bf16 v[60:63], v[20:23], a[232:239], v3
    v_smfmac_f32_16x16x64_bf16 v[60:63], v[24:27], a[240:247], v3
    v_smfmac_f32_16x16x64_bf16 v[60:63], v[28:31], a[248:255], v3
    v_smfmac_f32_16x16x64_bf16 v[60:63], v[32:35], v[120:127], v3
    v_smfmac_f32_16x16x64_bf16 v[60:63], v[36:39], v[128:135], v3
    v_smfmac_f32_16x16x64_bf16 v[60:63], v[40:43], v[136:143], v3
    v_smfmac_f32_16x16x64_bf16 v[64:67], v[16:19], v[144:151], v3
    v_smfmac_f32_16x16x64_bf16 v[68:71], v[16:19], v[200:207], v3
    v_permlane32_swap_b32 v52, v56
    v_permlane32_swap_b32 v53, v57
    v_permlane32_swap_b32 v54, v58
    v_smfmac_f32_16x16x64_bf16 v[64:67], v[20:23], v[152:159], v3
    v_permlane32_swap_b32 v55, v59
    v_add_f32 v52, v52, v56
    v_add_f32 v53, v53, v57
    v_smfmac_f32_16x16x64_bf16 v[68:71], v[20:23], v[208:215], v3
    v_add_f32 v54, v54, v58
    v_add_f32 v55, v55, v59
    v_cvt_pk_bf16_f32 v56, v52, v53
    v_smfmac_f32_16x16x64_bf16 v[64:67], v[24:27], v[160:167], v3
    v_cvt_pk_bf16_f32 v57, v54, v55
    ds_write_b64 v7, v[56:57] offset:512
    v_smfmac_f32_16x16x64_bf16 v[68:71], v[24:27], v[216:223], v3
    v_smfmac_f32_16x16x64_bf16 v[64:67], v[28:31], v[168:175], v3
    v_smfmac_f32_16x16x64_bf16 v[68:71], v[28:31], v[224:231], v3
    v_smfmac_f32_16x16x64_bf16 v[64:67], v[32:35], v[176:183], v3
    v_mov_b32 v44, v60
    v_mov_b32 v45, v61
    v_mov_b32 v46, v62
    v_smfmac_f32_16x16x64_bf16 v[68:71], v[32:35], v[232:239], v3
    v_mov_b32 v47, v63
    s_nop 0
    v_permlane32_swap_b32 v60, v44
    v_smfmac_f32_16x16x64_bf16 v[64:67], v[36:39], v[184:191], v3
    v_permlane32_swap_b32 v61, v45
    v_permlane32_swap_b32 v62, v46
    v_permlane32_swap_b32 v63, v47
    v_smfmac_f32_16x16x64_bf16 v[68:71], v[36:39], v[240:247], v3
    v_add_f32 v60, v60, v44
    v_add_f32 v61, v61, v45
    v_add_f32 v62, v62, v46
    v_smfmac_f32_16x16x64_bf16 v[64:67], v[40:43], v[192:199], v3
    v_add_f32 v63, v63, v47
    v_cvt_pk_bf16_f32 v44, v60, v61
    v_cvt_pk_bf16_f32 v45, v62, v63
    v_smfmac_f32_16x16x64_bf16 v[68:71], v[40:43], v[248:255], v3
    ds_write_b64 v8, v[44:45] offset:1024
    v_mov_b32 v52, 0
    v_mov_b32 v53, 0
    v_mov_b32 v54, 0
    v_mov_b32 v55, 0
    ds_read_b128 v[44:47], v10 offset:24576
    ds_read_b128 v[48:51], v10 offset:26624
    s_nop 1
    v_permlane32_swap_b32 v64, v68
    v_permlane32_swap_b32 v65, v69
    v_permlane32_swap_b32 v66, v70
    v_permlane32_swap_b32 v67, v71
    v_add_f32 v64, v64, v68
    v_add_f32 v65, v65, v69
    v_add_f32 v66, v66, v70
    v_add_f32 v67, v67, v71
    v_cvt_pk_bf16_f32 v68, v64, v65
    v_cvt_pk_bf16_f32 v69, v66, v67
    ds_write_b64 v7, v[68:69] offset:1280
    s_waitcnt lgkmcnt(0)
    s_barrier
    s_cmp_eq_u32 s12, 3
    s_cbranch_scc1 Lm_s_w3_f
    s_branch Lm_tj_51
Lm_t2_50:
    s_waitcnt lgkmcnt(6)
    v_smfmac_f32_16x16x64_bf16 v[44:47], v[16:19], a[0:7], v3
    s_waitcnt lgkmcnt(5)
    v_smfmac_f32_16x16x64_bf16 v[44:47], v[20:23], a[8:15], v3
    s_waitcnt lgkmcnt(4)
    v_smfmac_f32_16x16x64_bf16 v[44:47], v[24:27], a[16:23], v3
    s_waitcnt lgkmcnt(3)
    v_smfmac_f32_16x16x64_bf16 v[44:47], v[28:31], a[24:31], v3
    s_waitcnt lgkmcnt(2)
    v_smfmac_f32_16x16x64_bf16 v[44:47], v[32:35], a[32:39], v3
    s_waitcnt lgkmcnt(1)
    v_smfmac_f32_16x16x64_bf16 v[44:47], v[36:39], a[40:47], v3
    s_waitcnt lgkmcnt(0)
    v_smfmac_f32_16x16x64_bf16 v[44:47], v[40:43], a[48:55], v3
    v_smfmac_f32_16x16x64_bf16 v[48:51], v[16:19], a[56:63], v3
    s_waitcnt vmcnt(0)
    v_smfmac_f32_16x16x64_bf16 v[48:51], v[20:23], a[64:71], v3
    ds_read_b128 v[72:75], v10 offset:0
    ds_read_b128 v[76:79], v10 offset:512
    v_smfmac_f32_16x16x64_bf16 v[48:51], v[24:27], a[72:79], v3
    v_smfmac_f32_16x16x64_bf16 v[48:51], v[28:31], a[80:87], v3
    ds_read_b128 v[80:83], v10 offset:1024
    ds_read_b128 v[84:87], v10 offset:1536
    v_smfmac_f32_16x16x64_bf16 v[48:51], v[32:35], a[88:95], v3
    v_smfmac_f32_16x16x64_bf16 v[48:51], v[36:39], a[96:103], v3
    ds_read_b128 v[88:91], v10 offset:2048
    ds_read_b128 v[92:95], v10 offset:2560
    v_smfmac_f32_16x16x64_bf16 v[48:51], v[40:43], a[104:111], v3
    v_smfmac_f32_16x16x64_bf16 v[52:55], v[16:19], a[112:119], v3
    ds_read_b128 v[96:99], v10 offset:3072
    ds_read_b128 v[100:103], v10 offset:3584
    v_smfmac_f32_16x16x64_bf16 v[52:55], v[20:23], a[120:127], v3
    v_smfmac_f32_16x16x64_bf16 v[52:55], v[24:27], a[128:135], v3
    ds_read_b128 v[104:107], v10 offset:4096
    ds_read_b128 v[108:111], v10 offset:4608
    v_smfmac_f32_16x16x64_bf16 v[52:55], v[28:31], a[136:143], v3
    v_smfmac_f32_16x16x64_bf16 v[52:55], v[32:35], a[144:151], v3
    ds_read_b128 v[112:115], v10 offset:5120
    ds_read_b128 v[116:119], v10 offset:5632
    v_smfmac_f32_16x16x64_bf16 v[52:55], v[36:39], a[152:159], v3
    v_smfmac_f32_16x16x64_bf16 v[52:55], v[40:43], a[160:167], v3
    v_smfmac_f32_16x16x64_bf16 v[56:59], v[16:19], a[168:175], v3
    v_smfmac_f32_16x16x64_bf16 v[56:59], v[20:23], a[176:183], v3
    v_permlane32_swap_b32 v44, v48
    v_permlane32_swap_b32 v45, v49
    v_permlane32_swap_b32 v46, v50
    v_smfmac_f32_16x16x64_bf16 v[56:59], v[24:27], a[184:191], v3
    v_permlane32_swap_b32 v47, v51
    v_add_f32 v44, v44, v48
    v_add_f32 v45, v45, v49
    v_smfmac_f32_16x16x64_bf16 v[56:59], v[28:31], a[192:199], v3
    v_add_f32 v46, v46, v50
    v_add_f32 v47, v47, v51
    v_cvt_pk_bf16_f32 v48, v44, v45
    v_smfmac_f32_16x16x64_bf16 v[56:59], v[32:35], a[200:207], v3
    v_cvt_pk_bf16_f32 v49, v46, v47
    ds_write_b64 v7, v[48:49] offset:0
    v_smfmac_f32_16x16x64_bf16 v[56:59], v[36:39], a[208:215], v3
    v_smfmac_f32_16x16x64_bf16 v[56:59], v[40:43], a[216:223], v3
    v_smfmac_f32_16x16x64_bf16 v[60:63], v[16:19], a[224:231], v3
    v_smfmac_f32_16x16x64_bf16 v[60:63], v[20:23], a[232:239], v3
    v_smfmac_f32_16x16x64_bf16 v[60:63], v[24:27], a[240:247], v3
    v_smfmac_f32_16x16x64_bf16 v[60:63], v[28:31], a[248:255], v3
    v_smfmac_f32_16x16x64_bf16 v[60:63], v[32:35], v[120:127], v3
    v_smfmac_f32_16x16x64_bf16 v[60:63], v[36:39], v[128:135], v3
    v_smfmac_f32_16x16x64_bf16 v[60:63], v[40:43], v[136:143], v3
    v_smfmac_f32_16x16x64_bf16 v[64:67], v[16:19], v[144:151], v3
    v_smfmac_f32_16x16x64_bf16 v[68:71], v[16:19], v[200:207], v3
    v_permlane32_swap_b32 v52, v56
    v_permlane32_swap_b32 v53, v57
    v_permlane32_swap_b32 v54, v58
    v_smfmac_f32_16x16x64_bf16 v[64:67], v[20:23], v[152:159], v3
    v_permlane32_swap_b32 v55, v59
    v_add_f32 v52, v52, v56
    v_add_f32 v53, v53, v57
    v_smfmac_f32_16x16x64_bf16 v[68:71], v[20:23], v[208:215], v3
    v_add_f32 v54, v54, v58
    v_add_f32 v55, v55, v59
    v_cvt_pk_bf16_f32 v56, v52, v53
    v_smfmac_f32_16x16x64_bf16 v[64:67], v[24:27], v[160:167], v3
    v_cvt_pk_bf16_f32 v57, v54, v55
    ds_write_b64 v7, v[56:57] offset:512
    v_smfmac_f32_16x16x64_bf16 v[68:71], v[24:27], v[216:223], v3
    v_smfmac_f32_16x16x64_bf16 v[64:67], v[28:31], v[168:175], v3
    v_smfmac_f32_16x16x64_bf16 v[68:71], v[28:31], v[224:231], v3
    v_smfmac_f32_16x16x64_bf16 v[64:67], v[32:35], v[176:183], v3
    v_mov_b32 v44, v60
    v_mov_b32 v45, v61
    v_mov_b32 v46, v62
    v_smfmac_f32_16x16x64_bf16 v[68:71], v[32:35], v[232:239], v3
    v_mov_b32 v47, v63
    s_nop 0
    v_permlane32_swap_b32 v60, v44
    v_smfmac_f32_16x16x64_bf16 v[64:67], v[36:39], v[184:191], v3
    v_permlane32_swap_b32 v61, v45
    v_permlane32_swap_b32 v62, v46
    v_permlane32_swap_b32 v63, v47
    v_smfmac_f32_16x16x64_bf16 v[68:71], v[36:39], v[240:247], v3
    v_add_f32 v60, v60, v44
    v_add_f32 v61, v61, v45
    v_add_f32 v62, v62, v46
    v_smfmac_f32_16x16x64_bf16 v[64:67], v[40:43], v[192:199], v3
    v_add_f32 v63, v63, v47
    v_cvt_pk_bf16_f32 v44, v60, v61
    v_cvt_pk_bf16_f32 v45, v62, v63
    v_smfmac_f32_16x16x64_bf16 v[68:71], v[40:43], v[248:255], v3
    ds_write_b64 v8, v[44:45] offset:1024
    v_mov_b32 v52, 0
    v_mov_b32 v53, 0
    v_mov_b32 v54, 0
    v_mov_b32 v55, 0
    ds_read_b128 v[44:47], v10 offset:6144
    ds_read_b128 v[48:51], v10 offset:6656
    s_nop 1
    v_permlane32_swap_b32 v64, v68
    v_permlane32_swap_b32 v65, v69
    v_permlane32_swap_b32 v66, v70
    v_permlane32_swap_b32 v67, v71
    v_add_f32 v64, v64, v68
    v_add_f32 v65, v65, v69
    v_add_f32 v66, v66, v70
    v_add_f32 v67, v67, v71
    v_cvt_pk_bf16_f32 v68, v64, v65
    v_cvt_pk_bf16_f32 v69, v66, v67
    ds_write_b64 v7, v[68:69] offset:1280
    s_waitcnt lgkmcnt(0)
    s_barrier
Lm_tj_51:
    ds_read_b64_tr_b16 v[16:17], v9 offset:0
    ds_read_b64_tr_b16 v[18:19], v9 offset:128
    ds_read_b64_tr_b16 v[20:21], v9 offset:1024
    ds_read_b64_tr_b16 v[22:23], v9 offset:1152
    ds_read_b64_tr_b16 v[24:25], v9 offset:2048
    ds_read_b64_tr_b16 v[26:27], v9 offset:2176
    ds_read_b64_tr_b16 v[28:29], v9 offset:3072
    ds_read_b64_tr_b16 v[30:31], v9 offset:3200
    ds_read_b64_tr_b16 v[32:33], v9 offset:4096
    ds_read_b64_tr_b16 v[34:35], v9 offset:4224
    ds_read_b64_tr_b16 v[36:37], v9 offset:5120
    ds_read_b64_tr_b16 v[38:39], v9 offset:5248
    ds_read_b64_tr_b16 v[40:41], v9 offset:6144
    ds_read_b64_tr_b16 v[42:43], v9 offset:6272
    s_waitcnt lgkmcnt(12)
    v_smfmac_f32_16x16x64_bf16 v[52:55], v[16:19], v[72:79], v3
    s_waitcnt lgkmcnt(10)
    v_smfmac_f32_16x16x64_bf16 v[52:55], v[20:23], v[80:87], v3
    s_waitcnt lgkmcnt(8)
    v_smfmac_f32_16x16x64_bf16 v[52:55], v[24:27], v[88:95], v3
    s_waitcnt lgkmcnt(6)
    v_smfmac_f32_16x16x64_bf16 v[52:55], v[28:31], v[96:103], v3
    s_waitcnt lgkmcnt(4)
    v_smfmac_f32_16x16x64_bf16 v[52:55], v[32:35], v[104:111], v3
    s_waitcnt lgkmcnt(2)
    v_smfmac_f32_16x16x64_bf16 v[52:55], v[36:39], v[112:119], v3
    s_waitcnt lgkmcnt(0)
    v_smfmac_f32_16x16x64_bf16 v[52:55], v[40:43], v[44:51], v3
    s_nop 7
    v_permlane32_swap_b32 v52, v53
    v_permlane32_swap_b32 v54, v55
    v_add_f32 v52, v52, v53
    v_add_f32 v54, v54, v55
    ds_write_b32 v11, v52
    ds_write_b32 v11, v54 offset:384
    s_waitcnt lgkmcnt(0)
    s_barrier
    s_branch Lm_s_after_f
Lm_s_w3_f:
    s_barrier
    ds_read_b128 v[72:75], v12
    ds_read_b32 v76, v13
    s_waitcnt lgkmcnt(0)
    v_max3_f32 v77, v72, v73, v74
    v_max3_f32 v77, v77, v75, v76
    s_nop 1
    v_max_f32_dpp v77, v77, v77 quad_perm:[1,0,3,2] row_mask:0xf bank_mask:0xf
    s_nop 1
    v_max_f32_dpp v77, v77, v77 quad_perm:[2,3,0,1] row_mask:0xf bank_mask:0xf
    s_nop 1
    v_max_f32_dpp v77, v77, v77 row_half_mirror row_mask:0xf bank_mask:0xf
    v_sub_f32 v72, v72, v77
    v_sub_f32 v73, v73, v77
    v_sub_f32 v74, v74, v77
    v_sub_f32 v75, v75, v77
    v_sub_f32 v76, v76, v77
    v_exp_f32 v72, v72
    v_exp_f32 v73, v73
    v_exp_f32 v74, v74
    v_exp_f32 v75, v75
    v_exp_f32 v76, v76
    s_nop 0
    v_add_f32 v77, v72, v73
    v_add_f32 v78, v74, v75
    v_add_f32 v77, v77, v76
    v_add_f32 v77, v77, v78
    s_nop 1
    v_add_f32_dpp v77, v77, v77 quad_perm:[1,0,3,2] row_mask:0xf bank_mask:0xf
    s_nop 1
    v_add_f32_dpp v77, v77, v77 quad_perm:[2,3,0,1] row_mask:0xf bank_mask:0xf
    s_nop 1
    v_add_f32_dpp v77, v77, v77 row_half_mirror row_mask:0xf bank_mask:0xf
    v_rcp_f32 v77, v77
    s_nop 0
    v_mul_f32 v72, v72, v77
    v_mul_f32 v73, v73, v77
    v_mul_f32 v74, v74, v77
    v_mul_f32 v75, v75, v77
    v_mul_f32 v76, v76, v77
    v_cvt_pk_bf16_f32 v80, v72, v73
    v_cvt_pk_bf16_f32 v81, v74, v75
    v_mov_b32_dpp v78, v76 quad_perm:[1,0,3,2] row_mask:0xf bank_mask:0xf
    buffer_store_dwordx2 v[80:81], v14, s[4:7], s26 offen
    v_cvt_pk_bf16_f32 v79, v76, v78
    s_mov_b32 exec_lo, 0x55555555
    s_mov_b32 exec_hi, 0x55555555
    buffer_store_dword v79, v15, s[4:7], s27 offen
    s_mov_b64 exec, -1
Lm_s_after_f:
    s_barrier
    s_add_u32 s14, s14, 1
    s_add_u32 s15, s15, 7168
    s_add_u32 s26, s26, 8192
    s_add_u32 s27, s27, 2048
    s_add_u32 s28, s28, 28672
    s_cmp_lt_u32 s14, 63
    s_cbranch_scc0 Lm_fin
    s_mul_i32 s32, s12, 7168
    s_add_u32 s33, s32, s28
    s_add_u32 s32, s32, 20480
    s_mov_b32 m0, s32
    s_nop 0
    buffer_load_dwordx4 v6, s[4:7], s33 offen offset:0 lds
    buffer_load_dwordx4 v6, s[4:7], s33 offen offset:1024 lds
    buffer_load_dwordx4 v6, s[4:7], s33 offen offset:2048 lds
    buffer_load_dwordx4 v6, s[4:7], s33 offen offset:3072 lds
    s_add_u32 s32, s32, 4096
    s_add_u32 s33, s33, 4096
    s_mov_b32 m0, s32
    s_nop 0
    buffer_load_dwordx4 v6, s[4:7], s33 offen offset:0 lds
    buffer_load_dwordx4 v6, s[4:7], s33 offen offset:1024 lds
    buffer_load_dwordx4 v6, s[4:7], s33 offen offset:2048 lds
    s_cmp_eq_u32 s22, 0
    s_cbranch_scc1 Lm_sstep_f
    s_branch Lm_fin
Lm_value_f:
    s_sub_u32 s36, s13, 16
    v_and_b32 v16, 15, v1
    v_lshrrev_b32 v17, 4, v1
    v_mul_u32_u24 v21, 896, v16
    v_lshlrev_b32 v22, 5, v17
    v_add_u32 v21, v21, v22
    s_lshl_b32 s32, s12, 2
    s_add_u32 s32, s32, 0
    s_mul_i32 s32, s32, 448
    s_lshl_b32 s33, s36, 5
    s_add_u32 s32, s32, s33
    s_add_u32 s32, s32, 7168
    s_mul_i32 s32, s32, 896
    s_add_u32 s32, s32, 0
    buffer_load_dwordx4 a[0:3], v21, s[4:7], s32 offen offset:0
    buffer_load_dwordx4 a[4:7], v21, s[4:7], s32 offen offset:16
    buffer_load_dwordx4 a[8:11], v21, s[4:7], s32 offen offset:128
    buffer_load_dwordx4 a[12:15], v21, s[4:7], s32 offen offset:144
    buffer_load_dwordx4 a[16:19], v21, s[4:7], s32 offen offset:256
    buffer_load_dwordx4 a[20:23], v21, s[4:7], s32 offen offset:272
    buffer_load_dwordx4 a[24:27], v21, s[4:7], s32 offen offset:384
    buffer_load_dwordx4 a[28:31], v21, s[4:7], s32 offen offset:400
    buffer_load_dwordx4 a[32:35], v21, s[4:7], s32 offen offset:512
    buffer_load_dwordx4 a[36:39], v21, s[4:7], s32 offen offset:528
    buffer_load_dwordx4 a[40:43], v21, s[4:7], s32 offen offset:640
    buffer_load_dwordx4 a[44:47], v21, s[4:7], s32 offen offset:656
    buffer_load_dwordx4 a[48:51], v21, s[4:7], s32 offen offset:768
    buffer_load_dwordx4 a[52:55], v21, s[4:7], s32 offen offset:784
    s_waitcnt vmcnt(30)
    s_lshl_b32 s32, s12, 2
    s_add_u32 s32, s32, 0
    s_mul_i32 s32, s32, 448
    s_lshl_b32 s33, s36, 5
    s_add_u32 s32, s32, s33
    s_add_u32 s32, s32, 7184
    s_mul_i32 s32, s32, 896
    s_add_u32 s32, s32, 0
    buffer_load_dwordx4 a[56:59], v21, s[4:7], s32 offen offset:0
    buffer_load_dwordx4 a[60:63], v21, s[4:7], s32 offen offset:16
    buffer_load_dwordx4 a[64:67], v21, s[4:7], s32 offen offset:128
    buffer_load_dwordx4 a[68:71], v21, s[4:7], s32 offen offset:144
    buffer_load_dwordx4 a[72:75], v21, s[4:7], s32 offen offset:256
    buffer_load_dwordx4 a[76:79], v21, s[4:7], s32 offen offset:272
    buffer_load_dwordx4 a[80:83], v21, s[4:7], s32 offen offset:384
    buffer_load_dwordx4 a[84:87], v21, s[4:7], s32 offen offset:400
    buffer_load_dwordx4 a[88:91], v21, s[4:7], s32 offen offset:512
    buffer_load_dwordx4 a[92:95], v21, s[4:7], s32 offen offset:528
    buffer_load_dwordx4 a[96:99], v21, s[4:7], s32 offen offset:640
    buffer_load_dwordx4 a[100:103], v21, s[4:7], s32 offen offset:656
    buffer_load_dwordx4 a[104:107], v21, s[4:7], s32 offen offset:768
    buffer_load_dwordx4 a[108:111], v21, s[4:7], s32 offen offset:784
    s_waitcnt vmcnt(30)
    s_lshl_b32 s32, s12, 2
    s_add_u32 s32, s32, 1
    s_mul_i32 s32, s32, 448
    s_lshl_b32 s33, s36, 5
    s_add_u32 s32, s32, s33
    s_add_u32 s32, s32, 7168
    s_mul_i32 s32, s32, 896
    s_add_u32 s32, s32, 0
    buffer_load_dwordx4 a[112:115], v21, s[4:7], s32 offen offset:0
    buffer_load_dwordx4 a[116:119], v21, s[4:7], s32 offen offset:16
    buffer_load_dwordx4 a[120:123], v21, s[4:7], s32 offen offset:128
    buffer_load_dwordx4 a[124:127], v21, s[4:7], s32 offen offset:144
    buffer_load_dwordx4 a[128:131], v21, s[4:7], s32 offen offset:256
    buffer_load_dwordx4 a[132:135], v21, s[4:7], s32 offen offset:272
    buffer_load_dwordx4 a[136:139], v21, s[4:7], s32 offen offset:384
    buffer_load_dwordx4 a[140:143], v21, s[4:7], s32 offen offset:400
    buffer_load_dwordx4 a[144:147], v21, s[4:7], s32 offen offset:512
    buffer_load_dwordx4 a[148:151], v21, s[4:7], s32 offen offset:528
    buffer_load_dwordx4 a[152:155], v21, s[4:7], s32 offen offset:640
    buffer_load_dwordx4 a[156:159], v21, s[4:7], s32 offen offset:656
    buffer_load_dwordx4 a[160:163], v21, s[4:7], s32 offen offset:768
    buffer_load_dwordx4 a[164:167], v21, s[4:7], s32 offen offset:784
    s_waitcnt vmcnt(30)
    s_lshl_b32 s32, s12, 2
    s_add_u32 s32, s32, 1
    s_mul_i32 s32, s32, 448
    s_lshl_b32 s33, s36, 5
    s_add_u32 s32, s32, s33
    s_add_u32 s32, s32, 7184
    s_mul_i32 s32, s32, 896
    s_add_u32 s32, s32, 0
    buffer_load_dwordx4 a[168:171], v21, s[4:7], s32 offen offset:0
    buffer_load_dwordx4 a[172:175], v21, s[4:7], s32 offen offset:16
    buffer_load_dwordx4 a[176:179], v21, s[4:7], s32 offen offset:128
    buffer_load_dwordx4 a[180:183], v21, s[4:7], s32 offen offset:144
    buffer_load_dwordx4 a[184:187], v21, s[4:7], s32 offen offset:256
    buffer_load_dwordx4 a[188:191], v21, s[4:7], s32 offen offset:272
    buffer_load_dwordx4 a[192:195], v21, s[4:7], s32 offen offset:384
    buffer_load_dwordx4 a[196:199], v21, s[4:7], s32 offen offset:400
    buffer_load_dwordx4 a[200:203], v21, s[4:7], s32 offen offset:512
    buffer_load_dwordx4 a[204:207], v21, s[4:7], s32 offen offset:528
    buffer_load_dwordx4 a[208:211], v21, s[4:7], s32 offen offset:640
    buffer_load_dwordx4 a[212:215], v21, s[4:7], s32 offen offset:656
    buffer_load_dwordx4 a[216:219], v21, s[4:7], s32 offen offset:768
    buffer_load_dwordx4 a[220:223], v21, s[4:7], s32 offen offset:784
    s_waitcnt vmcnt(30)
    s_lshl_b32 s32, s12, 2
    s_add_u32 s32, s32, 2
    s_mul_i32 s32, s32, 448
    s_lshl_b32 s33, s36, 5
    s_add_u32 s32, s32, s33
    s_add_u32 s32, s32, 7168
    s_mul_i32 s32, s32, 896
    s_add_u32 s32, s32, 0
    buffer_load_dwordx4 a[224:227], v21, s[4:7], s32 offen offset:0
    buffer_load_dwordx4 a[228:231], v21, s[4:7], s32 offen offset:16
    buffer_load_dwordx4 a[232:235], v21, s[4:7], s32 offen offset:128
    buffer_load_dwordx4 a[236:239], v21, s[4:7], s32 offen offset:144
    buffer_load_dwordx4 a[240:243], v21, s[4:7], s32 offen offset:256
    buffer_load_dwordx4 a[244:247], v21, s[4:7], s32 offen offset:272
    buffer_load_dwordx4 a[248:251], v21, s[4:7], s32 offen offset:384
    buffer_load_dwordx4 a[252:255], v21, s[4:7], s32 offen offset:400
    buffer_load_dwordx4 v[192:195], v21, s[4:7], s32 offen offset:512
    buffer_load_dwordx4 v[196:199], v21, s[4:7], s32 offen offset:528
    buffer_load_dwordx4 v[200:203], v21, s[4:7], s32 offen offset:640
    buffer_load_dwordx4 v[204:207], v21, s[4:7], s32 offen offset:656
    buffer_load_dwordx4 v[208:211], v21, s[4:7], s32 offen offset:768
    buffer_load_dwordx4 v[212:215], v21, s[4:7], s32 offen offset:784
    s_waitcnt vmcnt(30)
    s_lshl_b32 s32, s12, 2
    s_add_u32 s32, s32, 2
    s_mul_i32 s32, s32, 448
    s_lshl_b32 s33, s36, 5
    s_add_u32 s32, s32, s33
    s_add_u32 s32, s32, 7184
    s_mul_i32 s32, s32, 896
    s_add_u32 s32, s32, 0
    buffer_load_dwordx4 v[216:219], v21, s[4:7], s32 offen offset:0
    buffer_load_dwordx4 v[220:223], v21, s[4:7], s32 offen offset:16
    buffer_load_dwordx4 v[224:227], v21, s[4:7], s32 offen offset:128
    buffer_load_dwordx4 v[228:231], v21, s[4:7], s32 offen offset:144
    buffer_load_dwordx4 v[232:235], v21, s[4:7], s32 offen offset:256
    buffer_load_dwordx4 v[236:239], v21, s[4:7], s32 offen offset:272
    buffer_load_dwordx4 v[240:243], v21, s[4:7], s32 offen offset:384
    buffer_load_dwordx4 v[244:247], v21, s[4:7], s32 offen offset:400
    buffer_load_dwordx4 v[248:251], v21, s[4:7], s32 offen offset:512
    buffer_load_dwordx4 v[252:255], v21, s[4:7], s32 offen offset:528
    s_lshl_b32 s33, s12, 15
    s_add_u32 s33, s33, 16384
    s_mov_b32 m0, s33
    s_add_u32 s34, s32, 640
    buffer_load_dwordx4 v21, s[4:7], s34 offen lds
    s_lshl_b32 s33, s12, 15
    s_add_u32 s33, s33, 17408
    s_mov_b32 m0, s33
    s_add_u32 s34, s32, 656
    buffer_load_dwordx4 v21, s[4:7], s34 offen lds
    s_lshl_b32 s33, s12, 15
    s_add_u32 s33, s33, 18432
    s_mov_b32 m0, s33
    s_add_u32 s34, s32, 768
    buffer_load_dwordx4 v21, s[4:7], s34 offen lds
    s_lshl_b32 s33, s12, 15
    s_add_u32 s33, s33, 19456
    s_mov_b32 m0, s33
    s_add_u32 s34, s32, 784
    buffer_load_dwordx4 v21, s[4:7], s34 offen lds
    s_waitcnt vmcnt(30)
    s_lshl_b32 s32, s12, 2
    s_add_u32 s32, s32, 3
    s_mul_i32 s32, s32, 448
    s_lshl_b32 s33, s36, 5
    s_add_u32 s32, s32, s33
    s_add_u32 s32, s32, 7168
    s_mul_i32 s32, s32, 896
    s_add_u32 s32, s32, 0
    s_lshl_b32 s33, s12, 15
    s_add_u32 s33, s33, 20480
    s_mov_b32 m0, s33
    s_add_u32 s34, s32, 0
    buffer_load_dwordx4 v21, s[4:7], s34 offen lds
    s_lshl_b32 s33, s12, 15
    s_add_u32 s33, s33, 21504
    s_mov_b32 m0, s33
    s_add_u32 s34, s32, 16
    buffer_load_dwordx4 v21, s[4:7], s34 offen lds
    s_lshl_b32 s33, s12, 15
    s_add_u32 s33, s33, 22528
    s_mov_b32 m0, s33
    s_add_u32 s34, s32, 128
    buffer_load_dwordx4 v21, s[4:7], s34 offen lds
    s_lshl_b32 s33, s12, 15
    s_add_u32 s33, s33, 23552
    s_mov_b32 m0, s33
    s_add_u32 s34, s32, 144
    buffer_load_dwordx4 v21, s[4:7], s34 offen lds
    s_lshl_b32 s33, s12, 15
    s_add_u32 s33, s33, 24576
    s_mov_b32 m0, s33
    s_add_u32 s34, s32, 256
    buffer_load_dwordx4 v21, s[4:7], s34 offen lds
    s_lshl_b32 s33, s12, 15
    s_add_u32 s33, s33, 25600
    s_mov_b32 m0, s33
    s_add_u32 s34, s32, 272
    buffer_load_dwordx4 v21, s[4:7], s34 offen lds
    s_lshl_b32 s33, s12, 15
    s_add_u32 s33, s33, 26624
    s_mov_b32 m0, s33
    s_add_u32 s34, s32, 384
    buffer_load_dwordx4 v21, s[4:7], s34 offen lds
    s_lshl_b32 s33, s12, 15
    s_add_u32 s33, s33, 27648
    s_mov_b32 m0, s33
    s_add_u32 s34, s32, 400
    buffer_load_dwordx4 v21, s[4:7], s34 offen lds
    s_lshl_b32 s33, s12, 15
    s_add_u32 s33, s33, 28672
    s_mov_b32 m0, s33
    s_add_u32 s34, s32, 512
    buffer_load_dwordx4 v21, s[4:7], s34 offen lds
    s_lshl_b32 s33, s12, 15
    s_add_u32 s33, s33, 29696
    s_mov_b32 m0, s33
    s_add_u32 s34, s32, 528
    buffer_load_dwordx4 v21, s[4:7], s34 offen lds
    s_lshl_b32 s33, s12, 15
    s_add_u32 s33, s33, 30720
    s_mov_b32 m0, s33
    s_add_u32 s34, s32, 640
    buffer_load_dwordx4 v21, s[4:7], s34 offen lds
    s_lshl_b32 s33, s12, 15
    s_add_u32 s33, s33, 31744
    s_mov_b32 m0, s33
    s_add_u32 s34, s32, 656
    buffer_load_dwordx4 v21, s[4:7], s34 offen lds
    s_lshl_b32 s33, s12, 15
    s_add_u32 s33, s33, 32768
    s_mov_b32 m0, s33
    s_add_u32 s34, s32, 768
    buffer_load_dwordx4 v21, s[4:7], s34 offen lds
    s_lshl_b32 s33, s12, 15
    s_add_u32 s33, s33, 33792
    s_mov_b32 m0, s33
    s_add_u32 s34, s32, 784
    buffer_load_dwordx4 v21, s[4:7], s34 offen lds
    s_waitcnt vmcnt(30)
    s_lshl_b32 s32, s12, 2
    s_add_u32 s32, s32, 3
    s_mul_i32 s32, s32, 448
    s_lshl_b32 s33, s36, 5
    s_add_u32 s32, s32, s33
    s_add_u32 s32, s32, 7184
    s_mul_i32 s32, s32, 896
    s_add_u32 s32, s32, 0
    s_lshl_b32 s33, s12, 15
    s_add_u32 s33, s33, 34816
    s_mov_b32 m0, s33
    s_add_u32 s34, s32, 0
    buffer_load_dwordx4 v21, s[4:7], s34 offen lds
    s_lshl_b32 s33, s12, 15
    s_add_u32 s33, s33, 35840
    s_mov_b32 m0, s33
    s_add_u32 s34, s32, 16
    buffer_load_dwordx4 v21, s[4:7], s34 offen lds
    s_lshl_b32 s33, s12, 15
    s_add_u32 s33, s33, 36864
    s_mov_b32 m0, s33
    s_add_u32 s34, s32, 128
    buffer_load_dwordx4 v21, s[4:7], s34 offen lds
    s_lshl_b32 s33, s12, 15
    s_add_u32 s33, s33, 37888
    s_mov_b32 m0, s33
    s_add_u32 s34, s32, 144
    buffer_load_dwordx4 v21, s[4:7], s34 offen lds
    s_lshl_b32 s33, s12, 15
    s_add_u32 s33, s33, 38912
    s_mov_b32 m0, s33
    s_add_u32 s34, s32, 256
    buffer_load_dwordx4 v21, s[4:7], s34 offen lds
    s_lshl_b32 s33, s12, 15
    s_add_u32 s33, s33, 39936
    s_mov_b32 m0, s33
    s_add_u32 s34, s32, 272
    buffer_load_dwordx4 v21, s[4:7], s34 offen lds
    s_lshl_b32 s33, s12, 15
    s_add_u32 s33, s33, 40960
    s_mov_b32 m0, s33
    s_add_u32 s34, s32, 384
    buffer_load_dwordx4 v21, s[4:7], s34 offen lds
    s_lshl_b32 s33, s12, 15
    s_add_u32 s33, s33, 41984
    s_mov_b32 m0, s33
    s_add_u32 s34, s32, 400
    buffer_load_dwordx4 v21, s[4:7], s34 offen lds
    s_lshl_b32 s33, s12, 15
    s_add_u32 s33, s33, 43008
    s_mov_b32 m0, s33
    s_add_u32 s34, s32, 512
    buffer_load_dwordx4 v21, s[4:7], s34 offen lds
    s_lshl_b32 s33, s12, 15
    s_add_u32 s33, s33, 44032
    s_mov_b32 m0, s33
    s_add_u32 s34, s32, 528
    buffer_load_dwordx4 v21, s[4:7], s34 offen lds
    s_lshl_b32 s33, s12, 15
    s_add_u32 s33, s33, 45056
    s_mov_b32 m0, s33
    s_add_u32 s34, s32, 640
    buffer_load_dwordx4 v21, s[4:7], s34 offen lds
    s_lshl_b32 s33, s12, 15
    s_add_u32 s33, s33, 46080
    s_mov_b32 m0, s33
    s_add_u32 s34, s32, 656
    buffer_load_dwordx4 v21, s[4:7], s34 offen lds
    s_lshl_b32 s33, s12, 15
    s_add_u32 s33, s33, 47104
    s_mov_b32 m0, s33
    s_add_u32 s34, s32, 768
    buffer_load_dwordx4 v21, s[4:7], s34 offen lds
    s_lshl_b32 s33, s12, 15
    s_add_u32 s33, s33, 48128
    s_mov_b32 m0, s33
    s_add_u32 s34, s32, 784
    buffer_load_dwordx4 v21, s[4:7], s34 offen lds
    s_waitcnt vmcnt(30)
    s_lshl_b32 s33, s12, 15
    s_add_u32 s33, s33, 16384
    v_add_u32 v7, s33, v6
    v_lshlrev_b32 v8, 3, v17
    v_and_b32 v22, 7, v16
    v_add_u32 v8, v8, v22
    v_lshlrev_b32 v8, 4, v8
    v_lshrrev_b32 v22, 3, v16
    v_lshlrev_b32 v22, 9, v22
    v_add_u32 v8, v8, v22
    s_lshl_b32 s33, s12, 11
    s_add_u32 s33, s33, 8192
    v_add_u32 v9, s33, v6
    s_lshl_b32 s33, s12, 10
    s_add_u32 s33, s33, 8192
    v_add_u32 v10, s33, v6
    v_lshrrev_b32 v22, 1, v17
    v_lshlrev_b32 v11, 7, v22
    v_and_b32 v22, 7, v16
    v_lshlrev_b32 v22, 4, v22
    v_add_u32 v11, v11, v22
    v_and_b32 v22, 1, v17
    v_lshlrev_b32 v22, 3, v22
    v_add_u32 v11, v11, v22
    s_mov_b32 s14, 0
    s_mov_b32 s15, 16527360
    s_lshl_b32 s26, s12, 11
    s_add_u32 s26, s26, 16994304
    s_lshl_b32 s27, s12, 9
    s_add_u32 s27, s27, 17518592
    v_lshrrev_b32 v22, 3, v16
    v_lshlrev_b32 v22, 8, v22
    v_add_u32 v187, v11, v22
    s_lshl_b32 s29, s36, 15
    s_lshl_b32 s33, s12, 12
    s_add_u32 s29, s29, s33
    s_add_u32 s29, s29, 47009792
    s_lshl_b32 s30, s36, 13
    s_lshl_b32 s33, s12, 10
    s_add_u32 s30, s30, s33
    s_add_u32 s30, s30, 76369920
    s_lshl_b32 s32, s36, 1
    s_add_u32 s32, s32, s12
    s_lshl_b32 s31, s32, 8
    s_add_u32 s31, s31, 16534528
    v_mov_b32 v12, 0
    v_mov_b32 v13, 0
    v_mov_b32 v14, 0
    v_mov_b32 v15, 0
    v_mov_b32 v1, 0
    s_mov_b32 s37, 100188160
    s_lshl_b32 s38, s36, 7
    s_add_u32 s38, s38, 100057088
    v_mov_b32 v0, s97
    s_add_u32 s39, s31, 75415552
    s_waitcnt vmcnt(0)
    s_mov_b32 s99, 100196352
    v_lshrrev_b32 v80, 4, v6
    v_min_u32 v80, 63, v80
    v_lshlrev_b32 v80, 4, v80
    s_mov_b32 s21, 0
Lm_wf_52:
    buffer_load_dwordx4 v[84:87], v80, s[4:7], s99 offen sc1
    s_waitcnt vmcnt(0)
    v_xor_b32 v84, s97, v84
    v_xor_b32 v85, s97, v85
    v_xor_b32 v86, s97, v86
    v_xor_b32 v87, s97, v87
    v_or_b32 v84, v84, v85
    v_or_b32 v84, v84, v86
    v_or_b32 v84, v84, v87
    v_cmp_ne_u32 vcc, 0, v84
    s_cbranch_vccz Lm_wf_52_ok
    s_sleep 1
    s_add_u32 s21, s21, 1
    s_cmp_lt_u32 s21, 400000
    s_cbranch_scc1 Lm_wf_52
Lm_wf_52_ok:
    s_mov_b32 s99, 100198400
    v_lshrrev_b32 v80, 4, v6
    v_min_u32 v80, 63, v80
    v_lshlrev_b32 v80, 4, v80
    s_mov_b32 s21, 0
Lm_wf_53:
    buffer_load_dwordx4 v[84:87], v80, s[4:7], s99 offen sc1
    s_waitcnt vmcnt(0)
    v_xor_b32 v84, s97, v84
    v_xor_b32 v85, s97, v85
    v_xor_b32 v86, s97, v86
    v_xor_b32 v87, s97, v87
    v_or_b32 v84, v84, v85
    v_or_b32 v84, v84, v86
    v_or_b32 v84, v84, v87
    v_cmp_ne_u32 vcc, 0, v84
    s_cbranch_vccz Lm_wf_53_ok
    s_sleep 1
    s_add_u32 s21, s21, 1
    s_cmp_lt_u32 s21, 400000
    s_cbranch_scc1 Lm_wf_53
Lm_wf_53_ok:
    v_xor_b32 v2, v0, v12
    v_xor_b32 v182, v0, v13
    v_or_b32 v2, v2, v182
    v_xor_b32 v182, v0, v14
    v_or_b32 v2, v2, v182
    v_xor_b32 v182, v0, v15
    v_or_b32 v2, v2, v182
    s_nop 0
    v_readfirstlane_b32 s32, v2
    s_nop 3
    s_cmp_eq_u32 s32, 0
    s_cbranch_scc1 Lm_pc_54_ok
    s_mov_b32 s21, 0
Lm_pc_54:
    buffer_load_dwordx4 v[12:15], v1, s[4:7], s37 offen sc1
    s_waitcnt vmcnt(0)
    v_xor_b32 v2, v0, v12
    v_xor_b32 v182, v0, v13
    v_or_b32 v2, v2, v182
    v_xor_b32 v182, v0, v14
    v_or_b32 v2, v2, v182
    v_xor_b32 v182, v0, v15
    v_or_b32 v2, v2, v182
    s_nop 0
    v_readfirstlane_b32 s32, v2
    s_nop 3
    s_cmp_eq_u32 s32, 0
    s_cbranch_scc1 Lm_pc_54_ok
    s_sleep 1
    s_add_u32 s21, s21, 1
    s_cmp_lt_u32 s21, 400000
    s_cbranch_scc1 Lm_pc_54
    s_mov_b32 s22, 1
Lm_pc_54_ok:
    s_add_u32 s32, s29, 0
    buffer_load_dwordx4 v[100:103], v6, s[4:7], s32 offen offset:0
    buffer_load_dwordx4 v[108:111], v6, s[4:7], s32 offen offset:1024
    buffer_load_dwordx4 v[116:119], v6, s[4:7], s32 offen offset:2048
    buffer_load_dwordx4 v[124:127], v6, s[4:7], s32 offen offset:3072
    s_add_u32 s32, s29, 16384
    buffer_load_dwordx4 v[104:107], v6, s[4:7], s32 offen offset:0
    buffer_load_dwordx4 v[112:115], v6, s[4:7], s32 offen offset:1024
    buffer_load_dwordx4 v[120:123], v6, s[4:7], s32 offen offset:2048
    buffer_load_dwordx4 v[128:131], v6, s[4:7], s32 offen offset:3072
    v_mov_b32 v44, 0
    v_mov_b32 v45, 0
    v_mov_b32 v46, 0
    v_mov_b32 v47, 0
    v_mov_b32 v48, 0
    v_mov_b32 v49, 0
    v_mov_b32 v50, 0
    v_mov_b32 v51, 0
    v_mov_b32 v52, 0
    v_mov_b32 v53, 0
    v_mov_b32 v54, 0
    v_mov_b32 v55, 0
    v_mov_b32 v56, 0
    v_mov_b32 v57, 0
    v_mov_b32 v58, 0
    v_mov_b32 v59, 0
    v_mov_b32 v60, 0
    v_mov_b32 v61, 0
    v_mov_b32 v62, 0
    v_mov_b32 v63, 0
    v_mov_b32 v64, 0
    v_mov_b32 v65, 0
    v_mov_b32 v66, 0
    v_mov_b32 v67, 0
    v_mov_b32 v68, 0
    v_mov_b32 v69, 0
    v_mov_b32 v70, 0
    v_mov_b32 v71, 0
    v_mov_b32 v72, 0
    v_mov_b32 v73, 0
    v_mov_b32 v74, 0
    v_mov_b32 v75, 0
    s_waitcnt vmcnt(0)
Lm_vstep_f:
    ds_read_b128 v[76:79], v7 offset:4096
    ds_read_b128 v[80:83], v7 offset:5120
    ds_read_b128 v[84:87], v7 offset:6144
    ds_read_b128 v[88:91], v7 offset:7168
    ds_read_b128 v[92:95], v7 offset:8192
    ds_read_b128 v[96:99], v7 offset:9216
    s_mov_b32 s21, 0
Lm_poll_55:
    buffer_load_dwordx4 v[168:171], v4, s[4:7], s15 offen sc1
    buffer_load_dwordx4 v[172:175], v5, s[4:7], s15 offen sc1
    s_waitcnt vmcnt(0)
    v_max3_u32 v178, v168, v169, v170
    v_max3_u32 v179, v171, v172, v173
    v_max3_u32 v178, v178, v174, v175
    v_max_u32 v178, v178, v179
    v_cmp_eq_u32 vcc, -1, v178
    s_cbranch_vccz Lm_poll_55_ok
    s_add_u32 s21, s21, 1
    s_cmp_lt_u32 s21, 400000
    s_cbranch_scc1 Lm_poll_55
    s_mov_b32 s22, 1
Lm_poll_55_ok:
    ds_write_b128 v4, v[168:171] offset:0
    ds_write_b128 v4, v[172:175] offset:4096
    s_waitcnt lgkmcnt(0)
    s_barrier
    ds_read_b128 v[16:19], v6 offset:0
    ds_read_b128 v[20:23], v6 offset:1024
    ds_read_b128 v[24:27], v6 offset:2048
    ds_read_b128 v[28:31], v6 offset:3072
    ds_read_b128 v[32:35], v6 offset:4096
    ds_read_b128 v[36:39], v6 offset:5120
    ds_read_b128 v[40:43], v6 offset:6144
    v_xor_b32 v2, v0, v12
    v_xor_b32 v182, v0, v13
    v_or_b32 v2, v2, v182
    v_xor_b32 v182, v0, v14
    v_or_b32 v2, v2, v182
    v_xor_b32 v182, v0, v15
    v_or_b32 v2, v2, v182
    s_nop 0
    v_readfirstlane_b32 s32, v2
    s_nop 3
    s_cmp_eq_u32 s32, 0
    s_cbranch_scc1 Lm_pc_56_ok
    s_mov_b32 s21, 0
Lm_pc_56:
    buffer_load_dwordx4 v[12:15], v1, s[4:7], s37 offen sc1
    s_waitcnt vmcnt(0)
    v_xor_b32 v2, v0, v12
    v_xor_b32 v182, v0, v13
    v_or_b32 v2, v2, v182
    v_xor_b32 v182, v0, v14
    v_or_b32 v2, v2, v182
    v_xor_b32 v182, v0, v15
    v_or_b32 v2, v2, v182
    s_nop 0
    v_readfirstlane_b32 s32, v2
    s_nop 3
    s_cmp_eq_u32 s32, 0
    s_cbranch_scc1 Lm_pc_56_ok
    s_sleep 1
    s_add_u32 s21, s21, 1
    s_cmp_lt_u32 s21, 400000
    s_cbranch_scc1 Lm_pc_56
    s_mov_b32 s22, 1
Lm_pc_56_ok:
    s_add_u32 s34, s29, 16384
    s_add_u32 s35, s37, 64
    s_waitcnt lgkmcnt(6)
    v_smfmac_f32_16x16x64_bf16 v[44:47], v[16:19], a[0:7], v3
    s_waitcnt lgkmcnt(5)
    v_smfmac_f32_16x16x64_bf16 v[44:47], v[20:23], a[8:15], v3
    s_waitcnt lgkmcnt(4)
    v_smfmac_f32_16x16x64_bf16 v[44:47], v[24:27], a[16:23], v3
    s_cmp_eq_u32 s14, 0
    s_cbranch_scc1 Lm_sw_57
    s_add_u32 s33, s30, 4294852608
    s_add_u32 s32, s30, 4294856704
    buffer_store_dwordx4 v[152:155], v6, s[4:7], s33 offen sc1
    buffer_store_dwordx4 v[156:159], v6, s[4:7], s32 offen sc1
Lm_sw_57:
    s_waitcnt lgkmcnt(3)
    v_smfmac_f32_16x16x64_bf16 v[44:47], v[28:31], a[24:31], v3
    s_waitcnt lgkmcnt(2)
    v_smfmac_f32_16x16x64_bf16 v[44:47], v[32:35], a[32:39], v3
    s_cmp_eq_u32 s14, 0
    s_cbranch_scc1 Lm_mx_58
    s_cmp_lt_u32 s12, 2
    s_cbranch_scc0 Lm_mx_58
    s_sub_u32 s32, s39, 7168
    s_mov_b32 exec_lo, 0x00ff00ff
    s_mov_b32 exec_hi, 0x00ff00ff
    buffer_store_dwordx2 v[180:181], v11, s[4:7], s32 offen sc1
    s_mov_b64 exec, -1
    s_nop 3
Lm_mx_58:
    s_waitcnt lgkmcnt(1)
    v_smfmac_f32_16x16x64_bf16 v[44:47], v[36:39], a[40:47], v3
    s_cmp_ge_u32 s14, 2
    s_cbranch_scc0 Lm_mc_59
    s_cmp_eq_u32 s12, 3
    s_cbranch_scc0 Lm_mc_59
    s_sub_u32 s32, s38, 4096
    s_mov_b64 exec, 1
    buffer_store_dword v0, v1, s[4:7], s32 offen sc1
    s_mov_b64 exec, -1
    s_nop 3
Lm_mc_59:
    s_waitcnt lgkmcnt(0)
    v_smfmac_f32_16x16x64_bf16 v[44:47], v[40:43], a[48:55], v3
    v_smfmac_f32_16x16x64_bf16 v[52:55], v[16:19], a[112:119], v3
    v_smfmac_f32_16x16x64_bf16 v[52:55], v[20:23], a[120:127], v3
    s_waitcnt lgkmcnt(4)
    v_smfmac_f32_16x16x64_bf16 v[68:71], v[16:19], v[76:83], v3
    ds_read_b128 v[76:79], v7 offset:10240
    ds_read_b128 v[80:83], v7 offset:11264
    v_smfmac_f32_16x16x64_bf16 v[52:55], v[24:27], a[128:135], v3
    buffer_load_dwordx4 v[100:103], v6, s[4:7], s29 offen offset:0
    v_smfmac_f32_16x16x64_bf16 v[52:55], v[28:31], a[136:143], v3
    s_waitcnt lgkmcnt(4)
    v_smfmac_f32_16x16x64_bf16 v[68:71], v[20:23], v[84:91], v3
    ds_read_b128 v[84:87], v7 offset:12288
    ds_read_b128 v[88:91], v7 offset:13312
    v_smfmac_f32_16x16x64_bf16 v[52:55], v[32:35], a[144:151], v3
    v_smfmac_f32_16x16x64_bf16 v[52:55], v[36:39], a[152:159], v3
    buffer_load_dwordx4 v[108:111], v6, s[4:7], s29 offen offset:1024
    s_waitcnt lgkmcnt(4)
    v_smfmac_f32_16x16x64_bf16 v[68:71], v[24:27], v[92:99], v3
    ds_read_b128 v[92:95], v7 offset:14336
    ds_read_b128 v[96:99], v7 offset:15360
    v_smfmac_f32_16x16x64_bf16 v[52:55], v[40:43], a[160:167], v3
    v_smfmac_f32_16x16x64_bf16 v[60:63], v[16:19], a[224:231], v3
    s_waitcnt lgkmcnt(4)
    v_smfmac_f32_16x16x64_bf16 v[68:71], v[28:31], v[76:83], v3
    buffer_load_dwordx4 v[116:119], v6, s[4:7], s29 offen offset:2048
    ds_read_b128 v[76:79], v7 offset:16384
    ds_read_b128 v[80:83], v7 offset:17408
    v_smfmac_f32_16x16x64_bf16 v[60:63], v[20:23], a[232:239], v3
    v_smfmac_f32_16x16x64_bf16 v[60:63], v[24:27], a[240:247], v3
    s_waitcnt lgkmcnt(4)
    v_smfmac_f32_16x16x64_bf16 v[68:71], v[32:35], v[84:91], v3
    ds_read_b128 v[84:87], v7 offset:18432
    ds_read_b128 v[88:91], v7 offset:19456
    v_smfmac_f32_16x16x64_bf16 v[60:63], v[28:31], a[248:255], v3
    buffer_load_dwordx4 v[124:127], v6, s[4:7], s29 offen offset:3072
    v_smfmac_f32_16x16x64_bf16 v[60:63], v[32:35], v[192:199], v3
    s_waitcnt lgkmcnt(4)
    v_smfmac_f32_16x16x64_bf16 v[68:71], v[36:39], v[92:99], v3
    ds_read_b128 v[92:95], v7 offset:20480
    ds_read_b128 v[96:99], v7 offset:21504
    v_smfmac_f32_16x16x64_bf16 v[60:63], v[36:39], v[200:207], v3
    v_permlane32_swap_b32 v44, v52
    v_permlane32_swap_b32 v45, v53
    v_permlane32_swap_b32 v46, v54
    v_smfmac_f32_16x16x64_bf16 v[60:63], v[40:43], v[208:215], v3
    buffer_load_dwordx4 v[104:107], v6, s[4:7], s34 offen offset:0
    v_permlane32_swap_b32 v47, v55
    v_add_f32 v44, v44, v52
    v_add_f32 v45, v45, v53
    s_waitcnt lgkmcnt(4)
    v_smfmac_f32_16x16x64_bf16 v[68:71], v[40:43], v[76:83], v3
    ds_read_b128 v[76:79], v7 offset:22528
    ds_read_b128 v[80:83], v7 offset:23552
    v_add_f32 v46, v46, v54
    v_add_f32 v47, v47, v55
    v_cvt_pk_bf16_f32 v152, v44, v45
    v_smfmac_f32_16x16x64_bf16 v[48:51], v[16:19], a[56:63], v3
    v_cvt_pk_bf16_f32 v153, v46, v47
    v_smfmac_f32_16x16x64_bf16 v[48:51], v[20:23], a[64:71], v3
    s_waitcnt lgkmcnt(4)
    v_smfmac_f32_16x16x64_bf16 v[72:75], v[16:19], v[84:91], v3
    buffer_load_dwordx4 v[112:115], v6, s[4:7], s34 offen offset:1024
    ds_read_b128 v[84:87], v7 offset:24576
    ds_read_b128 v[88:91], v7 offset:25600
    v_smfmac_f32_16x16x64_bf16 v[48:51], v[24:27], a[72:79], v3
    v_smfmac_f32_16x16x64_bf16 v[48:51], v[28:31], a[80:87], v3
    s_waitcnt lgkmcnt(4)
    v_smfmac_f32_16x16x64_bf16 v[72:75], v[20:23], v[92:99], v3
    ds_read_b128 v[92:95], v7 offset:26624
    ds_read_b128 v[96:99], v7 offset:27648
    v_smfmac_f32_16x16x64_bf16 v[48:51], v[32:35], a[88:95], v3
    buffer_load_dwordx4 v[120:123], v6, s[4:7], s34 offen offset:2048
    v_smfmac_f32_16x16x64_bf16 v[48:51], v[36:39], a[96:103], v3
    s_waitcnt lgkmcnt(4)
    v_smfmac_f32_16x16x64_bf16 v[72:75], v[24:27], v[76:83], v3
    ds_read_b128 v[76:79], v7 offset:28672
    ds_read_b128 v[80:83], v7 offset:29696
    v_permlane32_swap_b32 v60, v68
    v_permlane32_swap_b32 v61, v69
    v_permlane32_swap_b32 v62, v70
    v_smfmac_f32_16x16x64_bf16 v[48:51], v[40:43], a[104:111], v3
    v_permlane32_swap_b32 v63, v71
    v_add_f32 v60, v60, v68
    v_add_f32 v61, v61, v69
    v_smfmac_f32_16x16x64_bf16 v[56:59], v[16:19], a[168:175], v3
    buffer_load_dwordx4 v[128:131], v6, s[4:7], s34 offen offset:3072
    v_add_f32 v62, v62, v70
    v_add_f32 v63, v63, v71
    v_cvt_pk_bf16_f32 v154, v60, v61
    s_waitcnt lgkmcnt(4)
    v_smfmac_f32_16x16x64_bf16 v[72:75], v[28:31], v[84:91], v3
    ds_read_b128 v[84:87], v7 offset:30720
    ds_read_b128 v[88:91], v7 offset:31744
    v_cvt_pk_bf16_f32 v155, v62, v63
    v_smfmac_f32_16x16x64_bf16 v[56:59], v[20:23], a[176:183], v3
    v_smfmac_f32_16x16x64_bf16 v[56:59], v[24:27], a[184:191], v3
    s_waitcnt lgkmcnt(4)
    v_smfmac_f32_16x16x64_bf16 v[72:75], v[32:35], v[92:99], v3
    buffer_load_dwordx4 v[12:15], v1, s[4:7], s35 offen sc1
    ds_read_b128 v[92:95], v7 offset:0
    ds_read_b128 v[96:99], v7 offset:1024
    v_smfmac_f32_16x16x64_bf16 v[56:59], v[28:31], a[192:199], v3
    v_smfmac_f32_16x16x64_bf16 v[56:59], v[32:35], a[200:207], v3
    s_waitcnt lgkmcnt(4)
    v_smfmac_f32_16x16x64_bf16 v[72:75], v[36:39], v[76:83], v3
    ds_read_b128 v[76:79], v7 offset:2048
    ds_read_b128 v[80:83], v7 offset:3072
    v_smfmac_f32_16x16x64_bf16 v[56:59], v[36:39], a[208:215], v3
    v_smfmac_f32_16x16x64_bf16 v[56:59], v[40:43], a[216:223], v3
    s_waitcnt lgkmcnt(4)
    v_smfmac_f32_16x16x64_bf16 v[72:75], v[40:43], v[84:91], v3
    v_smfmac_f32_16x16x64_bf16 v[64:67], v[16:19], v[216:223], v3
    v_smfmac_f32_16x16x64_bf16 v[64:67], v[20:23], v[224:231], v3
    s_waitcnt lgkmcnt(2)
    v_smfmac_f32_16x16x64_bf16 v[64:67], v[36:39], v[92:99], v3
    v_smfmac_f32_16x16x64_bf16 v[64:67], v[24:27], v[232:239], v3
    v_smfmac_f32_16x16x64_bf16 v[64:67], v[28:31], v[240:247], v3
    s_waitcnt lgkmcnt(0)
    v_smfmac_f32_16x16x64_bf16 v[64:67], v[40:43], v[76:83], v3
    v_smfmac_f32_16x16x64_bf16 v[64:67], v[32:35], v[248:255], v3
    s_nop 7
    v_permlane32_swap_b32 v48, v56
    v_permlane32_swap_b32 v49, v57
    v_permlane32_swap_b32 v50, v58
    v_permlane32_swap_b32 v51, v59
    v_add_f32 v48, v48, v56
    v_add_f32 v49, v49, v57
    v_add_f32 v50, v50, v58
    v_add_f32 v51, v51, v59
    v_cvt_pk_bf16_f32 v156, v48, v49
    v_cvt_pk_bf16_f32 v157, v50, v51
    v_permlane32_swap_b32 v64, v72
    v_permlane32_swap_b32 v65, v73
    v_permlane32_swap_b32 v66, v74
    v_permlane32_swap_b32 v67, v75
    v_add_f32 v64, v64, v72
    v_add_f32 v65, v65, v73
    v_add_f32 v66, v66, v74
    v_add_f32 v67, v67, v75
    v_cvt_pk_bf16_f32 v158, v64, v65
    v_cvt_pk_bf16_f32 v159, v66, v67
    s_cmp_eq_u32 s14, 63
    s_cbranch_scc0 Lm_v_cont_f
    s_add_u32 s33, s30, 0
    s_add_u32 s32, s30, 4096
    buffer_store_dwordx4 v[152:155], v6, s[4:7], s33 offen sc1
    buffer_store_dwordx4 v[156:159], v6, s[4:7], s32 offen sc1
    s_waitcnt vmcnt(0)
    s_barrier
    s_cmp_eq_u32 s12, 0
    s_cbranch_scc0 Lm_fin
    s_sub_u32 s32, s38, 2048
    s_mov_b64 exec, 1
    buffer_store_dword v0, v1, s[4:7], s32 offen sc1
    buffer_store_dword v0, v1, s[4:7], s38 offen sc1
    s_mov_b64 exec, -1
    s_branch Lm_fin
Lm_v_cont_f:
    s_sleep 4
    s_mov_b32 s21, 0
    buffer_load_dwordx4 v[132:135], v8, s[4:7], s26 offen sc1
    buffer_load_dwordx4 v[136:139], v8, s[4:7], s26 offen offset:1024 sc1
    buffer_load_dwordx2 v[140:141], v187, s[4:7], s27 offen sc1
    s_sleep 3
    buffer_load_dwordx4 v[44:47], v8, s[4:7], s26 offen sc1
    buffer_load_dwordx4 v[48:51], v8, s[4:7], s26 offen offset:1024 sc1
    buffer_load_dwordx2 v[52:53], v187, s[4:7], s27 offen sc1
Lm_p2_60:
    s_waitcnt vmcnt(3)
    v_max3_u32 v176, v132, v133, v134
    v_max3_u32 v177, v135, v136, v137
    v_max3_u32 v176, v176, v138, v139
    v_max3_u32 v177, v177, v140, v141
    v_max_u32 v176, v176, v177
    v_cmp_eq_u32 vcc, -1, v176
    s_cbranch_vccz Lm_p2_60_ok0
    buffer_load_dwordx4 v[132:135], v8, s[4:7], s26 offen sc1
    buffer_load_dwordx4 v[136:139], v8, s[4:7], s26 offen offset:1024 sc1
    buffer_load_dwordx2 v[140:141], v187, s[4:7], s27 offen sc1
    s_waitcnt vmcnt(3)
    v_max3_u32 v176, v44, v45, v46
    v_max3_u32 v177, v47, v48, v49
    v_max3_u32 v176, v176, v50, v51
    v_max3_u32 v177, v177, v52, v53
    v_max_u32 v176, v176, v177
    v_cmp_eq_u32 vcc, -1, v176
    s_cbranch_vccz Lm_p2_60_ok1
    buffer_load_dwordx4 v[44:47], v8, s[4:7], s26 offen sc1
    buffer_load_dwordx4 v[48:51], v8, s[4:7], s26 offen offset:1024 sc1
    buffer_load_dwordx2 v[52:53], v187, s[4:7], s27 offen sc1
    s_add_u32 s21, s21, 1
    s_cmp_lt_u32 s21, 400000
    s_cbranch_scc1 Lm_p2_60
    s_mov_b32 s22, 1
Lm_p2_60_ok0:
    v_mfma_f32_16x16x32_bf16 v[160:163], v[100:103], v[132:135], 0
    v_mov_b32_dpp v142, v132 row_ror:8 row_mask:0xf bank_mask:0xf
    v_mov_b32_dpp v143, v133 row_ror:8 row_mask:0xf bank_mask:0xf
    v_mov_b32_dpp v144, v134 row_ror:8 row_mask:0xf bank_mask:0xf
    v_mfma_f32_16x16x32_bf16 v[164:167], v[104:107], v[132:135], 0
    v_mov_b32_dpp v145, v135 row_ror:8 row_mask:0xf bank_mask:0xf
    v_mov_b32_dpp v146, v136 row_ror:8 row_mask:0xf bank_mask:0xf
    v_mov_b32_dpp v147, v137 row_ror:8 row_mask:0xf bank_mask:0xf
    v_mfma_f32_16x16x32_bf16 v[160:163], v[116:119], v[136:139], v[160:163]
    v_mov_b32_dpp v148, v138 row_ror:8 row_mask:0xf bank_mask:0xf
    v_mov_b32_dpp v149, v139 row_ror:8 row_mask:0xf bank_mask:0xf
    v_mov_b32 v188, v140
    v_mfma_f32_16x16x32_bf16 v[164:167], v[120:123], v[136:139], v[164:167]
    v_mov_b32 v189, v141
    v_mov_b32_dpp v190, v140 row_ror:8 row_mask:0xf bank_mask:0xf
    v_mov_b32_dpp v191, v141 row_ror:8 row_mask:0xf bank_mask:0xf
    v_mfma_f32_16x16x32_bf16 v[160:163], v[108:111], v[142:145], v[160:163]
    v_mfma_f32_16x16x32_bf16 v[164:167], v[112:115], v[142:145], v[164:167]
    v_mfma_f32_16x16x32_bf16 v[160:163], v[124:127], v[146:149], v[160:163]
    v_mfma_f32_16x16x32_bf16 v[164:167], v[128:131], v[146:149], v[164:167]
    v_mfma_f32_16x16x32_bf16 v[160:163], v[152:155], v[188:191], v[160:163]
    v_mfma_f32_16x16x32_bf16 v[164:167], v[156:159], v[188:191], v[164:167]
    s_branch Lm_p2_60_done
Lm_p2_60_ok1:
    v_mfma_f32_16x16x32_bf16 v[160:163], v[100:103], v[44:47], 0
    v_mov_b32_dpp v142, v44 row_ror:8 row_mask:0xf bank_mask:0xf
    v_mov_b32_dpp v143, v45 row_ror:8 row_mask:0xf bank_mask:0xf
    v_mov_b32_dpp v144, v46 row_ror:8 row_mask:0xf bank_mask:0xf
    v_mfma_f32_16x16x32_bf16 v[164:167], v[104:107], v[44:47], 0
    v_mov_b32_dpp v145, v47 row_ror:8 row_mask:0xf bank_mask:0xf
    v_mov_b32_dpp v146, v48 row_ror:8 row_mask:0xf bank_mask:0xf
    v_mov_b32_dpp v147, v49 row_ror:8 row_mask:0xf bank_mask:0xf
    v_mfma_f32_16x16x32_bf16 v[160:163], v[116:119], v[48:51], v[160:163]
    v_mov_b32_dpp v148, v50 row_ror:8 row_mask:0xf bank_mask:0xf
    v_mov_b32_dpp v149, v51 row_ror:8 row_mask:0xf bank_mask:0xf
    v_mov_b32 v188, v52
    v_mfma_f32_16x16x32_bf16 v[164:167], v[120:123], v[48:51], v[164:167]
    v_mov_b32 v189, v53
    v_mov_b32_dpp v190, v52 row_ror:8 row_mask:0xf bank_mask:0xf
    v_mov_b32_dpp v191, v53 row_ror:8 row_mask:0xf bank_mask:0xf
    v_mfma_f32_16x16x32_bf16 v[160:163], v[108:111], v[142:145], v[160:163]
    v_mfma_f32_16x16x32_bf16 v[164:167], v[112:115], v[142:145], v[164:167]
    v_mfma_f32_16x16x32_bf16 v[160:163], v[124:127], v[146:149], v[160:163]
    v_mfma_f32_16x16x32_bf16 v[164:167], v[128:131], v[146:149], v[164:167]
    v_mfma_f32_16x16x32_bf16 v[160:163], v[152:155], v[188:191], v[160:163]
    v_mfma_f32_16x16x32_bf16 v[164:167], v[156:159], v[188:191], v[164:167]
Lm_p2_60_done:
    s_nop 7
    ds_write_b128 v9, v[160:163]
    ds_write_b128 v9, v[164:167] offset:1024
    s_waitcnt lgkmcnt(0)
    s_barrier
    s_cmp_lt_u32 s12, 2
    s_cbranch_scc0 Lm_v_nored_f
    ds_read_b128 v[76:79], v10 offset:0
    ds_read_b128 v[80:83], v10 offset:2048
    ds_read_b128 v[84:87], v10 offset:4096
    ds_read_b128 v[88:91], v10 offset:6144
    s_waitcnt lgkmcnt(2)
    v_pk_add_f32 v[76:77], v[76:77], v[80:81]
    v_pk_add_f32 v[78:79], v[78:79], v[82:83]
    s_waitcnt lgkmcnt(0)
    v_pk_add_f32 v[84:85], v[84:85], v[88:89]
    v_pk_add_f32 v[86:87], v[86:87], v[90:91]
    v_pk_add_f32 v[76:77], v[76:77], v[84:85]
    v_pk_add_f32 v[78:79], v[78:79], v[86:87]
    v_cvt_pk_bf16_f32 v180, v76, v77
    v_cvt_pk_bf16_f32 v181, v78, v79
    s_mov_b32 exec_lo, 0x00ff00ff
    s_mov_b32 exec_hi, 0x00ff00ff
    buffer_store_dwordx2 v[180:181], v11, s[4:7], s31 offen
    s_cmp_eq_u32 s14, 62
    s_cbranch_scc0 Lm_mxe_61
    buffer_store_dwordx2 v[180:181], v11, s[4:7], s39 offen sc1
Lm_mxe_61:
    s_mov_b64 exec, -1
Lm_v_nored_f:
    s_barrier
    s_cmp_lt_u32 s12, 2
    s_cbranch_scc1 Lm_vw_62
    s_waitcnt vmcnt(0)
    s_branch Lm_vw_62_e
Lm_vw_62:
    s_waitcnt vmcnt(1)
Lm_vw_62_e:
    v_mov_b32 v44, 0
    v_mov_b32 v45, 0
    v_mov_b32 v46, 0
    v_mov_b32 v47, 0
    v_mov_b32 v48, 0
    v_mov_b32 v49, 0
    v_mov_b32 v50, 0
    v_mov_b32 v51, 0
    v_mov_b32 v52, 0
    v_mov_b32 v53, 0
    v_mov_b32 v54, 0
    v_mov_b32 v55, 0
    v_mov_b32 v56, 0
    v_mov_b32 v57, 0
    v_mov_b32 v58, 0
    v_mov_b32 v59, 0
    v_mov_b32 v60, 0
    v_mov_b32 v61, 0
    v_mov_b32 v62, 0
    v_mov_b32 v63, 0
    v_mov_b32 v64, 0
    v_mov_b32 v65, 0
    v_mov_b32 v66, 0
    v_mov_b32 v67, 0
    v_mov_b32 v68, 0
    v_mov_b32 v69, 0
    v_mov_b32 v70, 0
    v_mov_b32 v71, 0
    v_mov_b32 v72, 0
    v_mov_b32 v73, 0
    v_mov_b32 v74, 0
    v_mov_b32 v75, 0
    s_add_u32 s14, s14, 1
    s_add_u32 s15, s15, 7168
    s_add_u32 s31, s31, 7168
    s_add_u32 s26, s26, 8192
    s_add_u32 s27, s27, 2048
    s_add_u32 s29, s29, 458752
    s_add_u32 s30, s30, 114688
    s_add_u32 s37, s37, 64
    s_add_u32 s38, s38, 2048
    s_add_u32 s39, s39, 7168
    s_cmp_eq_u32 s22, 0
    s_cbranch_scc1 Lm_vstep_f
    s_branch Lm_fin
Lm_slowteam:
    s_cmp_ge_u32 s13, 16
    s_cbranch_scc1 Lm_value_s
    v_and_b32 v16, 15, v1
    v_lshrrev_b32 v17, 4, v1
    v_and_b32 v18, 12, v16
    v_and_b32 v19, 1, v16
    v_lshlrev_b32 v19, 1, v19
    v_bfe_u32 v20, v16, 1, 1
    v_or_b32 v18, v18, v19
    v_or_b32 v18, v18, v20
    v_mul_u32_u24 v21, 896, v18
    v_lshlrev_b32 v22, 5, v17
    v_add_u32 v21, v21, v22
    s_mul_i32 s32, s13, 401408
    s_mul_i32 s33, s12, 100352
    s_add_u32 s32, s32, s33
    s_add_u32 s32, s32, 0
    buffer_load_dwordx4 a[0:3], v21, s[4:7], s32 offen offset:0
    buffer_load_dwordx4 a[4:7], v21, s[4:7], s32 offen offset:16
    buffer_load_dwordx4 a[8:11], v21, s[4:7], s32 offen offset:128
    buffer_load_dwordx4 a[12:15], v21, s[4:7], s32 offen offset:144
    buffer_load_dwordx4 a[16:19], v21, s[4:7], s32 offen offset:256
    buffer_load_dwordx4 a[20:23], v21, s[4:7], s32 offen offset:272
    buffer_load_dwordx4 a[24:27], v21, s[4:7], s32 offen offset:384
    buffer_load_dwordx4 a[28:31], v21, s[4:7], s32 offen offset:400
    buffer_load_dwordx4 a[32:35], v21, s[4:7], s32 offen offset:512
    buffer_load_dwordx4 a[36:39], v21, s[4:7], s32 offen offset:528
    buffer_load_dwordx4 a[40:43], v21, s[4:7], s32 offen offset:640
    buffer_load_dwordx4 a[44:47], v21, s[4:7], s32 offen offset:656
    buffer_load_dwordx4 a[48:51], v21, s[4:7], s32 offen offset:768
    buffer_load_dwordx4 a[52:55], v21, s[4:7], s32 offen offset:784
    s_add_u32 s32, s32, 14336
    buffer_load_dwordx4 a[56:59], v21, s[4:7], s32 offen offset:0
    buffer_load_dwordx4 a[60:63], v21, s[4:7], s32 offen offset:16
    buffer_load_dwordx4 a[64:67], v21, s[4:7], s32 offen offset:128
    buffer_load_dwordx4 a[68:71], v21, s[4:7], s32 offen offset:144
    buffer_load_dwordx4 a[72:75], v21, s[4:7], s32 offen offset:256
    buffer_load_dwordx4 a[76:79], v21, s[4:7], s32 offen offset:272
    buffer_load_dwordx4 a[80:83], v21, s[4:7], s32 offen offset:384
    buffer_load_dwordx4 a[84:87], v21, s[4:7], s32 offen offset:400
    buffer_load_dwordx4 a[88:91], v21, s[4:7], s32 offen offset:512
    buffer_load_dwordx4 a[92:95], v21, s[4:7], s32 offen offset:528
    buffer_load_dwordx4 a[96:99], v21, s[4:7], s32 offen offset:640
    buffer_load_dwordx4 a[100:103], v21, s[4:7], s32 offen offset:656
    buffer_load_dwordx4 a[104:107], v21, s[4:7], s32 offen offset:768
    buffer_load_dwordx4 a[108:111], v21, s[4:7], s32 offen offset:784
    s_add_u32 s32, s32, 14336
    buffer_load_dwordx4 a[112:115], v21, s[4:7], s32 offen offset:0
    buffer_load_dwordx4 a[116:119], v21, s[4:7], s32 offen offset:16
    buffer_load_dwordx4 a[120:123], v21, s[4:7], s32 offen offset:128
    buffer_load_dwordx4 a[124:127], v21, s[4:7], s32 offen offset:144
    s_waitcnt vmcnt(24)
    buffer_load_dwordx4 a[128:131], v21, s[4:7], s32 offen offset:256
    buffer_load_dwordx4 a[132:135], v21, s[4:7], s32 offen offset:272
    buffer_load_dwordx4 a[136:139], v21, s[4:7], s32 offen offset:384
    buffer_load_dwordx4 a[140:143], v21, s[4:7], s32 offen offset:400
    buffer_load_dwordx4 a[144:147], v21, s[4:7], s32 offen offset:512
    buffer_load_dwordx4 a[148:151], v21, s[4:7], s32 offen offset:528
    buffer_load_dwordx4 a[152:155], v21, s[4:7], s32 offen offset:640
    buffer_load_dwordx4 a[156:159], v21, s[4:7], s32 offen offset:656
    buffer_load_dwordx4 a[160:163], v21, s[4:7], s32 offen offset:768
    buffer_load_dwordx4 a[164:167], v21, s[4:7], s32 offen offset:784
    s_add_u32 s32, s32, 14336
    buffer_load_dwordx4 a[168:171], v21, s[4:7], s32 offen offset:0
    buffer_load_dwordx4 a[172:175], v21, s[4:7], s32 offen offset:16
    buffer_load_dwordx4 a[176:179], v21, s[4:7], s32 offen offset:128
    buffer_load_dwordx4 a[180:183], v21, s[4:7], s32 offen offset:144
    buffer_load_dwordx4 a[184:187], v21, s[4:7], s32 offen offset:256
    buffer_load_dwordx4 a[188:191], v21, s[4:7], s32 offen offset:272
    buffer_load_dwordx4 a[192:195], v21, s[4:7], s32 offen offset:384
    buffer_load_dwordx4 a[196:199], v21, s[4:7], s32 offen offset:400
    buffer_load_dwordx4 a[200:203], v21, s[4:7], s32 offen offset:512
    buffer_load_dwordx4 a[204:207], v21, s[4:7], s32 offen offset:528
    buffer_load_dwordx4 a[208:211], v21, s[4:7], s32 offen offset:640
    buffer_load_dwordx4 a[212:215], v21, s[4:7], s32 offen offset:656
    buffer_load_dwordx4 a[216:219], v21, s[4:7], s32 offen offset:768
    buffer_load_dwordx4 a[220:223], v21, s[4:7], s32 offen offset:784
    s_add_u32 s32, s32, 14336
    buffer_load_dwordx4 a[224:227], v21, s[4:7], s32 offen offset:0
    buffer_load_dwordx4 a[228:231], v21, s[4:7], s32 offen offset:16
    buffer_load_dwordx4 a[232:235], v21, s[4:7], s32 offen offset:128
    buffer_load_dwordx4 a[236:239], v21, s[4:7], s32 offen offset:144
    buffer_load_dwordx4 a[240:243], v21, s[4:7], s32 offen offset:256
    buffer_load_dwordx4 a[244:247], v21, s[4:7], s32 offen offset:272
    buffer_load_dwordx4 a[248:251], v21, s[4:7], s32 offen offset:384
    buffer_load_dwordx4 a[252:255], v21, s[4:7], s32 offen offset:400
    s_waitcnt vmcnt(24)
    buffer_load_dwordx4 v[120:123], v21, s[4:7], s32 offen offset:512
    buffer_load_dwordx4 v[124:127], v21, s[4:7], s32 offen offset:528
    buffer_load_dwordx4 v[128:131], v21, s[4:7], s32 offen offset:640
    buffer_load_dwordx4 v[132:135], v21, s[4:7], s32 offen offset:656
    buffer_load_dwordx4 v[136:139], v21, s[4:7], s32 offen offset:768
    buffer_load_dwordx4 v[140:143], v21, s[4:7], s32 offen offset:784
    s_add_u32 s32, s32, 14336
    buffer_load_dwordx4 v[144:147], v21, s[4:7], s32 offen offset:0
    buffer_load_dwordx4 v[148:151], v21, s[4:7], s32 offen offset:16
    buffer_load_dwordx4 v[152:155], v21, s[4:7], s32 offen offset:128
    buffer_load_dwordx4 v[156:159], v21, s[4:7], s32 offen offset:144
    buffer_load_dwordx4 v[160:163], v21, s[4:7], s32 offen offset:256
    buffer_load_dwordx4 v[164:167], v21, s[4:7], s32 offen offset:272
    buffer_load_dwordx4 v[168:171], v21, s[4:7], s32 offen offset:384
    buffer_load_dwordx4 v[172:175], v21, s[4:7], s32 offen offset:400
    buffer_load_dwordx4 v[176:179], v21, s[4:7], s32 offen offset:512
    buffer_load_dwordx4 v[180:183], v21, s[4:7], s32 offen offset:528
    buffer_load_dwordx4 v[184:187], v21, s[4:7], s32 offen offset:640
    buffer_load_dwordx4 v[188:191], v21, s[4:7], s32 offen offset:656
    buffer_load_dwordx4 v[192:195], v21, s[4:7], s32 offen offset:768
    buffer_load_dwordx4 v[196:199], v21, s[4:7], s32 offen offset:784
    s_add_u32 s32, s32, 14336
    buffer_load_dwordx4 v[200:203], v21, s[4:7], s32 offen offset:0
    buffer_load_dwordx4 v[204:207], v21, s[4:7], s32 offen offset:16
    buffer_load_dwordx4 v[208:211], v21, s[4:7], s32 offen offset:128
    buffer_load_dwordx4 v[212:215], v21, s[4:7], s32 offen offset:144
    buffer_load_dwordx4 v[216:219], v21, s[4:7], s32 offen offset:256
    buffer_load_dwordx4 v[220:223], v21, s[4:7], s32 offen offset:272
    buffer_load_dwordx4 v[224:227], v21, s[4:7], s32 offen offset:384
    buffer_load_dwordx4 v[228:231], v21, s[4:7], s32 offen offset:400
    buffer_load_dwordx4 v[232:235], v21, s[4:7], s32 offen offset:512
    buffer_load_dwordx4 v[236:239], v21, s[4:7], s32 offen offset:528
    buffer_load_dwordx4 v[240:243], v21, s[4:7], s32 offen offset:640
    buffer_load_dwordx4 v[244:247], v21, s[4:7], s32 offen offset:656
    s_waitcnt vmcnt(24)
    buffer_load_dwordx4 v[248:251], v21, s[4:7], s32 offen offset:768
    buffer_load_dwordx4 v[252:255], v21, s[4:7], s32 offen offset:784
    s_add_u32 s32, s32, 14336
    v_lshlrev_b32 v7, 4, v16
    v_and_b32 v22, 1, v17
    v_lshlrev_b32 v22, 3, v22
    v_add_u32 v7, v7, v22
    s_mul_i32 s33, s12, 1792
    s_add_u32 s33, s33, 8192
    v_add_u32 v8, s33, v7
    v_lshrrev_b32 v22, 5, v1
    v_lshlrev_b32 v22, 8, v22
    v_add_u32 v7, v8, v22
    v_lshlrev_b32 v9, 8, v17
    v_lshlrev_b32 v22, 3, v16
    v_add_u32 v9, v9, v22
    v_add_u32 v9, 8192, v9
    v_lshlrev_b32 v10, 9, v17
    v_lshlrev_b32 v22, 4, v16
    v_add_u32 v10, v10, v22
    s_lshl_b32 s33, s12, 8
    s_add_u32 s33, s33, 20480
    v_add_u32 v10, s33, v10
    v_lshlrev_b32 v23, 7, v17
    v_and_b32 v22, 7, v16
    v_lshlrev_b32 v22, 4, v22
    v_add_u32 v23, v23, v22
    s_cmp_eq_u32 s12, 2
    s_cselect_b64 vcc, -1, 0
    s_nop 1
    v_cndmask_b32 v10, v10, v23, vcc
    v_and_b32 v22, 1, v17
    v_lshlrev_b32 v22, 2, v22
    v_lshrrev_b32 v23, 5, v1
    v_add_u32 v22, v22, v23
    v_mul_u32_u24 v11, 192, v22
    v_lshlrev_b32 v22, 2, v16
    v_add_u32 v11, v11, v22
    s_lshl_b32 s33, s12, 6
    s_add_u32 s33, s33, 15360
    v_add_u32 v11, s33, v11
    v_and_b32 v22, 7, v1
    v_lshrrev_b32 v23, 3, v1
    v_mul_u32_u24 v12, 192, v23
    v_add_u32 v12, 15360, v12
    v_lshlrev_b32 v24, 2, v22
    v_add_u32 v13, v12, v24
    v_add_u32 v13, 128, v13
    v_lshlrev_b32 v24, 4, v22
    v_add_u32 v12, v12, v24
    v_lshrrev_b32 v24, 1, v22
    v_lshlrev_b32 v24, 3, v24
    v_add_u32 v24, v24, v23
    v_lshlrev_b32 v14, 4, v24
    v_and_b32 v24, 1, v22
    v_lshlrev_b32 v24, 3, v24
    v_add_u32 v14, v14, v24
    v_lshlrev_b32 v15, 4, v23
    v_lshlrev_b32 v24, 1, v22
    v_add_u32 v15, v15, v24
    s_mov_b32 s14, 0
    s_mov_b32 s15, 16527360
    s_lshl_b32 s26, s13, 9
    s_add_u32 s26, s26, 16994304
    s_lshl_b32 s27, s13, 7
    s_add_u32 s27, s27, 17518592
    s_mov_b32 s28, 12845056
    s_waitcnt vmcnt(0)
    s_mov_b32 s99, 100196352
    v_lshrrev_b32 v80, 4, v6
    v_min_u32 v80, 63, v80
    v_lshlrev_b32 v80, 4, v80
    s_mov_b32 s21, 0
Lm_wf_63:
    buffer_load_dwordx4 v[84:87], v80, s[4:7], s99 offen sc1
    s_waitcnt vmcnt(0)
    v_xor_b32 v84, s97, v84
    v_xor_b32 v85, s97, v85
    v_xor_b32 v86, s97, v86
    v_xor_b32 v87, s97, v87
    v_or_b32 v84, v84, v85
    v_or_b32 v84, v84, v86
    v_or_b32 v84, v84, v87
    v_cmp_ne_u32 vcc, 0, v84
    s_cbranch_vccz Lm_wf_63_ok
    s_sleep 1
    s_add_u32 s21, s21, 1
    s_cmp_lt_u32 s21, 400000
    s_cbranch_scc1 Lm_wf_63
Lm_wf_63_ok:
    s_mov_b32 s99, 100198400
    v_lshrrev_b32 v80, 4, v6
    v_min_u32 v80, 63, v80
    v_lshlrev_b32 v80, 4, v80
    s_mov_b32 s21, 0
Lm_wf_64:
    buffer_load_dwordx4 v[84:87], v80, s[4:7], s99 offen sc1
    s_waitcnt vmcnt(0)
    v_xor_b32 v84, s97, v84
    v_xor_b32 v85, s97, v85
    v_xor_b32 v86, s97, v86
    v_xor_b32 v87, s97, v87
    v_or_b32 v84, v84, v85
    v_or_b32 v84, v84, v86
    v_or_b32 v84, v84, v87
    v_cmp_ne_u32 vcc, 0, v84
    s_cbranch_vccz Lm_wf_64_ok
    s_sleep 1
    s_add_u32 s21, s21, 1
    s_cmp_lt_u32 s21, 400000
    s_cbranch_scc1 Lm_wf_64
Lm_wf_64_ok:
    s_mul_i32 s32, s12, 7168
    s_add_u32 s33, s32, s28
    s_add_u32 s32, s32, 20480
    s_mov_b32 m0, s32
    s_nop 0
    buffer_load_dwordx4 v6, s[4:7], s33 offen offset:0 lds
    buffer_load_dwordx4 v6, s[4:7], s33 offen offset:1024 lds
    buffer_load_dwordx4 v6, s[4:7], s33 offen offset:2048 lds
    buffer_load_dwordx4 v6, s[4:7], s33 offen offset:3072 lds
    s_add_u32 s32, s32, 4096
    s_add_u32 s33, s33, 4096
    s_mov_b32 m0, s32
    s_nop 0
    buffer_load_dwordx4 v6, s[4:7], s33 offen offset:0 lds
    buffer_load_dwordx4 v6, s[4:7], s33 offen offset:1024 lds
    buffer_load_dwordx4 v6, s[4:7], s33 offen offset:2048 lds
    s_waitcnt vmcnt(0)
Lm_sstep_s:
    v_mov_b32 v44, 0
    v_mov_b32 v45, 0
    v_mov_b32 v46, 0
    v_mov_b32 v47, 0
    v_mov_b32 v48, 0
    v_mov_b32 v49, 0
    v_mov_b32 v50, 0
    v_mov_b32 v51, 0
    v_mov_b32 v52, 0
    v_mov_b32 v53, 0
    v_mov_b32 v54, 0
    v_mov_b32 v55, 0
    v_mov_b32 v56, 0
    v_mov_b32 v57, 0
    v_mov_b32 v58, 0
    v_mov_b32 v59, 0
    v_mov_b32 v60, 0
    v_mov_b32 v61, 0
    v_mov_b32 v62, 0
    v_mov_b32 v63, 0
    v_mov_b32 v64, 0
    v_mov_b32 v65, 0
    v_mov_b32 v66, 0
    v_mov_b32 v67, 0
    v_mov_b32 v68, 0
    v_mov_b32 v69, 0
    v_mov_b32 v70, 0
    v_mov_b32 v71, 0
    s_sleep 14
    s_mov_b32 s21, 0
    buffer_load_dwordx4 v[72:75], v4, s[4:7], s15 offen sc1
    buffer_load_dwordx4 v[76:79], v5, s[4:7], s15 offen sc1
    s_sleep 2
    buffer_load_dwordx4 v[84:87], v4, s[4:7], s15 offen sc1
    buffer_load_dwordx4 v[88:91], v5, s[4:7], s15 offen sc1
Lm_p2_65:
    s_waitcnt vmcnt(2)
    v_max3_u32 v80, v72, v73, v74
    v_max3_u32 v81, v75, v76, v77
    v_max3_u32 v80, v80, v78, v79
    v_max_u32 v80, v80, v81
    v_cmp_eq_u32 vcc, -1, v80
    s_cbranch_vccz Lm_p2_65_ok0
    buffer_load_dwordx4 v[72:75], v4, s[4:7], s15 offen sc1
    buffer_load_dwordx4 v[76:79], v5, s[4:7], s15 offen sc1
    s_waitcnt vmcnt(2)
    v_max3_u32 v80, v84, v85, v86
    v_max3_u32 v81, v87, v88, v89
    v_max3_u32 v80, v80, v90, v91
    v_max_u32 v80, v80, v81
    v_cmp_eq_u32 vcc, -1, v80
    s_cbranch_vccz Lm_p2_65_ok1
    buffer_load_dwordx4 v[84:87], v4, s[4:7], s15 offen sc1
    buffer_load_dwordx4 v[88:91], v5, s[4:7], s15 offen sc1
    s_add_u32 s21, s21, 1
    s_cmp_lt_u32 s21, 400000
    s_cbranch_scc1 Lm_p2_65
    s_mov_b32 s22, 1
Lm_p2_65_ok0:
    ds_write_b128 v4, v[72:75] offset:0
    ds_write_b128 v4, v[76:79] offset:4096
    s_branch Lm_p2_65_done
Lm_p2_65_ok1:
    ds_write_b128 v4, v[84:87] offset:0
    ds_write_b128 v4, v[88:91] offset:4096
Lm_p2_65_done:
    s_waitcnt lgkmcnt(0)
    s_barrier
    ds_read_b128 v[16:19], v6 offset:0
    ds_read_b128 v[20:23], v6 offset:1024
    ds_read_b128 v[24:27], v6 offset:2048
    ds_read_b128 v[28:31], v6 offset:3072
    ds_read_b128 v[32:35], v6 offset:4096
    ds_read_b128 v[36:39], v6 offset:5120
    ds_read_b128 v[40:43], v6 offset:6144
    s_cmp_eq_u32 s12, 2
    s_cbranch_scc1 Lm_t2_66
    s_waitcnt lgkmcnt(6)
    v_smfmac_f32_16x16x64_bf16 v[44:47], v[16:19], a[0:7], v3
    s_waitcnt lgkmcnt(5)
    v_smfmac_f32_16x16x64_bf16 v[44:47], v[20:23], a[8:15], v3
    s_waitcnt lgkmcnt(4)
    v_smfmac_f32_16x16x64_bf16 v[44:47], v[24:27], a[16:23], v3
    s_waitcnt lgkmcnt(3)
    v_smfmac_f32_16x16x64_bf16 v[44:47], v[28:31], a[24:31], v3
    s_waitcnt lgkmcnt(2)
    v_smfmac_f32_16x16x64_bf16 v[44:47], v[32:35], a[32:39], v3
    s_waitcnt lgkmcnt(1)
    v_smfmac_f32_16x16x64_bf16 v[44:47], v[36:39], a[40:47], v3
    s_waitcnt lgkmcnt(0)
    v_smfmac_f32_16x16x64_bf16 v[44:47], v[40:43], a[48:55], v3
    v_smfmac_f32_16x16x64_bf16 v[48:51], v[16:19], a[56:63], v3
    s_waitcnt vmcnt(0)
    v_smfmac_f32_16x16x64_bf16 v[48:51], v[20:23], a[64:71], v3
    ds_read_b128 v[72:75], v10 offset:0
    ds_read_b128 v[76:79], v10 offset:2048
    v_smfmac_f32_16x16x64_bf16 v[48:51], v[24:27], a[72:79], v3
    v_smfmac_f32_16x16x64_bf16 v[48:51], v[28:31], a[80:87], v3
    ds_read_b128 v[80:83], v10 offset:4096
    ds_read_b128 v[84:87], v10 offset:6144
    v_smfmac_f32_16x16x64_bf16 v[48:51], v[32:35], a[88:95], v3
    v_smfmac_f32_16x16x64_bf16 v[48:51], v[36:39], a[96:103], v3
    ds_read_b128 v[88:91], v10 offset:8192
    ds_read_b128 v[92:95], v10 offset:10240
    v_smfmac_f32_16x16x64_bf16 v[48:51], v[40:43], a[104:111], v3
    v_smfmac_f32_16x16x64_bf16 v[52:55], v[16:19], a[112:119], v3
    ds_read_b128 v[96:99], v10 offset:12288
    ds_read_b128 v[100:103], v10 offset:14336
    v_smfmac_f32_16x16x64_bf16 v[52:55], v[20:23], a[120:127], v3
    v_smfmac_f32_16x16x64_bf16 v[52:55], v[24:27], a[128:135], v3
    ds_read_b128 v[104:107], v10 offset:16384
    ds_read_b128 v[108:111], v10 offset:18432
    v_smfmac_f32_16x16x64_bf16 v[52:55], v[28:31], a[136:143], v3
    v_smfmac_f32_16x16x64_bf16 v[52:55], v[32:35], a[144:151], v3
    ds_read_b128 v[112:115], v10 offset:20480
    ds_read_b128 v[116:119], v10 offset:22528
    v_smfmac_f32_16x16x64_bf16 v[52:55], v[36:39], a[152:159], v3
    v_smfmac_f32_16x16x64_bf16 v[52:55], v[40:43], a[160:167], v3
    v_smfmac_f32_16x16x64_bf16 v[56:59], v[16:19], a[168:175], v3
    v_smfmac_f32_16x16x64_bf16 v[56:59], v[20:23], a[176:183], v3
    v_permlane32_swap_b32 v44, v48
    v_permlane32_swap_b32 v45, v49
    v_permlane32_swap_b32 v46, v50
    v_smfmac_f32_16x16x64_bf16 v[56:59], v[24:27], a[184:191], v3
    v_permlane32_swap_b32 v47, v51
    v_add_f32 v44, v44, v48
    v_add_f32 v45, v45, v49
    v_smfmac_f32_16x16x64_bf16 v[56:59], v[28:31], a[192:199], v3
    v_add_f32 v46, v46, v50
    v_add_f32 v47, v47, v51
    v_cvt_pk_bf16_f32 v48, v44, v45
    v_smfmac_f32_16x16x64_bf16 v[56:59], v[32:35], a[200:207], v3
    v_cvt_pk_bf16_f32 v49, v46, v47
    ds_write_b64 v7, v[48:49] offset:0
    v_smfmac_f32_16x16x64_bf16 v[56:59], v[36:39], a[208:215], v3
    v_smfmac_f32_16x16x64_bf16 v[56:59], v[40:43], a[216:223], v3
    v_smfmac_f32_16x16x64_bf16 v[60:63], v[16:19], a[224:231], v3
    v_smfmac_f32_16x16x64_bf16 v[60:63], v[20:23], a[232:239], v3
    v_smfmac_f32_16x16x64_bf16 v[60:63], v[24:27], a[240:247], v3
    v_smfmac_f32_16x16x64_bf16 v[60:63], v[28:31], a[248:255], v3
    v_smfmac_f32_16x16x64_bf16 v[60:63], v[32:35], v[120:127], v3
    v_smfmac_f32_16x16x64_bf16 v[60:63], v[36:39], v[128:135], v3
    v_smfmac_f32_16x16x64_bf16 v[60:63], v[40:43], v[136:143], v3
    v_smfmac_f32_16x16x64_bf16 v[64:67], v[16:19], v[144:151], v3
    v_smfmac_f32_16x16x64_bf16 v[68:71], v[16:19], v[200:207], v3
    v_permlane32_swap_b32 v52, v56
    v_permlane32_swap_b32 v53, v57
    v_permlane32_swap_b32 v54, v58
    v_smfmac_f32_16x16x64_bf16 v[64:67], v[20:23], v[152:159], v3
    v_permlane32_swap_b32 v55, v59
    v_add_f32 v52, v52, v56
    v_add_f32 v53, v53, v57
    v_smfmac_f32_16x16x64_bf16 v[68:71], v[20:23], v[208:215], v3
    v_add_f32 v54, v54, v58
    v_add_f32 v55, v55, v59
    v_cvt_pk_bf16_f32 v56, v52, v53
    v_smfmac_f32_16x16x64_bf16 v[64:67], v[24:27], v[160:167], v3
    v_cvt_pk_bf16_f32 v57, v54, v55
    ds_write_b64 v7, v[56:57] offset:512
    v_smfmac_f32_16x16x64_bf16 v[68:71], v[24:27], v[216:223], v3
    v_smfmac_f32_16x16x64_bf16 v[64:67], v[28:31], v[168:175], v3
    v_smfmac_f32_16x16x64_bf16 v[68:71], v[28:31], v[224:231], v3
    v_smfmac_f32_16x16x64_bf16 v[64:67], v[32:35], v[176:183], v3
    v_mov_b32 v44, v60
    v_mov_b32 v45, v61
    v_mov_b32 v46, v62
    v_smfmac_f32_16x16x64_bf16 v[68:71], v[32:35], v[232:239], v3
    v_mov_b32 v47, v63
    s_nop 0
    v_permlane32_swap_b32 v60, v44
    v_smfmac_f32_16x16x64_bf16 v[64:67], v[36:39], v[184:191], v3
    v_permlane32_swap_b32 v61, v45
    v_permlane32_swap_b32 v62, v46
    v_permlane32_swap_b32 v63, v47
    v_smfmac_f32_16x16x64_bf16 v[68:71], v[36:39], v[240:247], v3
    v_add_f32 v60, v60, v44
    v_add_f32 v61, v61, v45
    v_add_f32 v62, v62, v46
    v_smfmac_f32_16x16x64_bf16 v[64:67], v[40:43], v[192:199], v3
    v_add_f32 v63, v63, v47
    v_cvt_pk_bf16_f32 v44, v60, v61
    v_cvt_pk_bf16_f32 v45, v62, v63
    v_smfmac_f32_16x16x64_bf16 v[68:71], v[40:43], v[248:255], v3
    ds_write_b64 v8, v[44:45] offset:1024
    v_mov_b32 v52, 0
    v_mov_b32 v53, 0
    v_mov_b32 v54, 0
    v_mov_b32 v55, 0
    ds_read_b128 v[44:47], v10 offset:24576
    ds_read_b128 v[48:51], v10 offset:26624
    s_nop 1
    v_permlane32_swap_b32 v64, v68
    v_permlane32_swap_b32 v65, v69
    v_permlane32_swap_b32 v66, v70
    v_permlane32_swap_b32 v67, v71
    v_add_f32 v64, v64, v68
    v_add_f32 v65, v65, v69
    v_add_f32 v66, v66, v70
    v_add_f32 v67, v67, v71
    v_cvt_pk_bf16_f32 v68, v64, v65
    v_cvt_pk_bf16_f32 v69, v66, v67
    ds_write_b64 v7, v[68:69] offset:1280
    s_waitcnt lgkmcnt(0)
    s_barrier
    s_cmp_eq_u32 s12, 3
    s_cbranch_scc1 Lm_s_w3_s
    s_branch Lm_tj_67
Lm_t2_66:
    s_waitcnt lgkmcnt(6)
    v_smfmac_f32_16x16x64_bf16 v[44:47], v[16:19], a[0:7], v3
    s_waitcnt lgkmcnt(5)
    v_smfmac_f32_16x16x64_bf16 v[44:47], v[20:23], a[8:15], v3
    s_waitcnt lgkmcnt(4)
    v_smfmac_f32_16x16x64_bf16 v[44:47], v[24:27], a[16:23], v3
    s_waitcnt lgkmcnt(3)
    v_smfmac_f32_16x16x64_bf16 v[44:47], v[28:31], a[24:31], v3
    s_waitcnt lgkmcnt(2)
    v_smfmac_f32_16x16x64_bf16 v[44:47], v[32:35], a[32:39], v3
    s_waitcnt lgkmcnt(1)
    v_smfmac_f32_16x16x64_bf16 v[44:47], v[36:39], a[40:47], v3
    s_waitcnt lgkmcnt(0)
    v_smfmac_f32_16x16x64_bf16 v[44:47], v[40:43], a[48:55], v3
    v_smfmac_f32_16x16x64_bf16 v[48:51], v[16:19], a[56:63], v3
    s_waitcnt vmcnt(0)
    v_smfmac_f32_16x16x64_bf16 v[48:51], v[20:23], a[64:71], v3
    ds_read_b128 v[72:75], v10 offset:0
    ds_read_b128 v[76:79], v10 offset:512
    v_smfmac_f32_16x16x64_bf16 v[48:51], v[24:27], a[72:79], v3
    v_smfmac_f32_16x16x64_bf16 v[48:51], v[28:31], a[80:87], v3
    ds_read_b128 v[80:83], v10 offset:1024
    ds_read_b128 v[84:87], v10 offset:1536
    v_smfmac_f32_16x16x64_bf16 v[48:51], v[32:35], a[88:95], v3
    v_smfmac_f32_16x16x64_bf16 v[48:51], v[36:39], a[96:103], v3
    ds_read_b128 v[88:91], v10 offset:2048
    ds_read_b128 v[92:95], v10 offset:2560
    v_smfmac_f32_16x16x64_bf16 v[48:51], v[40:43], a[104:111], v3
    v_smfmac_f32_16x16x64_bf16 v[52:55], v[16:19], a[112:119], v3
    ds_read_b128 v[96:99], v10 offset:3072
    ds_read_b128 v[100:103], v10 offset:3584
    v_smfmac_f32_16x16x64_bf16 v[52:55], v[20:23], a[120:127], v3
    v_smfmac_f32_16x16x64_bf16 v[52:55], v[24:27], a[128:135], v3
    ds_read_b128 v[104:107], v10 offset:4096
    ds_read_b128 v[108:111], v10 offset:4608
    v_smfmac_f32_16x16x64_bf16 v[52:55], v[28:31], a[136:143], v3
    v_smfmac_f32_16x16x64_bf16 v[52:55], v[32:35], a[144:151], v3
    ds_read_b128 v[112:115], v10 offset:5120
    ds_read_b128 v[116:119], v10 offset:5632
    v_smfmac_f32_16x16x64_bf16 v[52:55], v[36:39], a[152:159], v3
    v_smfmac_f32_16x16x64_bf16 v[52:55], v[40:43], a[160:167], v3
    v_smfmac_f32_16x16x64_bf16 v[56:59], v[16:19], a[168:175], v3
    v_smfmac_f32_16x16x64_bf16 v[56:59], v[20:23], a[176:183], v3
    v_permlane32_swap_b32 v44, v48
    v_permlane32_swap_b32 v45, v49
    v_permlane32_swap_b32 v46, v50
    v_smfmac_f32_16x16x64_bf16 v[56:59], v[24:27], a[184:191], v3
    v_permlane32_swap_b32 v47, v51
    v_add_f32 v44, v44, v48
    v_add_f32 v45, v45, v49
    v_smfmac_f32_16x16x64_bf16 v[56:59], v[28:31], a[192:199], v3
    v_add_f32 v46, v46, v50
    v_add_f32 v47, v47, v51
    v_cvt_pk_bf16_f32 v48, v44, v45
    v_smfmac_f32_16x16x64_bf16 v[56:59], v[32:35], a[200:207], v3
    v_cvt_pk_bf16_f32 v49, v46, v47
    ds_write_b64 v7, v[48:49] offset:0
    v_smfmac_f32_16x16x64_bf16 v[56:59], v[36:39], a[208:215], v3
    v_smfmac_f32_16x16x64_bf16 v[56:59], v[40:43], a[216:223], v3
    v_smfmac_f32_16x16x64_bf16 v[60:63], v[16:19], a[224:231], v3
    v_smfmac_f32_16x16x64_bf16 v[60:63], v[20:23], a[232:239], v3
    v_smfmac_f32_16x16x64_bf16 v[60:63], v[24:27], a[240:247], v3
    v_smfmac_f32_16x16x64_bf16 v[60:63], v[28:31], a[248:255], v3
    v_smfmac_f32_16x16x64_bf16 v[60:63], v[32:35], v[120:127], v3
    v_smfmac_f32_16x16x64_bf16 v[60:63], v[36:39], v[128:135], v3
    v_smfmac_f32_16x16x64_bf16 v[60:63], v[40:43], v[136:143], v3
    v_smfmac_f32_16x16x64_bf16 v[64:67], v[16:19], v[144:151], v3
    v_smfmac_f32_16x16x64_bf16 v[68:71], v[16:19], v[200:207], v3
    v_permlane32_swap_b32 v52, v56
    v_permlane32_swap_b32 v53, v57
    v_permlane32_swap_b32 v54, v58
    v_smfmac_f32_16x16x64_bf16 v[64:67], v[20:23], v[152:159], v3
    v_permlane32_swap_b32 v55, v59
    v_add_f32 v52, v52, v56
    v_add_f32 v53, v53, v57
    v_smfmac_f32_16x16x64_bf16 v[68:71], v[20:23], v[208:215], v3
    v_add_f32 v54, v54, v58
    v_add_f32 v55, v55, v59
    v_cvt_pk_bf16_f32 v56, v52, v53
    v_smfmac_f32_16x16x64_bf16 v[64:67], v[24:27], v[160:167], v3
    v_cvt_pk_bf16_f32 v57, v54, v55
    ds_write_b64 v7, v[56:57] offset:512
    v_smfmac_f32_16x16x64_bf16 v[68:71], v[24:27], v[216:223], v3
    v_smfmac_f32_16x16x64_bf16 v[64:67], v[28:31], v[168:175], v3
    v_smfmac_f32_16x16x64_bf16 v[68:71], v[28:31], v[224:231], v3
    v_smfmac_f32_16x16x64_bf16 v[64:67], v[32:35], v[176:183], v3
    v_mov_b32 v44, v60
    v_mov_b32 v45, v61
    v_mov_b32 v46, v62
    v_smfmac_f32_16x16x64_bf16 v[68:71], v[32:35], v[232:239], v3
    v_mov_b32 v47, v63
    s_nop 0
    v_permlane32_swap_b32 v60, v44
    v_smfmac_f32_16x16x64_bf16 v[64:67], v[36:39], v[184:191], v3
    v_permlane32_swap_b32 v61, v45
    v_permlane32_swap_b32 v62, v46
    v_permlane32_swap_b32 v63, v47
    v_smfmac_f32_16x16x64_bf16 v[68:71], v[36:39], v[240:247], v3
    v_add_f32 v60, v60, v44
    v_add_f32 v61, v61, v45
    v_add_f32 v62, v62, v46
    v_smfmac_f32_16x16x64_bf16 v[64:67], v[40:43], v[192:199], v3
    v_add_f32 v63, v63, v47
    v_cvt_pk_bf16_f32 v44, v60, v61
    v_cvt_pk_bf16_f32 v45, v62, v63
    v_smfmac_f32_16x16x64_bf16 v[68:71], v[40:43], v[248:255], v3
    ds_write_b64 v8, v[44:45] offset:1024
    v_mov_b32 v52, 0
    v_mov_b32 v53, 0
    v_mov_b32 v54, 0
    v_mov_b32 v55, 0
    ds_read_b128 v[44:47], v10 offset:6144
    ds_read_b128 v[48:51], v10 offset:6656
    s_nop 1
    v_permlane32_swap_b32 v64, v68
    v_permlane32_swap_b32 v65, v69
    v_permlane32_swap_b32 v66, v70
    v_permlane32_swap_b32 v67, v71
    v_add_f32 v64, v64, v68
    v_add_f32 v65, v65, v69
    v_add_f32 v66, v66, v70
    v_add_f32 v67, v67, v71
    v_cvt_pk_bf16_f32 v68, v64, v65
    v_cvt_pk_bf16_f32 v69, v66, v67
    ds_write_b64 v7, v[68:69] offset:1280
    s_waitcnt lgkmcnt(0)
    s_barrier
Lm_tj_67:
    ds_read_b64_tr_b16 v[16:17], v9 offset:0
    ds_read_b64_tr_b16 v[18:19], v9 offset:128
    ds_read_b64_tr_b16 v[20:21], v9 offset:1024
    ds_read_b64_tr_b16 v[22:23], v9 offset:1152
    ds_read_b64_tr_b16 v[24:25], v9 offset:2048
    ds_read_b64_tr_b16 v[26:27], v9 offset:2176
    ds_read_b64_tr_b16 v[28:29], v9 offset:3072
    ds_read_b64_tr_b16 v[30:31], v9 offset:3200
    ds_read_b64_tr_b16 v[32:33], v9 offset:4096
    ds_read_b64_tr_b16 v[34:35], v9 offset:4224
    ds_read_b64_tr_b16 v[36:37], v9 offset:5120
    ds_read_b64_tr_b16 v[38:39], v9 offset:5248
    ds_read_b64_tr_b16 v[40:41], v9 offset:6144
    ds_read_b64_tr_b16 v[42:43], v9 offset:6272
    s_waitcnt lgkmcnt(12)
    v_smfmac_f32_16x16x64_bf16 v[52:55], v[16:19], v[72:79], v3
    s_waitcnt lgkmcnt(10)
    v_smfmac_f32_16x16x64_bf16 v[52:55], v[20:23], v[80:87], v3
    s_waitcnt lgkmcnt(8)
    v_smfmac_f32_16x16x64_bf16 v[52:55], v[24:27], v[88:95], v3
    s_waitcnt lgkmcnt(6)
    v_smfmac_f32_16x16x64_bf16 v[52:55], v[28:31], v[96:103], v3
    s_waitcnt lgkmcnt(4)
    v_smfmac_f32_16x16x64_bf16 v[52:55], v[32:35], v[104:111], v3
    s_waitcnt lgkmcnt(2)
    v_smfmac_f32_16x16x64_bf16 v[52:55], v[36:39], v[112:119], v3
    s_waitcnt lgkmcnt(0)
    v_smfmac_f32_16x16x64_bf16 v[52:55], v[40:43], v[44:51], v3
    s_nop 7
    v_permlane32_swap_b32 v52, v53
    v_permlane32_swap_b32 v54, v55
    v_add_f32 v52, v52, v53
    v_add_f32 v54, v54, v55
    ds_write_b32 v11, v52
    ds_write_b32 v11, v54 offset:384
    s_waitcnt lgkmcnt(0)
    s_barrier
    s_branch Lm_s_after_s
Lm_s_w3_s:
    s_barrier
    ds_read_b128 v[72:75], v12
    ds_read_b32 v76, v13
    s_waitcnt lgkmcnt(0)
    v_max3_f32 v77, v72, v73, v74
    v_max3_f32 v77, v77, v75, v76
    s_nop 1
    v_max_f32_dpp v77, v77, v77 quad_perm:[1,0,3,2] row_mask:0xf bank_mask:0xf
    s_nop 1
    v_max_f32_dpp v77, v77, v77 quad_perm:[2,3,0,1] row_mask:0xf bank_mask:0xf
    s_nop 1
    v_max_f32_dpp v77, v77, v77 row_half_mirror row_mask:0xf bank_mask:0xf
    v_sub_f32 v72, v72, v77
    v_sub_f32 v73, v73, v77
    v_sub_f32 v74, v74, v77
    v_sub_f32 v75, v75, v77
    v_sub_f32 v76, v76, v77
    v_exp_f32 v72, v72
    v_exp_f32 v73, v73
    v_exp_f32 v74, v74
    v_exp_f32 v75, v75
    v_exp_f32 v76, v76
    s_nop 0
    v_add_f32 v77, v72, v73
    v_add_f32 v78, v74, v75
    v_add_f32 v77, v77, v76
    v_add_f32 v77, v77, v78
    s_nop 1
    v_add_f32_dpp v77, v77, v77 quad_perm:[1,0,3,2] row_mask:0xf bank_mask:0xf
    s_nop 1
    v_add_f32_dpp v77, v77, v77 quad_perm:[2,3,0,1] row_mask:0xf bank_mask:0xf
    s_nop 1
    v_add_f32_dpp v77, v77, v77 row_half_mirror row_mask:0xf bank_mask:0xf
    v_rcp_f32 v77, v77
    s_nop 0
    v_mul_f32 v72, v72, v77
    v_mul_f32 v73, v73, v77
    v_mul_f32 v74, v74, v77
    v_mul_f32 v75, v75, v77
    v_mul_f32 v76, v76, v77
    v_cvt_pk_bf16_f32 v80, v72, v73
    v_cvt_pk_bf16_f32 v81, v74, v75
    v_mov_b32_dpp v78, v76 quad_perm:[1,0,3,2] row_mask:0xf bank_mask:0xf
    buffer_store_dwordx2 v[80:81], v14, s[4:7], s26 offen sc1
    v_cvt_pk_bf16_f32 v79, v76, v78
    s_mov_b32 exec_lo, 0x55555555
    s_mov_b32 exec_hi, 0x55555555
    buffer_store_dword v79, v15, s[4:7], s27 offen sc1
    s_mov_b64 exec, -1
Lm_s_after_s:
    s_barrier
    s_add_u32 s14, s14, 1
    s_add_u32 s15, s15, 7168
    s_add_u32 s26, s26, 8192
    s_add_u32 s27, s27, 2048
    s_add_u32 s28, s28, 28672
    s_cmp_lt_u32 s14, 63
    s_cbranch_scc0 Lm_fin
    s_mul_i32 s32, s12, 7168
    s_add_u32 s33, s32, s28
    s_add_u32 s32, s32, 20480
    s_mov_b32 m0, s32
    s_nop 0
    buffer_load_dwordx4 v6, s[4:7], s33 offen offset:0 lds
    buffer_load_dwordx4 v6, s[4:7], s33 offen offset:1024 lds
    buffer_load_dwordx4 v6, s[4:7], s33 offen offset:2048 lds
    buffer_load_dwordx4 v6, s[4:7], s33 offen offset:3072 lds
    s_add_u32 s32, s32, 4096
    s_add_u32 s33, s33, 4096
    s_mov_b32 m0, s32
    s_nop 0
    buffer_load_dwordx4 v6, s[4:7], s33 offen offset:0 lds
    buffer_load_dwordx4 v6, s[4:7], s33 offen offset:1024 lds
    buffer_load_dwordx4 v6, s[4:7], s33 offen offset:2048 lds
    s_cmp_eq_u32 s22, 0
    s_cbranch_scc1 Lm_sstep_s
    s_branch Lm_fin
Lm_value_s:
    s_sub_u32 s36, s13, 16
    v_and_b32 v16, 15, v1
    v_lshrrev_b32 v17, 4, v1
    v_mul_u32_u24 v21, 896, v16
    v_lshlrev_b32 v22, 5, v17
    v_add_u32 v21, v21, v22
    s_lshl_b32 s32, s12, 2
    s_add_u32 s32, s32, 0
    s_mul_i32 s32, s32, 448
    s_lshl_b32 s33, s36, 5
    s_add_u32 s32, s32, s33
    s_add_u32 s32, s32, 7168
    s_mul_i32 s32, s32, 896
    s_add_u32 s32, s32, 0
    buffer_load_dwordx4 a[0:3], v21, s[4:7], s32 offen offset:0
    buffer_load_dwordx4 a[4:7], v21, s[4:7], s32 offen offset:16
    buffer_load_dwordx4 a[8:11], v21, s[4:7], s32 offen offset:128
    buffer_load_dwordx4 a[12:15], v21, s[4:7], s32 offen offset:144
    buffer_load_dwordx4 a[16:19], v21, s[4:7], s32 offen offset:256
    buffer_load_dwordx4 a[20:23], v21, s[4:7], s32 offen offset:272
    buffer_load_dwordx4 a[24:27], v21, s[4:7], s32 offen offset:384
    buffer_load_dwordx4 a[28:31], v21, s[4:7], s32 offen offset:400
    buffer_load_dwordx4 a[32:35], v21, s[4:7], s32 offen offset:512
    buffer_load_dwordx4 a[36:39], v21, s[4:7], s32 offen offset:528
    buffer_load_dwordx4 a[40:43], v21, s[4:7], s32 offen offset:640
    buffer_load_dwordx4 a[44:47], v21, s[4:7], s32 offen offset:656
    buffer_load_dwordx4 a[48:51], v21, s[4:7], s32 offen offset:768
    buffer_load_dwordx4 a[52:55], v21, s[4:7], s32 offen offset:784
    s_waitcnt vmcnt(30)
    s_lshl_b32 s32, s12, 2
    s_add_u32 s32, s32, 0
    s_mul_i32 s32, s32, 448
    s_lshl_b32 s33, s36, 5
    s_add_u32 s32, s32, s33
    s_add_u32 s32, s32, 7184
    s_mul_i32 s32, s32, 896
    s_add_u32 s32, s32, 0
    buffer_load_dwordx4 a[56:59], v21, s[4:7], s32 offen offset:0
    buffer_load_dwordx4 a[60:63], v21, s[4:7], s32 offen offset:16
    buffer_load_dwordx4 a[64:67], v21, s[4:7], s32 offen offset:128
    buffer_load_dwordx4 a[68:71], v21, s[4:7], s32 offen offset:144
    buffer_load_dwordx4 a[72:75], v21, s[4:7], s32 offen offset:256
    buffer_load_dwordx4 a[76:79], v21, s[4:7], s32 offen offset:272
    buffer_load_dwordx4 a[80:83], v21, s[4:7], s32 offen offset:384
    buffer_load_dwordx4 a[84:87], v21, s[4:7], s32 offen offset:400
    buffer_load_dwordx4 a[88:91], v21, s[4:7], s32 offen offset:512
    buffer_load_dwordx4 a[92:95], v21, s[4:7], s32 offen offset:528
    buffer_load_dwordx4 a[96:99], v21, s[4:7], s32 offen offset:640
    buffer_load_dwordx4 a[100:103], v21, s[4:7], s32 offen offset:656
    buffer_load_dwordx4 a[104:107], v21, s[4:7], s32 offen offset:768
    buffer_load_dwordx4 a[108:111], v21, s[4:7], s32 offen offset:784
    s_waitcnt vmcnt(30)
    s_lshl_b32 s32, s12, 2
    s_add_u32 s32, s32, 1
    s_mul_i32 s32, s32, 448
    s_lshl_b32 s33, s36, 5
    s_add_u32 s32, s32, s33
    s_add_u32 s32, s32, 7168
    s_mul_i32 s32, s32, 896
    s_add_u32 s32, s32, 0
    buffer_load_dwordx4 a[112:115], v21, s[4:7], s32 offen offset:0
    buffer_load_dwordx4 a[116:119], v21, s[4:7], s32 offen offset:16
    buffer_load_dwordx4 a[120:123], v21, s[4:7], s32 offen offset:128
    buffer_load_dwordx4 a[124:127], v21, s[4:7], s32 offen offset:144
    buffer_load_dwordx4 a[128:131], v21, s[4:7], s32 offen offset:256
    buffer_load_dwordx4 a[132:135], v21, s[4:7], s32 offen offset:272
    buffer_load_dwordx4 a[136:139], v21, s[4:7], s32 offen offset:384
    buffer_load_dwordx4 a[140:143], v21, s[4:7], s32 offen offset:400
    buffer_load_dwordx4 a[144:147], v21, s[4:7], s32 offen offset:512
    buffer_load_dwordx4 a[148:151], v21, s[4:7], s32 offen offset:528
    buffer_load_dwordx4 a[152:155], v21, s[4:7], s32 offen offset:640
    buffer_load_dwordx4 a[156:159], v21, s[4:7], s32 offen offset:656
    buffer_load_dwordx4 a[160:163], v21, s[4:7], s32 offen offset:768
    buffer_load_dwordx4 a[164:167], v21, s[4:7], s32 offen offset:784
    s_waitcnt vmcnt(30)
    s_lshl_b32 s32, s12, 2
    s_add_u32 s32, s32, 1
    s_mul_i32 s32, s32, 448
    s_lshl_b32 s33, s36, 5
    s_add_u32 s32, s32, s33
    s_add_u32 s32, s32, 7184
    s_mul_i32 s32, s32, 896
    s_add_u32 s32, s32, 0
    buffer_load_dwordx4 a[168:171], v21, s[4:7], s32 offen offset:0
    buffer_load_dwordx4 a[172:175], v21, s[4:7], s32 offen offset:16
    buffer_load_dwordx4 a[176:179], v21, s[4:7], s32 offen offset:128
    buffer_load_dwordx4 a[180:183], v21, s[4:7], s32 offen offset:144
    buffer_load_dwordx4 a[184:187], v21, s[4:7], s32 offen offset:256
    buffer_load_dwordx4 a[188:191], v21, s[4:7], s32 offen offset:272
    buffer_load_dwordx4 a[192:195], v21, s[4:7], s32 offen offset:384
    buffer_load_dwordx4 a[196:199], v21, s[4:7], s32 offen offset:400
    buffer_load_dwordx4 a[200:203], v21, s[4:7], s32 offen offset:512
    buffer_load_dwordx4 a[204:207], v21, s[4:7], s32 offen offset:528
    buffer_load_dwordx4 a[208:211], v21, s[4:7], s32 offen offset:640
    buffer_load_dwordx4 a[212:215], v21, s[4:7], s32 offen offset:656
    buffer_load_dwordx4 a[216:219], v21, s[4:7], s32 offen offset:768
    buffer_load_dwordx4 a[220:223], v21, s[4:7], s32 offen offset:784
    s_waitcnt vmcnt(30)
    s_lshl_b32 s32, s12, 2
    s_add_u32 s32, s32, 2
    s_mul_i32 s32, s32, 448
    s_lshl_b32 s33, s36, 5
    s_add_u32 s32, s32, s33
    s_add_u32 s32, s32, 7168
    s_mul_i32 s32, s32, 896
    s_add_u32 s32, s32, 0
    buffer_load_dwordx4 a[224:227], v21, s[4:7], s32 offen offset:0
    buffer_load_dwordx4 a[228:231], v21, s[4:7], s32 offen offset:16
    buffer_load_dwordx4 a[232:235], v21, s[4:7], s32 offen offset:128
    buffer_load_dwordx4 a[236:239], v21, s[4:7], s32 offen offset:144
    buffer_load_dwordx4 a[240:243], v21, s[4:7], s32 offen offset:256
    buffer_load_dwordx4 a[244:247], v21, s[4:7], s32 offen offset:272
    buffer_load_dwordx4 a[248:251], v21, s[4:7], s32 offen offset:384
    buffer_load_dwordx4 a[252:255], v21, s[4:7], s32 offen offset:400
    buffer_load_dwordx4 v[192:195], v21, s[4:7], s32 offen offset:512
    buffer_load_dwordx4 v[196:199], v21, s[4:7], s32 offen offset:528
    buffer_load_dwordx4 v[200:203], v21, s[4:7], s32 offen offset:640
    buffer_load_dwordx4 v[204:207], v21, s[4:7], s32 offen offset:656
    buffer_load_dwordx4 v[208:211], v21, s[4:7], s32 offen offset:768
    buffer_load_dwordx4 v[212:215], v21, s[4:7], s32 offen offset:784
    s_waitcnt vmcnt(30)
    s_lshl_b32 s32, s12, 2
    s_add_u32 s32, s32, 2
    s_mul_i32 s32, s32, 448
    s_lshl_b32 s33, s36, 5
    s_add_u32 s32, s32, s33
    s_add_u32 s32, s32, 7184
    s_mul_i32 s32, s32, 896
    s_add_u32 s32, s32, 0
    buffer_load_dwordx4 v[216:219], v21, s[4:7], s32 offen offset:0
    buffer_load_dwordx4 v[220:223], v21, s[4:7], s32 offen offset:16
    buffer_load_dwordx4 v[224:227], v21, s[4:7], s32 offen offset:128
    buffer_load_dwordx4 v[228:231], v21, s[4:7], s32 offen offset:144
    buffer_load_dwordx4 v[232:235], v21, s[4:7], s32 offen offset:256
    buffer_load_dwordx4 v[236:239], v21, s[4:7], s32 offen offset:272
    buffer_load_dwordx4 v[240:243], v21, s[4:7], s32 offen offset:384
    buffer_load_dwordx4 v[244:247], v21, s[4:7], s32 offen offset:400
    buffer_load_dwordx4 v[248:251], v21, s[4:7], s32 offen offset:512
    buffer_load_dwordx4 v[252:255], v21, s[4:7], s32 offen offset:528
    s_lshl_b32 s33, s12, 15
    s_add_u32 s33, s33, 16384
    s_mov_b32 m0, s33
    s_add_u32 s34, s32, 640
    buffer_load_dwordx4 v21, s[4:7], s34 offen lds
    s_lshl_b32 s33, s12, 15
    s_add_u32 s33, s33, 17408
    s_mov_b32 m0, s33
    s_add_u32 s34, s32, 656
    buffer_load_dwordx4 v21, s[4:7], s34 offen lds
    s_lshl_b32 s33, s12, 15
    s_add_u32 s33, s33, 18432
    s_mov_b32 m0, s33
    s_add_u32 s34, s32, 768
    buffer_load_dwordx4 v21, s[4:7], s34 offen lds
    s_lshl_b32 s33, s12, 15
    s_add_u32 s33, s33, 19456
    s_mov_b32 m0, s33
    s_add_u32 s34, s32, 784
    buffer_load_dwordx4 v21, s[4:7], s34 offen lds
    s_waitcnt vmcnt(30)
    s_lshl_b32 s32, s12, 2
    s_add_u32 s32, s32, 3
    s_mul_i32 s32, s32, 448
    s_lshl_b32 s33, s36, 5
    s_add_u32 s32, s32, s33
    s_add_u32 s32, s32, 7168
    s_mul_i32 s32, s32, 896
    s_add_u32 s32, s32, 0
    s_lshl_b32 s33, s12, 15
    s_add_u32 s33, s33, 20480
    s_mov_b32 m0, s33
    s_add_u32 s34, s32, 0
    buffer_load_dwordx4 v21, s[4:7], s34 offen lds
    s_lshl_b32 s33, s12, 15
    s_add_u32 s33, s33, 21504
    s_mov_b32 m0, s33
    s_add_u32 s34, s32, 16
    buffer_load_dwordx4 v21, s[4:7], s34 offen lds
    s_lshl_b32 s33, s12, 15
    s_add_u32 s33, s33, 22528
    s_mov_b32 m0, s33
    s_add_u32 s34, s32, 128
    buffer_load_dwordx4 v21, s[4:7], s34 offen lds
    s_lshl_b32 s33, s12, 15
    s_add_u32 s33, s33, 23552
    s_mov_b32 m0, s33
    s_add_u32 s34, s32, 144
    buffer_load_dwordx4 v21, s[4:7], s34 offen lds
    s_lshl_b32 s33, s12, 15
    s_add_u32 s33, s33, 24576
    s_mov_b32 m0, s33
    s_add_u32 s34, s32, 256
    buffer_load_dwordx4 v21, s[4:7], s34 offen lds
    s_lshl_b32 s33, s12, 15
    s_add_u32 s33, s33, 25600
    s_mov_b32 m0, s33
    s_add_u32 s34, s32, 272
    buffer_load_dwordx4 v21, s[4:7], s34 offen lds
    s_lshl_b32 s33, s12, 15
    s_add_u32 s33, s33, 26624
    s_mov_b32 m0, s33
    s_add_u32 s34, s32, 384
    buffer_load_dwordx4 v21, s[4:7], s34 offen lds
    s_lshl_b32 s33, s12, 15
    s_add_u32 s33, s33, 27648
    s_mov_b32 m0, s33
    s_add_u32 s34, s32, 400
    buffer_load_dwordx4 v21, s[4:7], s34 offen lds
    s_lshl_b32 s33, s12, 15
    s_add_u32 s33, s33, 28672
    s_mov_b32 m0, s33
    s_add_u32 s34, s32, 512
    buffer_load_dwordx4 v21, s[4:7], s34 offen lds
    s_lshl_b32 s33, s12, 15
    s_add_u32 s33, s33, 29696
    s_mov_b32 m0, s33
    s_add_u32 s34, s32, 528
    buffer_load_dwordx4 v21, s[4:7], s34 offen lds
    s_lshl_b32 s33, s12, 15
    s_add_u32 s33, s33, 30720
    s_mov_b32 m0, s33
    s_add_u32 s34, s32, 640
    buffer_load_dwordx4 v21, s[4:7], s34 offen lds
    s_lshl_b32 s33, s12, 15
    s_add_u32 s33, s33, 31744
    s_mov_b32 m0, s33
    s_add_u32 s34, s32, 656
    buffer_load_dwordx4 v21, s[4:7], s34 offen lds
    s_lshl_b32 s33, s12, 15
    s_add_u32 s33, s33, 32768
    s_mov_b32 m0, s33
    s_add_u32 s34, s32, 768
    buffer_load_dwordx4 v21, s[4:7], s34 offen lds
    s_lshl_b32 s33, s12, 15
    s_add_u32 s33, s33, 33792
    s_mov_b32 m0, s33
    s_add_u32 s34, s32, 784
    buffer_load_dwordx4 v21, s[4:7], s34 offen lds
    s_waitcnt vmcnt(30)
    s_lshl_b32 s32, s12, 2
    s_add_u32 s32, s32, 3
    s_mul_i32 s32, s32, 448
    s_lshl_b32 s33, s36, 5
    s_add_u32 s32, s32, s33
    s_add_u32 s32, s32, 7184
    s_mul_i32 s32, s32, 896
    s_add_u32 s32, s32, 0
    s_lshl_b32 s33, s12, 15
    s_add_u32 s33, s33, 34816
    s_mov_b32 m0, s33
    s_add_u32 s34, s32, 0
    buffer_load_dwordx4 v21, s[4:7], s34 offen lds
    s_lshl_b32 s33, s12, 15
    s_add_u32 s33, s33, 35840
    s_mov_b32 m0, s33
    s_add_u32 s34, s32, 16
    buffer_load_dwordx4 v21, s[4:7], s34 offen lds
    s_lshl_b32 s33, s12, 15
    s_add_u32 s33, s33, 36864
    s_mov_b32 m0, s33
    s_add_u32 s34, s32, 128
    buffer_load_dwordx4 v21, s[4:7], s34 offen lds
    s_lshl_b32 s33, s12, 15
    s_add_u32 s33, s33, 37888
    s_mov_b32 m0, s33
    s_add_u32 s34, s32, 144
    buffer_load_dwordx4 v21, s[4:7], s34 offen lds
    s_lshl_b32 s33, s12, 15
    s_add_u32 s33, s33, 38912
    s_mov_b32 m0, s33
    s_add_u32 s34, s32, 256
    buffer_load_dwordx4 v21, s[4:7], s34 offen lds
    s_lshl_b32 s33, s12, 15
    s_add_u32 s33, s33, 39936
    s_mov_b32 m0, s33
    s_add_u32 s34, s32, 272
    buffer_load_dwordx4 v21, s[4:7], s34 offen lds
    s_lshl_b32 s33, s12, 15
    s_add_u32 s33, s33, 40960
    s_mov_b32 m0, s33
    s_add_u32 s34, s32, 384
    buffer_load_dwordx4 v21, s[4:7], s34 offen lds
    s_lshl_b32 s33, s12, 15
    s_add_u32 s33, s33, 41984
    s_mov_b32 m0, s33
    s_add_u32 s34, s32, 400
    buffer_load_dwordx4 v21, s[4:7], s34 offen lds
    s_lshl_b32 s33, s12, 15
    s_add_u32 s33, s33, 43008
    s_mov_b32 m0, s33
    s_add_u32 s34, s32, 512
    buffer_load_dwordx4 v21, s[4:7], s34 offen lds
    s_lshl_b32 s33, s12, 15
    s_add_u32 s33, s33, 44032
    s_mov_b32 m0, s33
    s_add_u32 s34, s32, 528
    buffer_load_dwordx4 v21, s[4:7], s34 offen lds
    s_lshl_b32 s33, s12, 15
    s_add_u32 s33, s33, 45056
    s_mov_b32 m0, s33
    s_add_u32 s34, s32, 640
    buffer_load_dwordx4 v21, s[4:7], s34 offen lds
    s_lshl_b32 s33, s12, 15
    s_add_u32 s33, s33, 46080
    s_mov_b32 m0, s33
    s_add_u32 s34, s32, 656
    buffer_load_dwordx4 v21, s[4:7], s34 offen lds
    s_lshl_b32 s33, s12, 15
    s_add_u32 s33, s33, 47104
    s_mov_b32 m0, s33
    s_add_u32 s34, s32, 768
    buffer_load_dwordx4 v21, s[4:7], s34 offen lds
    s_lshl_b32 s33, s12, 15
    s_add_u32 s33, s33, 48128
    s_mov_b32 m0, s33
    s_add_u32 s34, s32, 784
    buffer_load_dwordx4 v21, s[4:7], s34 offen lds
    s_waitcnt vmcnt(30)
    s_lshl_b32 s33, s12, 15
    s_add_u32 s33, s33, 16384
    v_add_u32 v7, s33, v6
    v_lshlrev_b32 v8, 3, v17
    v_and_b32 v22, 7, v16
    v_add_u32 v8, v8, v22
    v_lshlrev_b32 v8, 4, v8
    v_lshrrev_b32 v22, 3, v16
    v_lshlrev_b32 v22, 9, v22
    v_add_u32 v8, v8, v22
    s_lshl_b32 s33, s12, 11
    s_add_u32 s33, s33, 8192
    v_add_u32 v9, s33, v6
    s_lshl_b32 s33, s12, 10
    s_add_u32 s33, s33, 8192
    v_add_u32 v10, s33, v6
    v_lshrrev_b32 v22, 1, v17
    v_lshlrev_b32 v11, 7, v22
    v_and_b32 v22, 7, v16
    v_lshlrev_b32 v22, 4, v22
    v_add_u32 v11, v11, v22
    v_and_b32 v22, 1, v17
    v_lshlrev_b32 v22, 3, v22
    v_add_u32 v11, v11, v22
    s_mov_b32 s14, 0
    s_mov_b32 s15, 16527360
    s_lshl_b32 s26, s12, 11
    s_add_u32 s26, s26, 16994304
    s_lshl_b32 s27, s12, 9
    s_add_u32 s27, s27, 17518592
    v_lshrrev_b32 v22, 3, v16
    v_lshlrev_b32 v22, 8, v22
    v_add_u32 v187, v11, v22
    s_lshl_b32 s29, s36, 15
    s_lshl_b32 s33, s12, 12
    s_add_u32 s29, s29, s33
    s_add_u32 s29, s29, 47009792
    s_lshl_b32 s30, s36, 13
    s_lshl_b32 s33, s12, 10
    s_add_u32 s30, s30, s33
    s_add_u32 s30, s30, 76369920
    s_lshl_b32 s32, s36, 1
    s_add_u32 s32, s32, s12
    s_lshl_b32 s31, s32, 8
    s_add_u32 s31, s31, 16534528
    v_mov_b32 v12, 0
    v_mov_b32 v13, 0
    v_mov_b32 v14, 0
    v_mov_b32 v15, 0
    v_mov_b32 v1, 0
    s_mov_b32 s37, 100188160
    s_lshl_b32 s38, s36, 7
    s_add_u32 s38, s38, 100057088
    v_mov_b32 v0, s97
    s_add_u32 s39, s31, 75415552
    s_waitcnt vmcnt(0)
    s_mov_b32 s99, 100196352
    v_lshrrev_b32 v80, 4, v6
    v_min_u32 v80, 63, v80
    v_lshlrev_b32 v80, 4, v80
    s_mov_b32 s21, 0
Lm_wf_68:
    buffer_load_dwordx4 v[84:87], v80, s[4:7], s99 offen sc1
    s_waitcnt vmcnt(0)
    v_xor_b32 v84, s97, v84
    v_xor_b32 v85, s97, v85
    v_xor_b32 v86, s97, v86
    v_xor_b32 v87, s97, v87
    v_or_b32 v84, v84, v85
    v_or_b32 v84, v84, v86
    v_or_b32 v84, v84, v87
    v_cmp_ne_u32 vcc, 0, v84
    s_cbranch_vccz Lm_wf_68_ok
    s_sleep 1
    s_add_u32 s21, s21, 1
    s_cmp_lt_u32 s21, 400000
    s_cbranch_scc1 Lm_wf_68
Lm_wf_68_ok:
    s_mov_b32 s99, 100198400
    v_lshrrev_b32 v80, 4, v6
    v_min_u32 v80, 63, v80
    v_lshlrev_b32 v80, 4, v80
    s_mov_b32 s21, 0
Lm_wf_69:
    buffer_load_dwordx4 v[84:87], v80, s[4:7], s99 offen sc1
    s_waitcnt vmcnt(0)
    v_xor_b32 v84, s97, v84
    v_xor_b32 v85, s97, v85
    v_xor_b32 v86, s97, v86
    v_xor_b32 v87, s97, v87
    v_or_b32 v84, v84, v85
    v_or_b32 v84, v84, v86
    v_or_b32 v84, v84, v87
    v_cmp_ne_u32 vcc, 0, v84
    s_cbranch_vccz Lm_wf_69_ok
    s_sleep 1
    s_add_u32 s21, s21, 1
    s_cmp_lt_u32 s21, 400000
    s_cbranch_scc1 Lm_wf_69
Lm_wf_69_ok:
    v_xor_b32 v2, v0, v12
    v_xor_b32 v182, v0, v13
    v_or_b32 v2, v2, v182
    v_xor_b32 v182, v0, v14
    v_or_b32 v2, v2, v182
    v_xor_b32 v182, v0, v15
    v_or_b32 v2, v2, v182
    s_nop 0
    v_readfirstlane_b32 s32, v2
    s_nop 3
    s_cmp_eq_u32 s32, 0
    s_cbranch_scc1 Lm_pc_70_ok
    s_mov_b32 s21, 0
Lm_pc_70:
    buffer_load_dwordx4 v[12:15], v1, s[4:7], s37 offen sc1
    s_waitcnt vmcnt(0)
    v_xor_b32 v2, v0, v12
    v_xor_b32 v182, v0, v13
    v_or_b32 v2, v2, v182
    v_xor_b32 v182, v0, v14
    v_or_b32 v2, v2, v182
    v_xor_b32 v182, v0, v15
    v_or_b32 v2, v2, v182
    s_nop 0
    v_readfirstlane_b32 s32, v2
    s_nop 3
    s_cmp_eq_u32 s32, 0
    s_cbranch_scc1 Lm_pc_70_ok
    s_sleep 1
    s_add_u32 s21, s21, 1
    s_cmp_lt_u32 s21, 400000
    s_cbranch_scc1 Lm_pc_70
    s_mov_b32 s22, 1
Lm_pc_70_ok:
    s_add_u32 s32, s29, 0
    buffer_load_dwordx4 v[100:103], v6, s[4:7], s32 offen offset:0
    buffer_load_dwordx4 v[108:111], v6, s[4:7], s32 offen offset:1024
    buffer_load_dwordx4 v[116:119], v6, s[4:7], s32 offen offset:2048
    buffer_load_dwordx4 v[124:127], v6, s[4:7], s32 offen offset:3072
    s_add_u32 s32, s29, 16384
    buffer_load_dwordx4 v[104:107], v6, s[4:7], s32 offen offset:0
    buffer_load_dwordx4 v[112:115], v6, s[4:7], s32 offen offset:1024
    buffer_load_dwordx4 v[120:123], v6, s[4:7], s32 offen offset:2048
    buffer_load_dwordx4 v[128:131], v6, s[4:7], s32 offen offset:3072
    v_mov_b32 v44, 0
    v_mov_b32 v45, 0
    v_mov_b32 v46, 0
    v_mov_b32 v47, 0
    v_mov_b32 v48, 0
    v_mov_b32 v49, 0
    v_mov_b32 v50, 0
    v_mov_b32 v51, 0
    v_mov_b32 v52, 0
    v_mov_b32 v53, 0
    v_mov_b32 v54, 0
    v_mov_b32 v55, 0
    v_mov_b32 v56, 0
    v_mov_b32 v57, 0
    v_mov_b32 v58, 0
    v_mov_b32 v59, 0
    v_mov_b32 v60, 0
    v_mov_b32 v61, 0
    v_mov_b32 v62, 0
    v_mov_b32 v63, 0
    v_mov_b32 v64, 0
    v_mov_b32 v65, 0
    v_mov_b32 v66, 0
    v_mov_b32 v67, 0
    v_mov_b32 v68, 0
    v_mov_b32 v69, 0
    v_mov_b32 v70, 0
    v_mov_b32 v71, 0
    v_mov_b32 v72, 0
    v_mov_b32 v73, 0
    v_mov_b32 v74, 0
    v_mov_b32 v75, 0
    s_waitcnt vmcnt(0)
Lm_vstep_s:
    ds_read_b128 v[76:79], v7 offset:4096
    ds_read_b128 v[80:83], v7 offset:5120
    ds_read_b128 v[84:87], v7 offset:6144
    ds_read_b128 v[88:91], v7 offset:7168
    ds_read_b128 v[92:95], v7 offset:8192
    ds_read_b128 v[96:99], v7 offset:9216
    s_mov_b32 s21, 0
Lm_poll_71:
    buffer_load_dwordx4 v[168:171], v4, s[4:7], s15 offen sc1
    buffer_load_dwordx4 v[172:175], v5, s[4:7], s15 offen sc1
    s_waitcnt vmcnt(0)
    v_max3_u32 v178, v168, v169, v170
    v_max3_u32 v179, v171, v172, v173
    v_max3_u32 v178, v178, v174, v175
    v_max_u32 v178, v178, v179
    v_cmp_eq_u32 vcc, -1, v178
    s_cbranch_vccz Lm_poll_71_ok
    s_add_u32 s21, s21, 1
    s_cmp_lt_u32 s21, 400000
    s_cbranch_scc1 Lm_poll_71
    s_mov_b32 s22, 1
Lm_poll_71_ok:
    ds_write_b128 v4, v[168:171] offset:0
    ds_write_b128 v4, v[172:175] offset:4096
    s_waitcnt lgkmcnt(0)
    s_barrier
    ds_read_b128 v[16:19], v6 offset:0
    ds_read_b128 v[20:23], v6 offset:1024
    ds_read_b128 v[24:27], v6 offset:2048
    ds_read_b128 v[28:31], v6 offset:3072
    ds_read_b128 v[32:35], v6 offset:4096
    ds_read_b128 v[36:39], v6 offset:5120
    ds_read_b128 v[40:43], v6 offset:6144
    v_xor_b32 v2, v0, v12
    v_xor_b32 v182, v0, v13
    v_or_b32 v2, v2, v182
    v_xor_b32 v182, v0, v14
    v_or_b32 v2, v2, v182
    v_xor_b32 v182, v0, v15
    v_or_b32 v2, v2, v182
    s_nop 0
    v_readfirstlane_b32 s32, v2
    s_nop 3
    s_cmp_eq_u32 s32, 0
    s_cbranch_scc1 Lm_pc_72_ok
    s_mov_b32 s21, 0
Lm_pc_72:
    buffer_load_dwordx4 v[12:15], v1, s[4:7], s37 offen sc1
    s_waitcnt vmcnt(0)
    v_xor_b32 v2, v0, v12
    v_xor_b32 v182, v0, v13
    v_or_b32 v2, v2, v182
    v_xor_b32 v182, v0, v14
    v_or_b32 v2, v2, v182
    v_xor_b32 v182, v0, v15
    v_or_b32 v2, v2, v182
    s_nop 0
    v_readfirstlane_b32 s32, v2
    s_nop 3
    s_cmp_eq_u32 s32, 0
    s_cbranch_scc1 Lm_pc_72_ok
    s_sleep 1
    s_add_u32 s21, s21, 1
    s_cmp_lt_u32 s21, 400000
    s_cbranch_scc1 Lm_pc_72
    s_mov_b32 s22, 1
Lm_pc_72_ok:
    s_add_u32 s34, s29, 16384
    s_add_u32 s35, s37, 64
    s_waitcnt lgkmcnt(6)
    v_smfmac_f32_16x16x64_bf16 v[44:47], v[16:19], a[0:7], v3
    s_waitcnt lgkmcnt(5)
    v_smfmac_f32_16x16x64_bf16 v[44:47], v[20:23], a[8:15], v3
    s_waitcnt lgkmcnt(4)
    v_smfmac_f32_16x16x64_bf16 v[44:47], v[24:27], a[16:23], v3
    s_cmp_eq_u32 s14, 0
    s_cbranch_scc1 Lm_sw_73
    s_add_u32 s33, s30, 4294852608
    s_add_u32 s32, s30, 4294856704
    buffer_store_dwordx4 v[152:155], v6, s[4:7], s33 offen sc1
    buffer_store_dwordx4 v[156:159], v6, s[4:7], s32 offen sc1
Lm_sw_73:
    s_waitcnt lgkmcnt(3)
    v_smfmac_f32_16x16x64_bf16 v[44:47], v[28:31], a[24:31], v3
    s_waitcnt lgkmcnt(2)
    v_smfmac_f32_16x16x64_bf16 v[44:47], v[32:35], a[32:39], v3
    s_cmp_eq_u32 s14, 0
    s_cbranch_scc1 Lm_mx_74
    s_cmp_lt_u32 s12, 2
    s_cbranch_scc0 Lm_mx_74
    s_sub_u32 s32, s39, 7168
    s_mov_b32 exec_lo, 0x00ff00ff
    s_mov_b32 exec_hi, 0x00ff00ff
    buffer_store_dwordx2 v[180:181], v11, s[4:7], s32 offen sc1
    s_mov_b64 exec, -1
    s_nop 3
Lm_mx_74:
    s_waitcnt lgkmcnt(1)
    v_smfmac_f32_16x16x64_bf16 v[44:47], v[36:39], a[40:47], v3
    s_cmp_ge_u32 s14, 2
    s_cbranch_scc0 Lm_mc_75
    s_cmp_eq_u32 s12, 3
    s_cbranch_scc0 Lm_mc_75
    s_sub_u32 s32, s38, 4096
    s_mov_b64 exec, 1
    buffer_store_dword v0, v1, s[4:7], s32 offen sc1
    s_mov_b64 exec, -1
    s_nop 3
Lm_mc_75:
    s_waitcnt lgkmcnt(0)
    v_smfmac_f32_16x16x64_bf16 v[44:47], v[40:43], a[48:55], v3
    v_smfmac_f32_16x16x64_bf16 v[52:55], v[16:19], a[112:119], v3
    v_smfmac_f32_16x16x64_bf16 v[52:55], v[20:23], a[120:127], v3
    s_waitcnt lgkmcnt(4)
    v_smfmac_f32_16x16x64_bf16 v[68:71], v[16:19], v[76:83], v3
    ds_read_b128 v[76:79], v7 offset:10240
    ds_read_b128 v[80:83], v7 offset:11264
    v_smfmac_f32_16x16x64_bf16 v[52:55], v[24:27], a[128:135], v3
    buffer_load_dwordx4 v[100:103], v6, s[4:7], s29 offen offset:0
    v_smfmac_f32_16x16x64_bf16 v[52:55], v[28:31], a[136:143], v3
    s_waitcnt lgkmcnt(4)
    v_smfmac_f32_16x16x64_bf16 v[68:71], v[20:23], v[84:91], v3
    ds_read_b128 v[84:87], v7 offset:12288
    ds_read_b128 v[88:91], v7 offset:13312
    v_smfmac_f32_16x16x64_bf16 v[52:55], v[32:35], a[144:151], v3
    v_smfmac_f32_16x16x64_bf16 v[52:55], v[36:39], a[152:159], v3
    buffer_load_dwordx4 v[108:111], v6, s[4:7], s29 offen offset:1024
    s_waitcnt lgkmcnt(4)
    v_smfmac_f32_16x16x64_bf16 v[68:71], v[24:27], v[92:99], v3
    ds_read_b128 v[92:95], v7 offset:14336
    ds_read_b128 v[96:99], v7 offset:15360
    v_smfmac_f32_16x16x64_bf16 v[52:55], v[40:43], a[160:167], v3
    v_smfmac_f32_16x16x64_bf16 v[60:63], v[16:19], a[224:231], v3
    s_waitcnt lgkmcnt(4)
    v_smfmac_f32_16x16x64_bf16 v[68:71], v[28:31], v[76:83], v3
    buffer_load_dwordx4 v[116:119], v6, s[4:7], s29 offen offset:2048
    ds_read_b128 v[76:79], v7 offset:16384
    ds_read_b128 v[80:83], v7 offset:17408
    v_smfmac_f32_16x16x64_bf16 v[60:63], v[20:23], a[232:239], v3
    v_smfmac_f32_16x16x64_bf16 v[60:63], v[24:27], a[240:247], v3
    s_waitcnt lgkmcnt(4)
    v_smfmac_f32_16x16x64_bf16 v[68:71], v[32:35], v[84:91], v3
    ds_read_b128 v[84:87], v7 offset:18432
    ds_read_b128 v[88:91], v7 offset:19456
    v_smfmac_f32_16x16x64_bf16 v[60:63], v[28:31], a[248:255], v3
    buffer_load_dwordx4 v[124:127], v6, s[4:7], s29 offen offset:3072
    v_smfmac_f32_16x16x64_bf16 v[60:63], v[32:35], v[192:199], v3
    s_waitcnt lgkmcnt(4)
    v_smfmac_f32_16x16x64_bf16 v[68:71], v[36:39], v[92:99], v3
    ds_read_b128 v[92:95], v7 offset:20480
    ds_read_b128 v[96:99], v7 offset:21504
    v_smfmac_f32_16x16x64_bf16 v[60:63], v[36:39], v[200:207], v3
    v_permlane32_swap_b32 v44, v52
    v_permlane32_swap_b32 v45, v53
    v_permlane32_swap_b32 v46, v54
    v_smfmac_f32_16x16x64_bf16 v[60:63], v[40:43], v[208:215], v3
    buffer_load_dwordx4 v[104:107], v6, s[4:7], s34 offen offset:0
    v_permlane32_swap_b32 v47, v55
    v_add_f32 v44, v44, v52
    v_add_f32 v45, v45, v53
    s_waitcnt lgkmcnt(4)
    v_smfmac_f32_16x16x64_bf16 v[68:71], v[40:43], v[76:83], v3
    ds_read_b128 v[76:79], v7 offset:22528
    ds_read_b128 v[80:83], v7 offset:23552
    v_add_f32 v46, v46, v54
    v_add_f32 v47, v47, v55
    v_cvt_pk_bf16_f32 v152, v44, v45
    v_smfmac_f32_16x16x64_bf16 v[48:51], v[16:19], a[56:63], v3
    v_cvt_pk_bf16_f32 v153, v46, v47
    v_smfmac_f32_16x16x64_bf16 v[48:51], v[20:23], a[64:71], v3
    s_waitcnt lgkmcnt(4)
    v_smfmac_f32_16x16x64_bf16 v[72:75], v[16:19], v[84:91], v3
    buffer_load_dwordx4 v[112:115], v6, s[4:7], s34 offen offset:1024
    ds_read_b128 v[84:87], v7 offset:24576
    ds_read_b128 v[88:91], v7 offset:25600
    v_smfmac_f32_16x16x64_bf16 v[48:51], v[24:27], a[72:79], v3
    v_smfmac_f32_16x16x64_bf16 v[48:51], v[28:31], a[80:87], v3
    s_waitcnt lgkmcnt(4)
    v_smfmac_f32_16x16x64_bf16 v[72:75], v[20:23], v[92:99], v3
    ds_read_b128 v[92:95], v7 offset:26624
    ds_read_b128 v[96:99], v7 offset:27648
    v_smfmac_f32_16x16x64_bf16 v[48:51], v[32:35], a[88:95], v3
    buffer_load_dwordx4 v[120:123], v6, s[4:7], s34 offen offset:2048
    v_smfmac_f32_16x16x64_bf16 v[48:51], v[36:39], a[96:103], v3
    s_waitcnt lgkmcnt(4)
    v_smfmac_f32_16x16x64_bf16 v[72:75], v[24:27], v[76:83], v3
    ds_read_b128 v[76:79], v7 offset:28672
    ds_read_b128 v[80:83], v7 offset:29696
    v_permlane32_swap_b32 v60, v68
    v_permlane32_swap_b32 v61, v69
    v_permlane32_swap_b32 v62, v70
    v_smfmac_f32_16x16x64_bf16 v[48:51], v[40:43], a[104:111], v3
    v_permlane32_swap_b32 v63, v71
    v_add_f32 v60, v60, v68
    v_add_f32 v61, v61, v69
    v_smfmac_f32_16x16x64_bf16 v[56:59], v[16:19], a[168:175], v3
    buffer_load_dwordx4 v[128:131], v6, s[4:7], s34 offen offset:3072
    v_add_f32 v62, v62, v70
    v_add_f32 v63, v63, v71
    v_cvt_pk_bf16_f32 v154, v60, v61
    s_waitcnt lgkmcnt(4)
    v_smfmac_f32_16x16x64_bf16 v[72:75], v[28:31], v[84:91], v3
    ds_read_b128 v[84:87], v7 offset:30720
    ds_read_b128 v[88:91], v7 offset:31744
    v_cvt_pk_bf16_f32 v155, v62, v63
    v_smfmac_f32_16x16x64_bf16 v[56:59], v[20:23], a[176:183], v3
    v_smfmac_f32_16x16x64_bf16 v[56:59], v[24:27], a[184:191], v3
    s_waitcnt lgkmcnt(4)
    v_smfmac_f32_16x16x64_bf16 v[72:75], v[32:35], v[92:99], v3
    buffer_load_dwordx4 v[12:15], v1, s[4:7], s35 offen sc1
    ds_read_b128 v[92:95], v7 offset:0
    ds_read_b128 v[96:99], v7 offset:1024
    v_smfmac_f32_16x16x64_bf16 v[56:59], v[28:31], a[192:199], v3
    v_smfmac_f32_16x16x64_bf16 v[56:59], v[32:35], a[200:207], v3
    s_waitcnt lgkmcnt(4)
    v_smfmac_f32_16x16x64_bf16 v[72:75], v[36:39], v[76:83], v3
    ds_read_b128 v[76:79], v7 offset:2048
    ds_read_b128 v[80:83], v7 offset:3072
    v_smfmac_f32_16x16x64_bf16 v[56:59], v[36:39], a[208:215], v3
    v_smfmac_f32_16x16x64_bf16 v[56:59], v[40:43], a[216:223], v3
    s_waitcnt lgkmcnt(4)
    v_smfmac_f32_16x16x64_bf16 v[72:75], v[40:43], v[84:91], v3
    v_smfmac_f32_16x16x64_bf16 v[64:67], v[16:19], v[216:223], v3
    v_smfmac_f32_16x16x64_bf16 v[64:67], v[20:23], v[224:231], v3
    s_waitcnt lgkmcnt(2)
    v_smfmac_f32_16x16x64_bf16 v[64:67], v[36:39], v[92:99], v3
    v_smfmac_f32_16x16x64_bf16 v[64:67], v[24:27], v[232:239], v3
    v_smfmac_f32_16x16x64_bf16 v[64:67], v[28:31], v[240:247], v3
    s_waitcnt lgkmcnt(0)
    v_smfmac_f32_16x16x64_bf16 v[64:67], v[40:43], v[76:83], v3
    v_smfmac_f32_16x16x64_bf16 v[64:67], v[32:35], v[248:255], v3
    s_nop 7
    v_permlane32_swap_b32 v48, v56
    v_permlane32_swap_b32 v49, v57
    v_permlane32_swap_b32 v50, v58
    v_permlane32_swap_b32 v51, v59
    v_add_f32 v48, v48, v56
    v_add_f32 v49, v49, v57
    v_add_f32 v50, v50, v58
    v_add_f32 v51, v51, v59
    v_cvt_pk_bf16_f32 v156, v48, v49
    v_cvt_pk_bf16_f32 v157, v50, v51
    v_permlane32_swap_b32 v64, v72
    v_permlane32_swap_b32 v65, v73
    v_permlane32_swap_b32 v66, v74
    v_permlane32_swap_b32 v67, v75
    v_add_f32 v64, v64, v72
    v_add_f32 v65, v65, v73
    v_add_f32 v66, v66, v74
    v_add_f32 v67, v67, v75
    v_cvt_pk_bf16_f32 v158, v64, v65
    v_cvt_pk_bf16_f32 v159, v66, v67
    s_cmp_eq_u32 s14, 63
    s_cbranch_scc0 Lm_v_cont_s
    s_add_u32 s33, s30, 0
    s_add_u32 s32, s30, 4096
    buffer_store_dwordx4 v[152:155], v6, s[4:7], s33 offen sc1
    buffer_store_dwordx4 v[156:159], v6, s[4:7], s32 offen sc1
    s_waitcnt vmcnt(0)
    s_barrier
    s_cmp_eq_u32 s12, 0
    s_cbranch_scc0 Lm_fin
    s_sub_u32 s32, s38, 2048
    s_mov_b64 exec, 1
    buffer_store_dword v0, v1, s[4:7], s32 offen sc1
    buffer_store_dword v0, v1, s[4:7], s38 offen sc1
    s_mov_b64 exec, -1
    s_branch Lm_fin
Lm_v_cont_s:
    s_sleep 4
    s_mov_b32 s21, 0
    buffer_load_dwordx4 v[132:135], v8, s[4:7], s26 offen sc1
    buffer_load_dwordx4 v[136:139], v8, s[4:7], s26 offen offset:1024 sc1
    buffer_load_dwordx2 v[140:141], v187, s[4:7], s27 offen sc1
    s_sleep 3
    buffer_load_dwordx4 v[44:47], v8, s[4:7], s26 offen sc1
    buffer_load_dwordx4 v[48:51], v8, s[4:7], s26 offen offset:1024 sc1
    buffer_load_dwordx2 v[52:53], v187, s[4:7], s27 offen sc1
Lm_p2_76:
    s_waitcnt vmcnt(3)
    v_max3_u32 v176, v132, v133, v134
    v_max3_u32 v177, v135, v136, v137
    v_max3_u32 v176, v176, v138, v139
    v_max3_u32 v177, v177, v140, v141
    v_max_u32 v176, v176, v177
    v_cmp_eq_u32 vcc, -1, v176
    s_cbranch_vccz Lm_p2_76_ok0
    buffer_load_dwordx4 v[132:135], v8, s[4:7], s26 offen sc1
    buffer_load_dwordx4 v[136:139], v8, s[4:7], s26 offen offset:1024 sc1
    buffer_load_dwordx2 v[140:141], v187, s[4:7], s27 offen sc1
    s_waitcnt vmcnt(3)
    v_max3_u32 v176, v44, v45, v46
    v_max3_u32 v177, v47, v48, v49
    v_max3_u32 v176, v176, v50, v51
    v_max3_u32 v177, v177, v52, v53
    v_max_u32 v176, v176, v177
    v_cmp_eq_u32 vcc, -1, v176
    s_cbranch_vccz Lm_p2_76_ok1
    buffer_load_dwordx4 v[44:47], v8, s[4:7], s26 offen sc1
    buffer_load_dwordx4 v[48:51], v8, s[4:7], s26 offen offset:1024 sc1
    buffer_load_dwordx2 v[52:53], v187, s[4:7], s27 offen sc1
    s_add_u32 s21, s21, 1
    s_cmp_lt_u32 s21, 400000
    s_cbranch_scc1 Lm_p2_76
    s_mov_b32 s22, 1
Lm_p2_76_ok0:
    v_mfma_f32_16x16x32_bf16 v[160:163], v[100:103], v[132:135], 0
    v_mov_b32_dpp v142, v132 row_ror:8 row_mask:0xf bank_mask:0xf
    v_mov_b32_dpp v143, v133 row_ror:8 row_mask:0xf bank_mask:0xf
    v_mov_b32_dpp v144, v134 row_ror:8 row_mask:0xf bank_mask:0xf
    v_mfma_f32_16x16x32_bf16 v[164:167], v[104:107], v[132:135], 0
    v_mov_b32_dpp v145, v135 row_ror:8 row_mask:0xf bank_mask:0xf
    v_mov_b32_dpp v146, v136 row_ror:8 row_mask:0xf bank_mask:0xf
    v_mov_b32_dpp v147, v137 row_ror:8 row_mask:0xf bank_mask:0xf
    v_mfma_f32_16x16x32_bf16 v[160:163], v[116:119], v[136:139], v[160:163]
    v_mov_b32_dpp v148, v138 row_ror:8 row_mask:0xf bank_mask:0xf
    v_mov_b32_dpp v149, v139 row_ror:8 row_mask:0xf bank_mask:0xf
    v_mov_b32 v188, v140
    v_mfma_f32_16x16x32_bf16 v[164:167], v[120:123], v[136:139], v[164:167]
    v_mov_b32 v189, v141
    v_mov_b32_dpp v190, v140 row_ror:8 row_mask:0xf bank_mask:0xf
    v_mov_b32_dpp v191, v141 row_ror:8 row_mask:0xf bank_mask:0xf
    v_mfma_f32_16x16x32_bf16 v[160:163], v[108:111], v[142:145], v[160:163]
    v_mfma_f32_16x16x32_bf16 v[164:167], v[112:115], v[142:145], v[164:167]
    v_mfma_f32_16x16x32_bf16 v[160:163], v[124:127], v[146:149], v[160:163]
    v_mfma_f32_16x16x32_bf16 v[164:167], v[128:131], v[146:149], v[164:167]
    v_mfma_f32_16x16x32_bf16 v[160:163], v[152:155], v[188:191], v[160:163]
    v_mfma_f32_16x16x32_bf16 v[164:167], v[156:159], v[188:191], v[164:167]
    s_branch Lm_p2_76_done
Lm_p2_76_ok1:
    v_mfma_f32_16x16x32_bf16 v[160:163], v[100:103], v[44:47], 0
    v_mov_b32_dpp v142, v44 row_ror:8 row_mask:0xf bank_mask:0xf
    v_mov_b32_dpp v143, v45 row_ror:8 row_mask:0xf bank_mask:0xf
    v_mov_b32_dpp v144, v46 row_ror:8 row_mask:0xf bank_mask:0xf
    v_mfma_f32_16x16x32_bf16 v[164:167], v[104:107], v[44:47], 0
    v_mov_b32_dpp v145, v47 row_ror:8 row_mask:0xf bank_mask:0xf
    v_mov_b32_dpp v146, v48 row_ror:8 row_mask:0xf bank_mask:0xf
    v_mov_b32_dpp v147, v49 row_ror:8 row_mask:0xf bank_mask:0xf
    v_mfma_f32_16x16x32_bf16 v[160:163], v[116:119], v[48:51], v[160:163]
    v_mov_b32_dpp v148, v50 row_ror:8 row_mask:0xf bank_mask:0xf
    v_mov_b32_dpp v149, v51 row_ror:8 row_mask:0xf bank_mask:0xf
    v_mov_b32 v188, v52
    v_mfma_f32_16x16x32_bf16 v[164:167], v[120:123], v[48:51], v[164:167]
    v_mov_b32 v189, v53
    v_mov_b32_dpp v190, v52 row_ror:8 row_mask:0xf bank_mask:0xf
    v_mov_b32_dpp v191, v53 row_ror:8 row_mask:0xf bank_mask:0xf
    v_mfma_f32_16x16x32_bf16 v[160:163], v[108:111], v[142:145], v[160:163]
    v_mfma_f32_16x16x32_bf16 v[164:167], v[112:115], v[142:145], v[164:167]
    v_mfma_f32_16x16x32_bf16 v[160:163], v[124:127], v[146:149], v[160:163]
    v_mfma_f32_16x16x32_bf16 v[164:167], v[128:131], v[146:149], v[164:167]
    v_mfma_f32_16x16x32_bf16 v[160:163], v[152:155], v[188:191], v[160:163]
    v_mfma_f32_16x16x32_bf16 v[164:167], v[156:159], v[188:191], v[164:167]
Lm_p2_76_done:
    s_nop 7
    ds_write_b128 v9, v[160:163]
    ds_write_b128 v9, v[164:167] offset:1024
    s_waitcnt lgkmcnt(0)
    s_barrier
    s_cmp_lt_u32 s12, 2
    s_cbranch_scc0 Lm_v_nored_s
    ds_read_b128 v[76:79], v10 offset:0
    ds_read_b128 v[80:83], v10 offset:2048
    ds_read_b128 v[84:87], v10 offset:4096
    ds_read_b128 v[88:91], v10 offset:6144
    s_waitcnt lgkmcnt(2)
    v_pk_add_f32 v[76:77], v[76:77], v[80:81]
    v_pk_add_f32 v[78:79], v[78:79], v[82:83]
    s_waitcnt lgkmcnt(0)
    v_pk_add_f32 v[84:85], v[84:85], v[88:89]
    v_pk_add_f32 v[86:87], v[86:87], v[90:91]
    v_pk_add_f32 v[76:77], v[76:77], v[84:85]
    v_pk_add_f32 v[78:79], v[78:79], v[86:87]
    v_cvt_pk_bf16_f32 v180, v76, v77
    v_cvt_pk_bf16_f32 v181, v78, v79
    s_mov_b32 exec_lo, 0x00ff00ff
    s_mov_b32 exec_hi, 0x00ff00ff
    buffer_store_dwordx2 v[180:181], v11, s[4:7], s31 offen sc1
    s_cmp_eq_u32 s14, 62
    s_cbranch_scc0 Lm_mxe_77
    buffer_store_dwordx2 v[180:181], v11, s[4:7], s39 offen sc1
Lm_mxe_77:
    s_mov_b64 exec, -1
Lm_v_nored_s:
    s_barrier
    s_cmp_lt_u32 s12, 2
    s_cbranch_scc1 Lm_vw_78
    s_waitcnt vmcnt(0)
    s_branch Lm_vw_78_e
Lm_vw_78:
    s_waitcnt vmcnt(1)
Lm_vw_78_e:
    v_mov_b32 v44, 0
    v_mov_b32 v45, 0
    v_mov_b32 v46, 0
    v_mov_b32 v47, 0
    v_mov_b32 v48, 0
    v_mov_b32 v49, 0
    v_mov_b32 v50, 0
    v_mov_b32 v51, 0
    v_mov_b32 v52, 0
    v_mov_b32 v53, 0
    v_mov_b32 v54, 0
    v_mov_b32 v55, 0
    v_mov_b32 v56, 0
    v_mov_b32 v57, 0
    v_mov_b32 v58, 0
    v_mov_b32 v59, 0
    v_mov_b32 v60, 0
    v_mov_b32 v61, 0
    v_mov_b32 v62, 0
    v_mov_b32 v63, 0
    v_mov_b32 v64, 0
    v_mov_b32 v65, 0
    v_mov_b32 v66, 0
    v_mov_b32 v67, 0
    v_mov_b32 v68, 0
    v_mov_b32 v69, 0
    v_mov_b32 v70, 0
    v_mov_b32 v71, 0
    v_mov_b32 v72, 0
    v_mov_b32 v73, 0
    v_mov_b32 v74, 0
    v_mov_b32 v75, 0
    s_add_u32 s14, s14, 1
    s_add_u32 s15, s15, 7168
    s_add_u32 s31, s31, 7168
    s_add_u32 s26, s26, 8192
    s_add_u32 s27, s27, 2048
    s_add_u32 s29, s29, 458752
    s_add_u32 s30, s30, 114688
    s_add_u32 s37, s37, 64
    s_add_u32 s38, s38, 2048
    s_add_u32 s39, s39, 7168
    s_cmp_eq_u32 s22, 0
    s_cbranch_scc1 Lm_vstep_s
    s_branch Lm_fin
Lm_pref:
    s_mov_b32 s99, 100196352
    v_lshrrev_b32 v80, 4, v6
    v_min_u32 v80, 63, v80
    v_lshlrev_b32 v80, 4, v80
    s_mov_b32 s21, 0
Lm_wf_79:
    buffer_load_dwordx4 v[84:87], v80, s[4:7], s99 offen sc1
    s_waitcnt vmcnt(0)
    v_xor_b32 v84, s97, v84
    v_xor_b32 v85, s97, v85
    v_xor_b32 v86, s97, v86
    v_xor_b32 v87, s97, v87
    v_or_b32 v84, v84, v85
    v_or_b32 v84, v84, v86
    v_or_b32 v84, v84, v87
    v_cmp_ne_u32 vcc, 0, v84
    s_cbranch_vccz Lm_wf_79_ok
    s_sleep 1
    s_add_u32 s21, s21, 1
    s_cmp_lt_u32 s21, 400000
    s_cbranch_scc1 Lm_wf_79
Lm_wf_79_ok:
    s_mov_b32 s99, 100198400
    v_lshrrev_b32 v80, 4, v6
    v_min_u32 v80, 63, v80
    v_lshlrev_b32 v80, 4, v80
    s_mov_b32 s21, 0
Lm_wf_80:
    buffer_load_dwordx4 v[84:87], v80, s[4:7], s99 offen sc1
    s_waitcnt vmcnt(0)
    v_xor_b32 v84, s97, v84
    v_xor_b32 v85, s97, v85
    v_xor_b32 v86, s97, v86
    v_xor_b32 v87, s97, v87
    v_or_b32 v84, v84, v85
    v_or_b32 v84, v84, v86
    v_or_b32 v84, v84, v87
    v_cmp_ne_u32 vcc, 0, v84
    s_cbranch_vccz Lm_wf_80_ok
    s_sleep 1
    s_add_u32 s21, s21, 1
    s_cmp_lt_u32 s21, 400000
    s_cbranch_scc1 Lm_wf_80
Lm_wf_80_ok:
    s_sub_u32 s36, s13, 30
    s_lshl_b32 s44, s36, 2
    s_add_u32 s44, s44, s12
    s_mov_b32 s14, 0
    v_mov_b32 v9, 0
    s_cmp_eq_u32 s44, 4
    s_cbranch_scc0 Lm_pfw
    s_mov_b32 s37, 100024320
    s_mov_b32 s46, 100188160
    v_mov_b32 v28, s97
    v_mov_b32 v29, s97
    v_mov_b32 v30, s97
    v_mov_b32 v31, s97
Lm_bf:
    v_mov_b32 v20, v1
    v_min_u32 v20, 55, v20
    v_lshlrev_b32 v20, 3, v20
    s_mov_b32 s21, 0
Lm_wf_81:
    buffer_load_dwordx2 v[22:23], v20, s[4:7], s37 offen sc1
    s_waitcnt vmcnt(0)
    v_xor_b32 v22, s97, v22
    v_xor_b32 v23, s97, v23
    v_or_b32 v22, v22, v23
    v_cmp_ne_u32 vcc, 0, v22
    s_cbranch_vccz Lm_wf_81_ok
    s_sleep 2
    s_add_u32 s21, s21, 1
    s_cmp_lt_u32 s21, 400000
    s_cbranch_scc1 Lm_wf_81
Lm_wf_81_ok:
    s_cmp_eq_u32 s42, 0
    s_mov_b64 exec, 1
    s_cbranch_scc0 Lm_br_82
    buffer_store_dwordx4 v[28:31], v9, s[4:7], s46 offen
    s_branch Lm_br_82_e
Lm_br_82:
    buffer_store_dwordx4 v[28:31], v9, s[4:7], s46 offen sc1
Lm_br_82_e:
    s_mov_b64 exec, -1
    s_add_u32 s37, s37, 512
    s_add_u32 s46, s46, 64
    s_add_u32 s14, s14, 1
    s_cmp_lt_u32 s14, 64
    s_cbranch_scc1 Lm_bf
    s_branch Lm_fin
Lm_pfw:
    s_cmp_gt_u32 s44, 4
    s_cselect_b32 s45, 1, 0
    s_sub_u32 s45, s44, s45
    v_lshlrev_b32 v7, 7, v1
    s_mov_b32 s29, 47009792
    s_mov_b32 s28, 12845056
    s_mov_b32 s26, 16994304
    s_mov_b32 s27, 17518592
    s_mov_b32 s15, 16527360
    v_mov_b32 v8, 7164
    s_mov_b32 s46, 100188160
Lm_pf:
    s_cmp_lt_u32 s14, 4
    s_cbranch_scc1 Lm_pf_go
    s_add_u32 s15, s15, 7168
    s_mov_b32 s21, 0
Lm_pf_w:
    buffer_load_dword v10, v8, s[4:7], s15 offen sc1
    s_waitcnt vmcnt(0)
    v_cmp_eq_u32 vcc, -1, v10
    s_cbranch_vccz Lm_pf_go
    s_sleep 2
    s_add_u32 s21, s21, 1
    s_cmp_lt_u32 s21, 400000
    s_cbranch_scc1 Lm_pf_w
    s_branch Lm_fin
Lm_pf_go:
    s_mov_b32 s21, 0
Lm_pf_b:
    buffer_load_dword v10, v9, s[4:7], s46 offen sc1
    s_waitcnt vmcnt(0)
    v_cmp_ne_u32 vcc, s97, v10
    s_cbranch_vccz Lm_pf_bo
    s_sleep 2
    s_add_u32 s21, s21, 1
    s_cmp_lt_u32 s21, 400000
    s_cbranch_scc1 Lm_pf_b
    s_branch Lm_fin
Lm_pf_bo:
    s_add_u32 s46, s46, 64
    s_lshl_b32 s32, s45, 13
    s_add_u32 s32, s32, s28
    s_mul_i32 s33, s14, 7168
    s_add_u32 s33, s33, 16534528
    s_cmp_eq_u32 s45, 4
    s_cselect_b32 s32, s26, s32
    s_cmp_eq_u32 s45, 5
    s_cselect_b32 s32, s27, s32
    s_cmp_eq_u32 s45, 6
    s_cselect_b32 s32, s33, s32
    buffer_load_dword v18, v7, s[4:7], s32 offen
    s_waitcnt vmcnt(0)
    s_add_u32 s29, s29, 458752
    s_add_u32 s28, s28, 28672
    s_add_u32 s26, s26, 8192
    s_add_u32 s27, s27, 2048
    s_add_u32 s14, s14, 1
    s_cmp_lt_u32 s14, 64
    s_cbranch_scc1 Lm_pf
    s_branch Lm_fin
Lm_worker:
    s_sub_u32 s41, s13, 64
    s_mov_b32 s22, s12
    s_mov_b32 s78, s41
    s_cmp_lt_u32 s41, 224
    s_cbranch_scc0 Lm_exit
    s_load_dwordx2 s[60:61], s[0:1], 128
    s_load_dwordx2 s[62:63], s[0:1], 0
    s_load_dwordx2 s[64:65], s[0:1], 112
    s_load_dwordx2 s[66:67], s[0:1], 64
    s_waitcnt lgkmcnt(0)
    s_mov_b32 s16, s60
    s_and_b32 s17, s61, 0xffff
    s_mov_b32 s18, 268435456
    s_mov_b32 s19, 0x20000
    s_mov_b32 s12, s62
    s_and_b32 s13, s63, 0xffff
    s_mov_b32 s14, 1835008
    s_mov_b32 s15, 0x20000
    s_mov_b32 s44, s64
    s_and_b32 s45, s65, 0xffff
    s_mov_b32 s46, 1835008
    s_mov_b32 s47, 0x20000
    s_mov_b32 s48, s66
    s_and_b32 s49, s67, 0xffff
    s_mov_b32 s50, 896
    s_mov_b32 s51, 0x20000
    s_mov_b32 s34, 100196352
    v_mov_b32 v7, v1
    v_min_u32 v7, 63, v7
    v_lshlrev_b32 v7, 4, v7
    s_mov_b32 s21, 0
Lm_wf_83:
    buffer_load_dwordx4 v[8:11], v7, s[16:19], s34 offen sc1
    s_waitcnt vmcnt(0)
    v_xor_b32 v8, s97, v8
    v_xor_b32 v9, s97, v9
    v_xor_b32 v10, s97, v10
    v_xor_b32 v11, s97, v11
    v_or_b32 v8, v8, v9
    v_or_b32 v8, v8, v10
    v_or_b32 v8, v8, v11
    v_cmp_ne_u32 vcc, 0, v8
    s_cbranch_vccz Lm_wf_83_ok
    s_sleep 4
    s_add_u32 s21, s21, 1
    s_cmp_lt_u32 s21, 400000
    s_cbranch_scc1 Lm_wf_83
Lm_wf_83_ok:
    s_mov_b32 s34, 100198400
    v_mov_b32 v7, v1
    v_min_u32 v7, 63, v7
    v_lshlrev_b32 v7, 4, v7
    s_mov_b32 s21, 0
Lm_wf_84:
    buffer_load_dwordx4 v[8:11], v7, s[16:19], s34 offen sc1
    s_waitcnt vmcnt(0)
    v_xor_b32 v8, s97, v8
    v_xor_b32 v9, s97, v9
    v_xor_b32 v10, s97, v10
    v_xor_b32 v11, s97, v11
    v_or_b32 v8, v8, v9
    v_or_b32 v8, v8, v10
    v_or_b32 v8, v8, v11
    v_cmp_ne_u32 vcc, 0, v8
    s_cbranch_vccz Lm_wf_84_ok
    s_sleep 4
    s_add_u32 s21, s21, 1
    s_cmp_lt_u32 s21, 400000
    s_cbranch_scc1 Lm_wf_84
Lm_wf_84_ok:
    v_lshlrev_b32 v12, 4, v0
    v_mov_b32 v16, -1
    v_mov_b32 v17, -1
    v_mov_b32 v18, -1
    v_mov_b32 v19, -1
    s_lshl_b32 s28, s41, 12
    s_add_u32 s28, s28, 83709952
Lm_lf_85:
    s_cmp_lt_u32 s28, 85807104
    s_cbranch_scc0 Lm_lf_85_e
    buffer_store_dwordx4 v[16:19], v12, s[16:19], s28 offen sc1
    s_add_u32 s28, s28, 917504
    s_branch Lm_lf_85
Lm_lf_85_e:
    s_lshl_b32 s28, s41, 12
    s_add_u32 s28, s28, 85807104
Lm_lf_86:
    s_cmp_lt_u32 s28, 86331392
    s_cbranch_scc0 Lm_lf_86_e
    buffer_store_dwordx4 v[16:19], v12, s[16:19], s28 offen sc1
    s_add_u32 s28, s28, 917504
    s_branch Lm_lf_86
Lm_lf_86_e:
    s_lshl_b32 s28, s41, 12
    s_add_u32 s28, s28, 91836416
Lm_lf_87:
    s_cmp_lt_u32 s28, 91844608
    s_cbranch_scc0 Lm_lf_87_e
    buffer_store_dwordx4 v[16:19], v12, s[16:19], s28 offen sc1
    s_add_u32 s28, s28, 917504
    s_branch Lm_lf_87
Lm_lf_87_e:
    s_lshl_b32 s28, s41, 12
    s_add_u32 s28, s28, 91844608
Lm_lf_88:
    s_cmp_lt_u32 s28, 91860992
    s_cbranch_scc0 Lm_lf_88_e
    buffer_store_dwordx4 v[16:19], v12, s[16:19], s28 offen sc1
    s_add_u32 s28, s28, 917504
    s_branch Lm_lf_88
Lm_lf_88_e:
    s_lshl_b32 s28, s41, 12
    s_add_u32 s28, s28, 91860992
Lm_lf_89:
    s_cmp_lt_u32 s28, 91877376
    s_cbranch_scc0 Lm_lf_89_e
    buffer_store_dwordx4 v[16:19], v12, s[16:19], s28 offen sc1
    s_add_u32 s28, s28, 917504
    s_branch Lm_lf_89
Lm_lf_89_e:
    s_lshl_b32 s28, s41, 12
    s_add_u32 s28, s28, 90001408
Lm_lf_90:
    s_cmp_lt_u32 s28, 91836416
    s_cbranch_scc0 Lm_lf_90_e
    buffer_store_dwordx4 v[16:19], v12, s[16:19], s28 offen sc1
    s_add_u32 s28, s28, 917504
    s_branch Lm_lf_90
Lm_lf_90_e:
    s_lshl_b32 s28, s41, 12
    s_add_u32 s28, s28, 99794944
Lm_lf_91:
    s_cmp_lt_u32 s28, 100024320
    s_cbranch_scc0 Lm_lf_91_e
    buffer_store_dwordx4 v[16:19], v12, s[16:19], s28 offen sc1
    s_add_u32 s28, s28, 917504
    s_branch Lm_lf_91
Lm_lf_91_e:
    s_nop 1
    s_mov_b32 s20, s41
    s_and_b32 s21, s20, 1
    s_lshr_b32 s23, s20, 1
    s_lshl_b32 s23, s23, 2
    s_add_u32 s23, s23, s22
    v_and_b32 v2, 31, v1
    v_lshrrev_b32 v3, 5, v1
    v_and_b32 v4, 0x13, v2
    v_bfe_u32 v5, v2, 2, 1
    v_lshlrev_b32 v5, 3, v5
    v_or_b32 v4, v4, v5
    v_bfe_u32 v5, v2, 3, 1
    v_lshlrev_b32 v5, 2, v5
    v_or_b32 v4, v4, v5
    s_cmp_lt_u32 s23, 224
    s_cselect_b64 vcc, -1, 0
    s_cselect_b32 s24, 1, 0
    s_nop 1
    v_cndmask_b32 v6, v2, v4, vcc
    v_cndmask_b32 v7, v4, v2, vcc
    v_mul_u32_u24 v6, 896, v6
    v_lshlrev_b32 v5, 4, v3
    v_add_u32 v6, v6, v5
    s_mul_i32 s25, s23, 28672
    s_add_u32 s25, s25, 0
    buffer_load_dwordx4 v[32:35], v6, s[16:19], s25 offen offset:0
    buffer_load_dwordx4 v[36:39], v6, s[16:19], s25 offen offset:32
    buffer_load_dwordx4 v[40:43], v6, s[16:19], s25 offen offset:64
    buffer_load_dwordx4 v[44:47], v6, s[16:19], s25 offen offset:96
    buffer_load_dwordx4 v[48:51], v6, s[16:19], s25 offen offset:128
    buffer_load_dwordx4 v[52:55], v6, s[16:19], s25 offen offset:160
    buffer_load_dwordx4 v[56:59], v6, s[16:19], s25 offen offset:192
    buffer_load_dwordx4 v[60:63], v6, s[16:19], s25 offen offset:224
    buffer_load_dwordx4 v[64:67], v6, s[16:19], s25 offen offset:256
    buffer_load_dwordx4 v[68:71], v6, s[16:19], s25 offen offset:288
    buffer_load_dwordx4 v[72:75], v6, s[16:19], s25 offen offset:320
    buffer_load_dwordx4 v[76:79], v6, s[16:19], s25 offen offset:352
    buffer_load_dwordx4 v[80:83], v6, s[16:19], s25 offen offset:384
    buffer_load_dwordx4 v[84:87], v6, s[16:19], s25 offen offset:416
    buffer_load_dwordx4 v[88:91], v6, s[16:19], s25 offen offset:448
    buffer_load_dwordx4 v[92:95], v6, s[16:19], s25 offen offset:480
    buffer_load_dwordx4 v[96:99], v6, s[16:19], s25 offen offset:512
    buffer_load_dwordx4 v[100:103], v6, s[16:19], s25 offen offset:544
    buffer_load_dwordx4 v[104:107], v6, s[16:19], s25 offen offset:576
    buffer_load_dwordx4 v[108:111], v6, s[16:19], s25 offen offset:608
    buffer_load_dwordx4 v[112:115], v6, s[16:19], s25 offen offset:640
    buffer_load_dwordx4 v[116:119], v6, s[16:19], s25 offen offset:672
    buffer_load_dwordx4 v[120:123], v6, s[16:19], s25 offen offset:704
    buffer_load_dwordx4 v[124:127], v6, s[16:19], s25 offen offset:736
    buffer_load_dwordx4 v[128:131], v6, s[16:19], s25 offen offset:768
    buffer_load_dwordx4 v[132:135], v6, s[16:19], s25 offen offset:800
    buffer_load_dwordx4 v[136:139], v6, s[16:19], s25 offen offset:832
    buffer_load_dwordx4 v[140:143], v6, s[16:19], s25 offen offset:864
    v_lshlrev_b32 v8, 9, v3
    v_lshlrev_b32 v5, 4, v7
    v_add_u32 v8, v8, v5
    v_lshrrev_b32 v10, 4, v2
    v_and_b32 v11, 15, v2
    v_lshlrev_b32 v12, 4, v3
    v_add_u32 v11, v11, v12
    v_lshlrev_b32 v11, 4, v11
    v_lshlrev_b32 v12, 10, v10
    v_lshlrev_b32 v13, 14, v10
    v_cndmask_b32 v12, v13, v12, vcc
    v_add_u32 v9, v11, v12
    s_cmp_lt_u32 s23, 224
    s_cselect_b32 s28, 0, 224
    s_sub_u32 s28, s23, s28
    s_mul_i32 s29, s28, 4682
    s_lshr_b32 s29, s29, 16
    s_mul_i32 s30, s29, 14
    s_sub_u32 s30, s28, s30
    s_cmp_eq_u32 s24, 1
    s_cbranch_scc1 Lm_pT_92
    s_lshl_b32 s26, s30, 15
    s_lshl_b32 s31, s29, 10
    s_add_u32 s26, s26, s31
    s_add_u32 s26, s26, 47009792
    s_mov_b32 s27, 458752
    s_branch Lm_pJ_93
Lm_pT_92:
    s_mul_i32 s26, s29, 28672
    s_lshl_b32 s31, s30, 11
    s_add_u32 s26, s26, s31
    s_add_u32 s26, s26, 17649664
    s_mov_b32 s27, 458752
Lm_pJ_93:
    s_mul_i32 s31, s21, s27
    s_add_u32 s26, s26, s31
    s_lshl_b32 s27, s27, 1
    v_lshlrev_b32 v14, 4, v1
    s_mul_i32 s32, s21, 28672
    s_mul_i32 s31, s22, 7168
    s_add_u32 s32, s32, s31
    s_add_u32 s32, s32, 14680064
    s_mov_b32 s33, s31
    s_mov_b32 s34, 0
    s_add_u32 s35, s33, s34
    s_mov_b32 m0, s35
    s_nop 0
    buffer_load_dwordx4 v14, s[16:19], s32 offen offset:0 lds
    buffer_load_dwordx4 v14, s[16:19], s32 offen offset:1024 lds
    buffer_load_dwordx4 v14, s[16:19], s32 offen offset:2048 lds
    buffer_load_dwordx4 v14, s[16:19], s32 offen offset:3072 lds
    s_add_u32 s35, s35, 4096
    s_add_u32 s36, s32, 4096
    s_mov_b32 m0, s35
    s_nop 0
    buffer_load_dwordx4 v14, s[16:19], s36 offen offset:0 lds
    buffer_load_dwordx4 v14, s[16:19], s36 offen offset:1024 lds
    buffer_load_dwordx4 v14, s[16:19], s36 offen offset:2048 lds
    s_add_u32 s32, s32, 57344
    v_mov_b32 v16, s97
    v_mov_b32 v17, 0
    s_lshl_b32 s38, s21, 9
    s_lshr_b32 s39, s20, 1
    s_lshl_b32 s39, s39, 2
    s_add_u32 s38, s38, s39
    s_add_u32 s38, s38, 100024320
    s_mov_b32 s37, 0
    s_waitcnt vmcnt(0)
Lm_pl_94:
    s_waitcnt vmcnt(2)
    s_barrier
    s_cmp_ge_u32 s37, 2
    s_cbranch_scc0 Lm_pf_95
    s_cmp_eq_u32 s22, 0
    s_cbranch_scc0 Lm_pf_95
    s_mov_b64 exec, 1
    buffer_store_dword v16, v17, s[16:19], s38 offen sc1
    s_mov_b64 exec, -1
    s_add_u32 s38, s38, 1024
Lm_pf_95:
    v_add_u32 v15, s34, v8
    s_xor_b32 s34, s34, 28672
    s_cmp_lt_u32 s37, 31
    s_cbranch_scc0 Lm_pn_96
    s_add_u32 s35, s33, s34
    s_mov_b32 m0, s35
    s_nop 0
    buffer_load_dwordx4 v14, s[16:19], s32 offen offset:0 lds
    buffer_load_dwordx4 v14, s[16:19], s32 offen offset:1024 lds
    buffer_load_dwordx4 v14, s[16:19], s32 offen offset:2048 lds
    buffer_load_dwordx4 v14, s[16:19], s32 offen offset:3072 lds
    s_add_u32 s35, s35, 4096
    s_add_u32 s36, s32, 4096
    s_mov_b32 m0, s35
    s_nop 0
    buffer_load_dwordx4 v14, s[16:19], s36 offen offset:0 lds
    buffer_load_dwordx4 v14, s[16:19], s36 offen offset:1024 lds
    buffer_load_dwordx4 v14, s[16:19], s36 offen offset:2048 lds
    s_add_u32 s32, s32, 57344
Lm_pn_96:
    v_mov_b32 v144, 0
    v_mov_b32 v145, 0
    v_mov_b32 v146, 0
    v_mov_b32 v147, 0
    v_mov_b32 v148, 0
    v_mov_b32 v149, 0
    v_mov_b32 v150, 0
    v_mov_b32 v151, 0
    v_mov_b32 v152, 0
    v_mov_b32 v153, 0
    v_mov_b32 v154, 0
    v_mov_b32 v155, 0
    v_mov_b32 v156, 0
    v_mov_b32 v157, 0
    v_mov_b32 v158, 0
    v_mov_b32 v159, 0
    s_cmp_eq_u32 s24, 1
    s_cbranch_scc0 Lm_pv_97_b
    ds_read_b128 v[160:163], v15 offset:0
    ds_read_b128 v[164:167], v15 offset:1024
    ds_read_b128 v[168:171], v15 offset:2048
    s_waitcnt lgkmcnt(2)
    v_mfma_f32_32x32x16_bf16 v[144:159], v[32:35], v[160:163], v[144:159]
    ds_read_b128 v[160:163], v15 offset:3072
    s_waitcnt lgkmcnt(2)
    v_mfma_f32_32x32x16_bf16 v[144:159], v[36:39], v[164:167], v[144:159]
    ds_read_b128 v[164:167], v15 offset:4096
    s_waitcnt lgkmcnt(2)
    v_mfma_f32_32x32x16_bf16 v[144:159], v[40:43], v[168:171], v[144:159]
    ds_read_b128 v[168:171], v15 offset:5120
    s_waitcnt lgkmcnt(2)
    v_mfma_f32_32x32x16_bf16 v[144:159], v[44:47], v[160:163], v[144:159]
    ds_read_b128 v[160:163], v15 offset:6144
    s_waitcnt lgkmcnt(2)
    v_mfma_f32_32x32x16_bf16 v[144:159], v[48:51], v[164:167], v[144:159]
    ds_read_b128 v[164:167], v15 offset:7168
    s_waitcnt lgkmcnt(2)
    v_mfma_f32_32x32x16_bf16 v[144:159], v[52:55], v[168:171], v[144:159]
    ds_read_b128 v[168:171], v15 offset:8192
    s_waitcnt lgkmcnt(2)
    v_mfma_f32_32x32x16_bf16 v[144:159], v[56:59], v[160:163], v[144:159]
    ds_read_b128 v[160:163], v15 offset:9216
    s_waitcnt lgkmcnt(2)
    v_mfma_f32_32x32x16_bf16 v[144:159], v[60:63], v[164:167], v[144:159]
    ds_read_b128 v[164:167], v15 offset:10240
    s_waitcnt lgkmcnt(2)
    v_mfma_f32_32x32x16_bf16 v[144:159], v[64:67], v[168:171], v[144:159]
    ds_read_b128 v[168:171], v15 offset:11264
    s_waitcnt lgkmcnt(2)
    v_mfma_f32_32x32x16_bf16 v[144:159], v[68:71], v[160:163], v[144:159]
    ds_read_b128 v[160:163], v15 offset:12288
    s_waitcnt lgkmcnt(2)
    v_mfma_f32_32x32x16_bf16 v[144:159], v[72:75], v[164:167], v[144:159]
    ds_read_b128 v[164:167], v15 offset:13312
    s_waitcnt lgkmcnt(2)
    v_mfma_f32_32x32x16_bf16 v[144:159], v[76:79], v[168:171], v[144:159]
    ds_read_b128 v[168:171], v15 offset:14336
    s_waitcnt lgkmcnt(2)
    v_mfma_f32_32x32x16_bf16 v[144:159], v[80:83], v[160:163], v[144:159]
    ds_read_b128 v[160:163], v15 offset:15360
    s_waitcnt lgkmcnt(2)
    v_mfma_f32_32x32x16_bf16 v[144:159], v[84:87], v[164:167], v[144:159]
    ds_read_b128 v[164:167], v15 offset:16384
    s_waitcnt lgkmcnt(2)
    v_mfma_f32_32x32x16_bf16 v[144:159], v[88:91], v[168:171], v[144:159]
    ds_read_b128 v[168:171], v15 offset:17408
    s_waitcnt lgkmcnt(2)
    v_mfma_f32_32x32x16_bf16 v[144:159], v[92:95], v[160:163], v[144:159]
    ds_read_b128 v[160:163], v15 offset:18432
    s_waitcnt lgkmcnt(2)
    v_mfma_f32_32x32x16_bf16 v[144:159], v[96:99], v[164:167], v[144:159]
    ds_read_b128 v[164:167], v15 offset:19456
    s_waitcnt lgkmcnt(2)
    v_mfma_f32_32x32x16_bf16 v[144:159], v[100:103], v[168:171], v[144:159]
    ds_read_b128 v[168:171], v15 offset:20480
    s_waitcnt lgkmcnt(2)
    v_mfma_f32_32x32x16_bf16 v[144:159], v[104:107], v[160:163], v[144:159]
    ds_read_b128 v[160:163], v15 offset:21504
    s_waitcnt lgkmcnt(2)
    v_mfma_f32_32x32x16_bf16 v[144:159], v[108:111], v[164:167], v[144:159]
    ds_read_b128 v[164:167], v15 offset:22528
    s_waitcnt lgkmcnt(2)
    v_mfma_f32_32x32x16_bf16 v[144:159], v[112:115], v[168:171], v[144:159]
    ds_read_b128 v[168:171], v15 offset:23552
    s_waitcnt lgkmcnt(2)
    v_mfma_f32_32x32x16_bf16 v[144:159], v[116:119], v[160:163], v[144:159]
    ds_read_b128 v[160:163], v15 offset:24576
    s_waitcnt lgkmcnt(2)
    v_mfma_f32_32x32x16_bf16 v[144:159], v[120:123], v[164:167], v[144:159]
    ds_read_b128 v[164:167], v15 offset:25600
    s_waitcnt lgkmcnt(2)
    v_mfma_f32_32x32x16_bf16 v[144:159], v[124:127], v[168:171], v[144:159]
    ds_read_b128 v[168:171], v15 offset:26624
    s_waitcnt lgkmcnt(2)
    v_mfma_f32_32x32x16_bf16 v[144:159], v[128:131], v[160:163], v[144:159]
    ds_read_b128 v[160:163], v15 offset:27648
    s_waitcnt lgkmcnt(2)
    v_mfma_f32_32x32x16_bf16 v[144:159], v[132:135], v[164:167], v[144:159]
    s_waitcnt lgkmcnt(1)
    v_mfma_f32_32x32x16_bf16 v[144:159], v[136:139], v[168:171], v[144:159]
    s_waitcnt lgkmcnt(0)
    v_mfma_f32_32x32x16_bf16 v[144:159], v[140:143], v[160:163], v[144:159]
    s_branch Lm_pv_97_j
Lm_pv_97_b:
    ds_read_b128 v[160:163], v15 offset:0
    ds_read_b128 v[164:167], v15 offset:1024
    ds_read_b128 v[168:171], v15 offset:2048
    s_waitcnt lgkmcnt(2)
    v_mfma_f32_32x32x16_bf16 v[144:159], v[160:163], v[32:35], v[144:159]
    ds_read_b128 v[160:163], v15 offset:3072
    s_waitcnt lgkmcnt(2)
    v_mfma_f32_32x32x16_bf16 v[144:159], v[164:167], v[36:39], v[144:159]
    ds_read_b128 v[164:167], v15 offset:4096
    s_waitcnt lgkmcnt(2)
    v_mfma_f32_32x32x16_bf16 v[144:159], v[168:171], v[40:43], v[144:159]
    ds_read_b128 v[168:171], v15 offset:5120
    s_waitcnt lgkmcnt(2)
    v_mfma_f32_32x32x16_bf16 v[144:159], v[160:163], v[44:47], v[144:159]
    ds_read_b128 v[160:163], v15 offset:6144
    s_waitcnt lgkmcnt(2)
    v_mfma_f32_32x32x16_bf16 v[144:159], v[164:167], v[48:51], v[144:159]
    ds_read_b128 v[164:167], v15 offset:7168
    s_waitcnt lgkmcnt(2)
    v_mfma_f32_32x32x16_bf16 v[144:159], v[168:171], v[52:55], v[144:159]
    ds_read_b128 v[168:171], v15 offset:8192
    s_waitcnt lgkmcnt(2)
    v_mfma_f32_32x32x16_bf16 v[144:159], v[160:163], v[56:59], v[144:159]
    ds_read_b128 v[160:163], v15 offset:9216
    s_waitcnt lgkmcnt(2)
    v_mfma_f32_32x32x16_bf16 v[144:159], v[164:167], v[60:63], v[144:159]
    ds_read_b128 v[164:167], v15 offset:10240
    s_waitcnt lgkmcnt(2)
    v_mfma_f32_32x32x16_bf16 v[144:159], v[168:171], v[64:67], v[144:159]
    ds_read_b128 v[168:171], v15 offset:11264
    s_waitcnt lgkmcnt(2)
    v_mfma_f32_32x32x16_bf16 v[144:159], v[160:163], v[68:71], v[144:159]
    ds_read_b128 v[160:163], v15 offset:12288
    s_waitcnt lgkmcnt(2)
    v_mfma_f32_32x32x16_bf16 v[144:159], v[164:167], v[72:75], v[144:159]
    ds_read_b128 v[164:167], v15 offset:13312
    s_waitcnt lgkmcnt(2)
    v_mfma_f32_32x32x16_bf16 v[144:159], v[168:171], v[76:79], v[144:159]
    ds_read_b128 v[168:171], v15 offset:14336
    s_waitcnt lgkmcnt(2)
    v_mfma_f32_32x32x16_bf16 v[144:159], v[160:163], v[80:83], v[144:159]
    ds_read_b128 v[160:163], v15 offset:15360
    s_waitcnt lgkmcnt(2)
    v_mfma_f32_32x32x16_bf16 v[144:159], v[164:167], v[84:87], v[144:159]
    ds_read_b128 v[164:167], v15 offset:16384
    s_waitcnt lgkmcnt(2)
    v_mfma_f32_32x32x16_bf16 v[144:159], v[168:171], v[88:91], v[144:159]
    ds_read_b128 v[168:171], v15 offset:17408
    s_waitcnt lgkmcnt(2)
    v_mfma_f32_32x32x16_bf16 v[144:159], v[160:163], v[92:95], v[144:159]
    ds_read_b128 v[160:163], v15 offset:18432
    s_waitcnt lgkmcnt(2)
    v_mfma_f32_32x32x16_bf16 v[144:159], v[164:167], v[96:99], v[144:159]
    ds_read_b128 v[164:167], v15 offset:19456
    s_waitcnt lgkmcnt(2)
    v_mfma_f32_32x32x16_bf16 v[144:159], v[168:171], v[100:103], v[144:159]
    ds_read_b128 v[168:171], v15 offset:20480
    s_waitcnt lgkmcnt(2)
    v_mfma_f32_32x32x16_bf16 v[144:159], v[160:163], v[104:107], v[144:159]
    ds_read_b128 v[160:163], v15 offset:21504
    s_waitcnt lgkmcnt(2)
    v_mfma_f32_32x32x16_bf16 v[144:159], v[164:167], v[108:111], v[144:159]
    ds_read_b128 v[164:167], v15 offset:22528
    s_waitcnt lgkmcnt(2)
    v_mfma_f32_32x32x16_bf16 v[144:159], v[168:171], v[112:115], v[144:159]
    ds_read_b128 v[168:171], v15 offset:23552
    s_waitcnt lgkmcnt(2)
    v_mfma_f32_32x32x16_bf16 v[144:159], v[160:163], v[116:119], v[144:159]
    ds_read_b128 v[160:163], v15 offset:24576
    s_waitcnt lgkmcnt(2)
    v_mfma_f32_32x32x16_bf16 v[144:159], v[164:167], v[120:123], v[144:159]
    ds_read_b128 v[164:167], v15 offset:25600
    s_waitcnt lgkmcnt(2)
    v_mfma_f32_32x32x16_bf16 v[144:159], v[168:171], v[124:127], v[144:159]
    ds_read_b128 v[168:171], v15 offset:26624
    s_waitcnt lgkmcnt(2)
    v_mfma_f32_32x32x16_bf16 v[144:159], v[160:163], v[128:131], v[144:159]
    ds_read_b128 v[160:163], v15 offset:27648
    s_waitcnt lgkmcnt(2)
    v_mfma_f32_32x32x16_bf16 v[144:159], v[164:167], v[132:135], v[144:159]
    s_waitcnt lgkmcnt(1)
    v_mfma_f32_32x32x16_bf16 v[144:159], v[168:171], v[136:139], v[144:159]
    s_waitcnt lgkmcnt(0)
    v_mfma_f32_32x32x16_bf16 v[144:159], v[160:163], v[140:143], v[144:159]
Lm_pv_97_j:
    s_nop 15
    v_cvt_pk_bf16_f32 v176, v144, v145
    v_cvt_pk_bf16_f32 v177, v146, v147
    v_cvt_pk_bf16_f32 v178, v148, v149
    v_cvt_pk_bf16_f32 v179, v150, v151
    v_cvt_pk_bf16_f32 v180, v152, v153
    v_cvt_pk_bf16_f32 v181, v154, v155
    v_cvt_pk_bf16_f32 v182, v156, v157
    v_cvt_pk_bf16_f32 v183, v158, v159
    buffer_store_dwordx4 v[176:179], v9, s[16:19], s26 offen sc1
    buffer_store_dwordx4 v[180:183], v9, s[16:19], s26 offen offset:512 sc1
    s_add_u32 s26, s26, s27
    s_add_u32 s37, s37, 1
    s_cmp_lt_u32 s37, 32
    s_cbranch_scc1 Lm_pl_94
    s_waitcnt vmcnt(0)
    s_barrier
    s_cmp_eq_u32 s22, 0
    s_cbranch_scc0 Lm_pe_99
    s_mov_b64 exec, 1
    buffer_store_dword v16, v17, s[16:19], s38 offen sc1
    s_add_u32 s38, s38, 1024
    buffer_store_dword v16, v17, s[16:19], s38 offen sc1
    s_mov_b64 exec, -1
Lm_pe_99:
    s_cmp_eq_u32 s22, 0
    s_cbranch_scc0 Lm_ff_100
    s_lshl_b32 s28, s41, 2
    s_add_u32 s28, s28, 100199424
    v_mov_b32 v16, s97
    v_mov_b32 v17, 0
    s_mov_b64 exec, 1
    buffer_store_dword v16, v17, s[16:19], s28 offen sc1
    s_mov_b64 exec, -1
Lm_ff_100:
    s_mov_b32 s34, 100199424
    v_mov_b32 v7, v1
    v_min_u32 v7, 55, v7
    v_lshlrev_b32 v7, 4, v7
    s_mov_b32 s21, 0
Lm_wf_101:
    buffer_load_dwordx4 v[8:11], v7, s[16:19], s34 offen sc1
    s_waitcnt vmcnt(0)
    v_xor_b32 v8, s97, v8
    v_xor_b32 v9, s97, v9
    v_xor_b32 v10, s97, v10
    v_xor_b32 v11, s97, v11
    v_or_b32 v8, v8, v9
    v_or_b32 v8, v8, v10
    v_or_b32 v8, v8, v11
    v_cmp_ne_u32 vcc, 0, v8
    s_cbranch_vccz Lm_wf_101_ok
    s_sleep 4
    s_add_u32 s21, s21, 1
    s_cmp_lt_u32 s21, 400000
    s_cbranch_scc1 Lm_wf_101
Lm_wf_101_ok:
    s_mov_b32 s40, s41
Lm_task:
    s_cmp_lt_u32 s40, 704
    s_cbranch_scc0 Lm_wdone
    s_barrier
    s_mul_i32 s20, s40, 5958
    s_lshr_b32 s20, s20, 16
    s_mul_i32 s21, s20, 11
    s_sub_u32 s21, s40, s21
    s_cmp_lt_u32 s21, 4
    s_cbranch_scc0 Lm_tx2
    v_and_b32 v2, 15, v1
    v_lshrrev_b32 v3, 4, v1
    v_lshlrev_b32 v4, 4, v1
    s_mul_i32 s23, s20, 28672
    s_add_u32 s23, s23, 12845056
    s_mul_i32 s24, s22, 7168
    s_add_u32 s23, s23, s24
    s_mov_b32 m0, s24
    s_nop 0
    buffer_load_dwordx4 v4, s[16:19], s23 offen offset:0 lds
    buffer_load_dwordx4 v4, s[16:19], s23 offen offset:1024 lds
    buffer_load_dwordx4 v4, s[16:19], s23 offen offset:2048 lds
    buffer_load_dwordx4 v4, s[16:19], s23 offen offset:3072 lds
    s_add_u32 s24, s24, 4096
    s_add_u32 s23, s23, 4096
    s_mov_b32 m0, s24
    s_nop 0
    buffer_load_dwordx4 v4, s[16:19], s23 offen offset:0 lds
    buffer_load_dwordx4 v4, s[16:19], s23 offen offset:1024 lds
    buffer_load_dwordx4 v4, s[16:19], s23 offen offset:2048 lds
    s_lshl_b32 s34, s20, 9
    s_add_u32 s34, s34, 100024320
    v_mov_b32 v11, v1
    v_min_u32 v11, 55, v11
    v_lshlrev_b32 v11, 3, v11
    s_mov_b32 s36, 0
Lm_wf_102:
    buffer_load_dwordx2 v[12:13], v11, s[16:19], s34 offen sc1
    s_waitcnt vmcnt(0)
    v_xor_b32 v12, s97, v12
    v_xor_b32 v13, s97, v13
    v_or_b32 v12, v12, v13
    v_cmp_ne_u32 vcc, 0, v12
    s_cbranch_vccz Lm_wf_102_ok
    s_sleep 8
    s_add_u32 s36, s36, 1
    s_cmp_lt_u32 s36, 400000
    s_cbranch_scc1 Lm_wf_102
Lm_wf_102_ok:
    s_lshl_b32 s25, s21, 2
    s_add_u32 s25, s25, s22
    s_lshl_b32 s26, s20, 4
    s_add_u32 s26, s26, s25
    s_mul_i32 s26, s26, 28672
    s_add_u32 s26, s26, 17649664
    s_add_u32 s27, s26, 0
    buffer_load_dwordx4 v[32:35], v4, s[16:19], s27 offen offset:0 sc1
    buffer_load_dwordx4 v[36:39], v4, s[16:19], s27 offen offset:2048 sc1
    s_add_u32 s27, s27, 4096
    buffer_load_dwordx4 v[40:43], v4, s[16:19], s27 offen offset:0 sc1
    buffer_load_dwordx4 v[44:47], v4, s[16:19], s27 offen offset:2048 sc1
    s_add_u32 s27, s27, 4096
    buffer_load_dwordx4 v[48:51], v4, s[16:19], s27 offen offset:0 sc1
    buffer_load_dwordx4 v[52:55], v4, s[16:19], s27 offen offset:2048 sc1
    s_add_u32 s27, s27, 4096
    buffer_load_dwordx4 v[56:59], v4, s[16:19], s27 offen offset:0 sc1
    buffer_load_dwordx4 v[60:63], v4, s[16:19], s27 offen offset:2048 sc1
    s_add_u32 s27, s27, 4096
    buffer_load_dwordx4 v[64:67], v4, s[16:19], s27 offen offset:0 sc1
    buffer_load_dwordx4 v[68:71], v4, s[16:19], s27 offen offset:2048 sc1
    s_add_u32 s27, s27, 4096
    buffer_load_dwordx4 v[72:75], v4, s[16:19], s27 offen offset:0 sc1
    buffer_load_dwordx4 v[76:79], v4, s[16:19], s27 offen offset:2048 sc1
    s_add_u32 s27, s27, 4096
    buffer_load_dwordx4 v[80:83], v4, s[16:19], s27 offen offset:0 sc1
    buffer_load_dwordx4 v[84:87], v4, s[16:19], s27 offen offset:2048 sc1
    s_add_u32 s27, s27, 4096
    s_add_u32 s27, s26, 1024
    buffer_load_dwordx4 v[88:91], v4, s[16:19], s27 offen offset:0 sc1
    buffer_load_dwordx4 v[92:95], v4, s[16:19], s27 offen offset:2048 sc1
    s_add_u32 s27, s27, 4096
    buffer_load_dwordx4 v[96:99], v4, s[16:19], s27 offen offset:0 sc1
    buffer_load_dwordx4 v[100:103], v4, s[16:19], s27 offen offset:2048 sc1
    s_add_u32 s27, s27, 4096
    buffer_load_dwordx4 v[104:107], v4, s[16:19], s27 offen offset:0 sc1
    buffer_load_dwordx4 v[108:111], v4, s[16:19], s27 offen offset:2048 sc1
    s_add_u32 s27, s27, 4096
    buffer_load_dwordx4 v[112:115], v4, s[16:19], s27 offen offset:0 sc1
    buffer_load_dwordx4 v[116:119], v4, s[16:19], s27 offen offset:2048 sc1
    s_add_u32 s27, s27, 4096
    buffer_load_dwordx4 v[120:123], v4, s[16:19], s27 offen offset:0 sc1
    buffer_load_dwordx4 v[124:127], v4, s[16:19], s27 offen offset:2048 sc1
    s_add_u32 s27, s27, 4096
    buffer_load_dwordx4 v[128:131], v4, s[16:19], s27 offen offset:0 sc1
    buffer_load_dwordx4 v[132:135], v4, s[16:19], s27 offen offset:2048 sc1
    s_add_u32 s27, s27, 4096
    buffer_load_dwordx4 v[136:139], v4, s[16:19], s27 offen offset:0 sc1
    buffer_load_dwordx4 v[140:143], v4, s[16:19], s27 offen offset:2048 sc1
    s_add_u32 s27, s27, 4096
    v_lshlrev_b32 v5, 7, v3
    v_and_b32 v6, 7, v2
    v_lshlrev_b32 v6, 4, v6
    v_add_u32 v5, v5, v6
    s_mul_i32 s28, s20, 7168
    s_add_u32 s28, s28, 91942912
    s_add_u32 s29, s28, 4096
    v_lshrrev_b32 v7, 2, v2
    v_lshlrev_b32 v7, 3, v7
    v_and_b32 v8, 3, v2
    v_add_u32 v7, v7, v8
    v_lshlrev_b32 v7, 4, v7
    v_lshlrev_b32 v8, 9, v3
    v_add_u32 v7, v7, v8
    v_lshlrev_b32 v9, 3, v3
    v_sub_u32 v9, v9, v2
    v_mov_b32 v200, 0
    v_mov_b32 v201, 0
    v_mov_b32 v202, 0
    v_mov_b32 v203, 0
    v_mov_b32 v204, 0
    v_mov_b32 v205, 0
    v_mov_b32 v206, 0
    v_mov_b32 v207, 0
    v_mov_b32 v208, 0
    v_mov_b32 v209, 0
    v_mov_b32 v210, 0
    v_mov_b32 v211, 0
    v_mov_b32 v212, 0
    v_mov_b32 v213, 0
    v_mov_b32 v214, 0
    v_mov_b32 v215, 0
    v_mov_b32 v216, 0
    v_mov_b32 v217, 0
    v_mov_b32 v218, 0
    v_mov_b32 v219, 0
    v_mov_b32 v220, 0
    v_mov_b32 v221, 0
    v_mov_b32 v222, 0
    v_mov_b32 v223, 0
    s_waitcnt vmcnt(0)
    s_barrier
    ds_read_b128 v[224:227], v7 offset:0
    ds_read_b128 v[228:231], v7 offset:64
    ds_read_b128 v[232:235], v7 offset:2048
    s_waitcnt lgkmcnt(2)
    v_mfma_f32_16x16x32_bf16 v[200:203], v[224:227], v[32:35], v[200:203]
    v_mfma_f32_16x16x32_bf16 v[212:215], v[224:227], v[88:91], v[212:215]
    ds_read_b128 v[224:227], v7 offset:2112
    s_waitcnt lgkmcnt(2)
    v_mfma_f32_16x16x32_bf16 v[204:207], v[228:231], v[32:35], v[204:207]
    v_mfma_f32_16x16x32_bf16 v[216:219], v[228:231], v[88:91], v[216:219]
    ds_read_b128 v[228:231], v7 offset:4096
    s_waitcnt lgkmcnt(2)
    v_mfma_f32_16x16x32_bf16 v[200:203], v[232:235], v[36:39], v[200:203]
    v_mfma_f32_16x16x32_bf16 v[212:215], v[232:235], v[92:95], v[212:215]
    ds_read_b128 v[232:235], v7 offset:4160
    s_waitcnt lgkmcnt(2)
    v_mfma_f32_16x16x32_bf16 v[204:207], v[224:227], v[36:39], v[204:207]
    v_mfma_f32_16x16x32_bf16 v[216:219], v[224:227], v[92:95], v[216:219]
    ds_read_b128 v[224:227], v7 offset:6144
    s_waitcnt lgkmcnt(2)
    v_mfma_f32_16x16x32_bf16 v[200:203], v[228:231], v[40:43], v[200:203]
    v_mfma_f32_16x16x32_bf16 v[212:215], v[228:231], v[96:99], v[212:215]
    ds_read_b128 v[228:231], v7 offset:6208
    s_waitcnt lgkmcnt(2)
    v_mfma_f32_16x16x32_bf16 v[204:207], v[232:235], v[40:43], v[204:207]
    v_mfma_f32_16x16x32_bf16 v[216:219], v[232:235], v[96:99], v[216:219]
    ds_read_b128 v[232:235], v7 offset:8192
    s_waitcnt lgkmcnt(2)
    v_mfma_f32_16x16x32_bf16 v[200:203], v[224:227], v[44:47], v[200:203]
    v_mfma_f32_16x16x32_bf16 v[212:215], v[224:227], v[100:103], v[212:215]
    ds_read_b128 v[224:227], v7 offset:8256
    s_waitcnt lgkmcnt(2)
    v_mfma_f32_16x16x32_bf16 v[204:207], v[228:231], v[44:47], v[204:207]
    v_mfma_f32_16x16x32_bf16 v[216:219], v[228:231], v[100:103], v[216:219]
    ds_read_b128 v[228:231], v7 offset:10240
    s_waitcnt lgkmcnt(2)
    v_mfma_f32_16x16x32_bf16 v[200:203], v[232:235], v[48:51], v[200:203]
    v_mfma_f32_16x16x32_bf16 v[212:215], v[232:235], v[104:107], v[212:215]
    ds_read_b128 v[232:235], v7 offset:10304
    s_waitcnt lgkmcnt(2)
    v_mfma_f32_16x16x32_bf16 v[204:207], v[224:227], v[48:51], v[204:207]
    v_mfma_f32_16x16x32_bf16 v[216:219], v[224:227], v[104:107], v[216:219]
    ds_read_b128 v[224:227], v7 offset:12288
    s_waitcnt lgkmcnt(2)
    v_mfma_f32_16x16x32_bf16 v[200:203], v[228:231], v[52:55], v[200:203]
    v_mfma_f32_16x16x32_bf16 v[212:215], v[228:231], v[108:111], v[212:215]
    ds_read_b128 v[228:231], v7 offset:12352
    s_waitcnt lgkmcnt(2)
    v_mfma_f32_16x16x32_bf16 v[204:207], v[232:235], v[52:55], v[204:207]
    v_mfma_f32_16x16x32_bf16 v[216:219], v[232:235], v[108:111], v[216:219]
    ds_read_b128 v[232:235], v7 offset:14336
    s_waitcnt lgkmcnt(2)
    v_mfma_f32_16x16x32_bf16 v[200:203], v[224:227], v[56:59], v[200:203]
    v_mfma_f32_16x16x32_bf16 v[212:215], v[224:227], v[112:115], v[212:215]
    ds_read_b128 v[224:227], v7 offset:14400
    s_waitcnt lgkmcnt(2)
    v_mfma_f32_16x16x32_bf16 v[204:207], v[228:231], v[56:59], v[204:207]
    v_mfma_f32_16x16x32_bf16 v[216:219], v[228:231], v[112:115], v[216:219]
    ds_read_b128 v[228:231], v7 offset:16384
    s_waitcnt lgkmcnt(2)
    v_mfma_f32_16x16x32_bf16 v[200:203], v[232:235], v[60:63], v[200:203]
    v_mfma_f32_16x16x32_bf16 v[212:215], v[232:235], v[116:119], v[212:215]
    ds_read_b128 v[232:235], v7 offset:16448
    s_waitcnt lgkmcnt(2)
    v_mfma_f32_16x16x32_bf16 v[204:207], v[224:227], v[60:63], v[204:207]
    v_mfma_f32_16x16x32_bf16 v[216:219], v[224:227], v[116:119], v[216:219]
    ds_read_b128 v[224:227], v7 offset:18432
    s_waitcnt lgkmcnt(2)
    v_mfma_f32_16x16x32_bf16 v[200:203], v[228:231], v[64:67], v[200:203]
    v_mfma_f32_16x16x32_bf16 v[212:215], v[228:231], v[120:123], v[212:215]
    ds_read_b128 v[228:231], v7 offset:18496
    s_waitcnt lgkmcnt(2)
    v_mfma_f32_16x16x32_bf16 v[204:207], v[232:235], v[64:67], v[204:207]
    v_mfma_f32_16x16x32_bf16 v[216:219], v[232:235], v[120:123], v[216:219]
    ds_read_b128 v[232:235], v7 offset:20480
    s_waitcnt lgkmcnt(2)
    v_mfma_f32_16x16x32_bf16 v[200:203], v[224:227], v[68:71], v[200:203]
    v_mfma_f32_16x16x32_bf16 v[212:215], v[224:227], v[124:127], v[212:215]
    ds_read_b128 v[224:227], v7 offset:20544
    s_waitcnt lgkmcnt(2)
    v_mfma_f32_16x16x32_bf16 v[204:207], v[228:231], v[68:71], v[204:207]
    v_mfma_f32_16x16x32_bf16 v[216:219], v[228:231], v[124:127], v[216:219]
    ds_read_b128 v[228:231], v7 offset:22528
    s_waitcnt lgkmcnt(2)
    v_mfma_f32_16x16x32_bf16 v[200:203], v[232:235], v[72:75], v[200:203]
    v_mfma_f32_16x16x32_bf16 v[212:215], v[232:235], v[128:131], v[212:215]
    ds_read_b128 v[232:235], v7 offset:22592
    s_waitcnt lgkmcnt(2)
    v_mfma_f32_16x16x32_bf16 v[204:207], v[224:227], v[72:75], v[204:207]
    v_mfma_f32_16x16x32_bf16 v[216:219], v[224:227], v[128:131], v[216:219]
    ds_read_b128 v[224:227], v7 offset:24576
    s_waitcnt lgkmcnt(2)
    v_mfma_f32_16x16x32_bf16 v[200:203], v[228:231], v[76:79], v[200:203]
    v_mfma_f32_16x16x32_bf16 v[212:215], v[228:231], v[132:135], v[212:215]
    ds_read_b128 v[228:231], v7 offset:24640
    s_waitcnt lgkmcnt(2)
    v_mfma_f32_16x16x32_bf16 v[204:207], v[232:235], v[76:79], v[204:207]
    v_mfma_f32_16x16x32_bf16 v[216:219], v[232:235], v[132:135], v[216:219]
    ds_read_b128 v[232:235], v7 offset:26624
    s_waitcnt lgkmcnt(2)
    v_mfma_f32_16x16x32_bf16 v[200:203], v[224:227], v[80:83], v[200:203]
    v_mfma_f32_16x16x32_bf16 v[212:215], v[224:227], v[136:139], v[212:215]
    ds_read_b128 v[224:227], v7 offset:26688
    s_waitcnt lgkmcnt(2)
    v_mfma_f32_16x16x32_bf16 v[204:207], v[228:231], v[80:83], v[204:207]
    v_mfma_f32_16x16x32_bf16 v[216:219], v[228:231], v[136:139], v[216:219]
    s_waitcnt lgkmcnt(1)
    v_mfma_f32_16x16x32_bf16 v[200:203], v[232:235], v[84:87], v[200:203]
    v_mfma_f32_16x16x32_bf16 v[212:215], v[232:235], v[140:143], v[212:215]
    s_waitcnt lgkmcnt(0)
    v_mfma_f32_16x16x32_bf16 v[204:207], v[224:227], v[84:87], v[204:207]
    v_mfma_f32_16x16x32_bf16 v[216:219], v[224:227], v[140:143], v[216:219]
    s_mov_b32 s36, 0
Lm_pd_103:
    buffer_load_dwordx4 v[144:147], v5, s[16:19], s28 offen offset:0 sc1
    buffer_load_dwordx4 v[148:151], v5, s[16:19], s28 offen offset:512 sc1
    buffer_load_dwordx4 v[152:155], v5, s[16:19], s28 offen offset:1024 sc1
    buffer_load_dwordx4 v[156:159], v5, s[16:19], s28 offen offset:1536 sc1
    buffer_load_dwordx4 v[160:163], v5, s[16:19], s28 offen offset:2048 sc1
    buffer_load_dwordx4 v[164:167], v5, s[16:19], s28 offen offset:2560 sc1
    buffer_load_dwordx4 v[168:171], v5, s[16:19], s28 offen offset:3072 sc1
    buffer_load_dwordx4 v[172:175], v5, s[16:19], s28 offen offset:3584 sc1
    buffer_load_dwordx4 v[176:179], v5, s[16:19], s29 offen offset:0 sc1
    buffer_load_dwordx4 v[180:183], v5, s[16:19], s29 offen offset:512 sc1
    buffer_load_dwordx4 v[184:187], v5, s[16:19], s29 offen offset:1024 sc1
    buffer_load_dwordx4 v[188:191], v5, s[16:19], s29 offen offset:1536 sc1
    buffer_load_dwordx4 v[192:195], v5, s[16:19], s29 offen offset:2048 sc1
    buffer_load_dwordx4 v[196:199], v5, s[16:19], s29 offen offset:2560 sc1
    s_waitcnt vmcnt(0)
    v_max3_u32 v12, v144, v145, v146
    v_max3_u32 v13, v147, v148, v149
    v_max3_u32 v12, v12, v150, v151
    v_max3_u32 v13, v13, v152, v153
    v_max3_u32 v12, v12, v154, v155
    v_max3_u32 v13, v13, v156, v157
    v_max3_u32 v12, v12, v158, v159
    v_max3_u32 v13, v13, v160, v161
    v_max3_u32 v12, v12, v162, v163
    v_max3_u32 v13, v13, v164, v165
    v_max3_u32 v12, v12, v166, v167
    v_max3_u32 v13, v13, v168, v169
    v_max3_u32 v12, v12, v170, v171
    v_max3_u32 v13, v13, v172, v173
    v_max3_u32 v12, v12, v174, v175
    v_max3_u32 v13, v13, v176, v177
    v_max3_u32 v12, v12, v178, v179
    v_max3_u32 v13, v13, v180, v181
    v_max3_u32 v12, v12, v182, v183
    v_max3_u32 v13, v13, v184, v185
    v_max3_u32 v12, v12, v186, v187
    v_max3_u32 v13, v13, v188, v189
    v_max3_u32 v12, v12, v190, v191
    v_max3_u32 v13, v13, v192, v193
    v_max3_u32 v12, v12, v194, v195
    v_max3_u32 v13, v13, v196, v197
    v_max3_u32 v12, v12, v198, v199
    v_max_u32 v12, v12, v13
    v_cmp_eq_u32 vcc, -1, v12
    s_cbranch_vccz Lm_pd_103_ok
    s_sleep 3
    s_add_u32 s36, s36, 1
    s_cmp_lt_u32 s36, 400000
    s_cbranch_scc1 Lm_pd_103
Lm_pd_103_ok:
    v_mfma_f32_16x16x32_bf16 v[208:211], v[144:147], v[32:35], v[208:211]
    v_mfma_f32_16x16x32_bf16 v[220:223], v[144:147], v[88:91], v[220:223]
    v_mfma_f32_16x16x32_bf16 v[208:211], v[148:151], v[36:39], v[208:211]
    v_mfma_f32_16x16x32_bf16 v[220:223], v[148:151], v[92:95], v[220:223]
    v_mfma_f32_16x16x32_bf16 v[208:211], v[152:155], v[40:43], v[208:211]
    v_mfma_f32_16x16x32_bf16 v[220:223], v[152:155], v[96:99], v[220:223]
    v_mfma_f32_16x16x32_bf16 v[208:211], v[156:159], v[44:47], v[208:211]
    v_mfma_f32_16x16x32_bf16 v[220:223], v[156:159], v[100:103], v[220:223]
    v_mfma_f32_16x16x32_bf16 v[208:211], v[160:163], v[48:51], v[208:211]
    v_mfma_f32_16x16x32_bf16 v[220:223], v[160:163], v[104:107], v[220:223]
    v_mfma_f32_16x16x32_bf16 v[208:211], v[164:167], v[52:55], v[208:211]
    v_mfma_f32_16x16x32_bf16 v[220:223], v[164:167], v[108:111], v[220:223]
    v_mfma_f32_16x16x32_bf16 v[208:211], v[168:171], v[56:59], v[208:211]
    v_mfma_f32_16x16x32_bf16 v[220:223], v[168:171], v[112:115], v[220:223]
    v_mfma_f32_16x16x32_bf16 v[208:211], v[172:175], v[60:63], v[208:211]
    v_mfma_f32_16x16x32_bf16 v[220:223], v[172:175], v[116:119], v[220:223]
    v_mfma_f32_16x16x32_bf16 v[208:211], v[176:179], v[64:67], v[208:211]
    v_mfma_f32_16x16x32_bf16 v[220:223], v[176:179], v[120:123], v[220:223]
    v_mfma_f32_16x16x32_bf16 v[208:211], v[180:183], v[68:71], v[208:211]
    v_mfma_f32_16x16x32_bf16 v[220:223], v[180:183], v[124:127], v[220:223]
    v_mfma_f32_16x16x32_bf16 v[208:211], v[184:187], v[72:75], v[208:211]
    v_mfma_f32_16x16x32_bf16 v[220:223], v[184:187], v[128:131], v[220:223]
    v_mfma_f32_16x16x32_bf16 v[208:211], v[188:191], v[76:79], v[208:211]
    v_mfma_f32_16x16x32_bf16 v[220:223], v[188:191], v[132:135], v[220:223]
    v_mfma_f32_16x16x32_bf16 v[208:211], v[192:195], v[80:83], v[208:211]
    v_mfma_f32_16x16x32_bf16 v[220:223], v[192:195], v[136:139], v[220:223]
    v_mfma_f32_16x16x32_bf16 v[208:211], v[196:199], v[84:87], v[208:211]
    v_mfma_f32_16x16x32_bf16 v[220:223], v[196:199], v[140:143], v[220:223]
    s_nop 9
    v_mov_b32 v10, 0xff800000
    s_lshl_b32 s30, s20, 1
    v_cmp_lt_i32 vcc, 0, v9
    s_nop 1
    v_cndmask_b32 v200, v200, v10, vcc
    v_cmp_lt_i32 vcc, -1, v9
    s_nop 1
    v_cndmask_b32 v201, v201, v10, vcc
    v_cmp_lt_i32 vcc, -2, v9
    s_nop 1
    v_cndmask_b32 v202, v202, v10, vcc
    v_cmp_lt_i32 vcc, -3, v9
    s_nop 1
    v_cndmask_b32 v203, v203, v10, vcc
    v_cmp_lt_i32 vcc, -4, v9
    s_nop 1
    v_cndmask_b32 v204, v204, v10, vcc
    v_cmp_lt_i32 vcc, -5, v9
    s_nop 1
    v_cndmask_b32 v205, v205, v10, vcc
    v_cmp_lt_i32 vcc, -6, v9
    s_nop 1
    v_cndmask_b32 v206, v206, v10, vcc
    v_cmp_lt_i32 vcc, -7, v9
    s_nop 1
    v_cndmask_b32 v207, v207, v10, vcc
    v_cmp_lt_u32 vcc, 1, v3
    s_nop 1
    v_cndmask_b32 v208, v208, v10, vcc
    v_cndmask_b32 v209, v209, v10, vcc
    v_cndmask_b32 v210, v210, v10, vcc
    v_cndmask_b32 v211, v211, v10, vcc
    v_max3_f32 v236, v200, v201, v202
    v_max3_f32 v236, v236, v203, v204
    v_max3_f32 v236, v236, v205, v206
    v_max3_f32 v236, v236, v207, v208
    v_max3_f32 v236, v236, v209, v210
    v_max_f32 v236, v236, v211
    v_mov_b32 v237, v236
    s_nop 1
    v_permlane16_swap_b32 v236, v237
    v_max_f32 v236, v236, v237
    v_mov_b32 v237, v236
    s_nop 1
    v_permlane32_swap_b32 v236, v237
    v_max_f32 v236, v236, v237
    v_sub_f32 v200, v200, v236
    v_sub_f32 v201, v201, v236
    v_sub_f32 v202, v202, v236
    v_sub_f32 v203, v203, v236
    v_sub_f32 v204, v204, v236
    v_sub_f32 v205, v205, v236
    v_sub_f32 v206, v206, v236
    v_sub_f32 v207, v207, v236
    v_sub_f32 v208, v208, v236
    v_sub_f32 v209, v209, v236
    v_sub_f32 v210, v210, v236
    v_sub_f32 v211, v211, v236
    v_exp_f32 v200, v200
    v_exp_f32 v201, v201
    v_exp_f32 v202, v202
    v_exp_f32 v203, v203
    v_exp_f32 v204, v204
    v_exp_f32 v205, v205
    v_exp_f32 v206, v206
    v_exp_f32 v207, v207
    v_exp_f32 v208, v208
    v_exp_f32 v209, v209
    v_exp_f32 v210, v210
    v_exp_f32 v211, v211
    s_nop 0
    v_add_f32 v236, v200, v201
    v_add_f32 v236, v236, v202
    v_add_f32 v236, v236, v203
    v_add_f32 v236, v236, v204
    v_add_f32 v236, v236, v205
    v_add_f32 v236, v236, v206
    v_add_f32 v236, v236, v207
    v_add_f32 v236, v236, v208
    v_add_f32 v236, v236, v209
    v_add_f32 v236, v236, v210
    v_add_f32 v236, v236, v211
    v_mov_b32 v237, v236
    s_nop 1
    v_permlane16_swap_b32 v236, v237
    v_add_f32 v236, v236, v237
    v_mov_b32 v237, v236
    s_nop 1
    v_permlane32_swap_b32 v236, v237
    v_add_f32 v236, v236, v237
    v_rcp_f32 v236, v236
    s_nop 0
    v_mul_f32 v200, v200, v236
    v_mul_f32 v201, v201, v236
    v_mul_f32 v202, v202, v236
    v_mul_f32 v203, v203, v236
    v_mul_f32 v204, v204, v236
    v_mul_f32 v205, v205, v236
    v_mul_f32 v206, v206, v236
    v_mul_f32 v207, v207, v236
    v_mul_f32 v208, v208, v236
    v_mul_f32 v209, v209, v236
    v_mul_f32 v210, v210, v236
    v_mul_f32 v211, v211, v236
    v_cvt_pk_bf16_f32 v240, v200, v201
    v_cvt_pk_bf16_f32 v241, v202, v203
    v_cvt_pk_bf16_f32 v242, v204, v205
    v_cvt_pk_bf16_f32 v243, v206, v207
    v_cvt_pk_bf16_f32 v244, v208, v209
    v_cvt_pk_bf16_f32 v245, v210, v211
    s_add_u32 s31, s30, 0
    s_lshl_b32 s32, s31, 4
    s_add_u32 s32, s32, s25
    s_lshl_b32 s32, s32, 10
    s_add_u32 s32, s32, 83709952
    buffer_store_dwordx4 v[240:243], v4, s[16:19], s32 offen sc1
    s_lshl_b32 s32, s31, 2
    s_add_u32 s32, s32, s21
    s_lshl_b32 s32, s32, 10
    s_add_u32 s32, s32, 85807104
    s_and_b32 s33, s22, 1
    s_lshl_b32 s33, s33, 9
    s_add_u32 s32, s32, s33
    s_lshr_b32 s33, s22, 1
    s_lshl_b32 s33, s33, 3
    s_add_u32 s32, s32, s33
    s_mov_b32 exec_hi, 0
    buffer_store_dwordx2 v[244:245], v4, s[16:19], s32 offen sc1
    s_mov_b32 exec_hi, -1
    s_nop 1
    v_cmp_lt_i32 vcc, 16, v9
    s_nop 1
    v_cndmask_b32 v212, v212, v10, vcc
    v_cmp_lt_i32 vcc, 15, v9
    s_nop 1
    v_cndmask_b32 v213, v213, v10, vcc
    v_cmp_lt_i32 vcc, 14, v9
    s_nop 1
    v_cndmask_b32 v214, v214, v10, vcc
    v_cmp_lt_i32 vcc, 13, v9
    s_nop 1
    v_cndmask_b32 v215, v215, v10, vcc
    v_cmp_lt_i32 vcc, 12, v9
    s_nop 1
    v_cndmask_b32 v216, v216, v10, vcc
    v_cmp_lt_i32 vcc, 11, v9
    s_nop 1
    v_cndmask_b32 v217, v217, v10, vcc
    v_cmp_lt_i32 vcc, 10, v9
    s_nop 1
    v_cndmask_b32 v218, v218, v10, vcc
    v_cmp_lt_i32 vcc, 9, v9
    s_nop 1
    v_cndmask_b32 v219, v219, v10, vcc
    v_cmp_lt_u32 vcc, 1, v3
    s_nop 1
    v_cndmask_b32 v220, v220, v10, vcc
    v_cndmask_b32 v221, v221, v10, vcc
    v_cndmask_b32 v222, v222, v10, vcc
    v_cndmask_b32 v223, v223, v10, vcc
    v_max3_f32 v236, v212, v213, v214
    v_max3_f32 v236, v236, v215, v216
    v_max3_f32 v236, v236, v217, v218
    v_max3_f32 v236, v236, v219, v220
    v_max3_f32 v236, v236, v221, v222
    v_max_f32 v236, v236, v223
    v_mov_b32 v237, v236
    s_nop 1
    v_permlane16_swap_b32 v236, v237
    v_max_f32 v236, v236, v237
    v_mov_b32 v237, v236
    s_nop 1
    v_permlane32_swap_b32 v236, v237
    v_max_f32 v236, v236, v237
    v_sub_f32 v212, v212, v236
    v_sub_f32 v213, v213, v236
    v_sub_f32 v214, v214, v236
    v_sub_f32 v215, v215, v236
    v_sub_f32 v216, v216, v236
    v_sub_f32 v217, v217, v236
    v_sub_f32 v218, v218, v236
    v_sub_f32 v219, v219, v236
    v_sub_f32 v220, v220, v236
    v_sub_f32 v221, v221, v236
    v_sub_f32 v222, v222, v236
    v_sub_f32 v223, v223, v236
    v_exp_f32 v212, v212
    v_exp_f32 v213, v213
    v_exp_f32 v214, v214
    v_exp_f32 v215, v215
    v_exp_f32 v216, v216
    v_exp_f32 v217, v217
    v_exp_f32 v218, v218
    v_exp_f32 v219, v219
    v_exp_f32 v220, v220
    v_exp_f32 v221, v221
    v_exp_f32 v222, v222
    v_exp_f32 v223, v223
    s_nop 0
    v_add_f32 v236, v212, v213
    v_add_f32 v236, v236, v214
    v_add_f32 v236, v236, v215
    v_add_f32 v236, v236, v216
    v_add_f32 v236, v236, v217
    v_add_f32 v236, v236, v218
    v_add_f32 v236, v236, v219
    v_add_f32 v236, v236, v220
    v_add_f32 v236, v236, v221
    v_add_f32 v236, v236, v222
    v_add_f32 v236, v236, v223
    v_mov_b32 v237, v236
    s_nop 1
    v_permlane16_swap_b32 v236, v237
    v_add_f32 v236, v236, v237
    v_mov_b32 v237, v236
    s_nop 1
    v_permlane32_swap_b32 v236, v237
    v_add_f32 v236, v236, v237
    v_rcp_f32 v236, v236
    s_nop 0
    v_mul_f32 v212, v212, v236
    v_mul_f32 v213, v213, v236
    v_mul_f32 v214, v214, v236
    v_mul_f32 v215, v215, v236
    v_mul_f32 v216, v216, v236
    v_mul_f32 v217, v217, v236
    v_mul_f32 v218, v218, v236
    v_mul_f32 v219, v219, v236
    v_mul_f32 v220, v220, v236
    v_mul_f32 v221, v221, v236
    v_mul_f32 v222, v222, v236
    v_mul_f32 v223, v223, v236
    v_cvt_pk_bf16_f32 v240, v212, v213
    v_cvt_pk_bf16_f32 v241, v214, v215
    v_cvt_pk_bf16_f32 v242, v216, v217
    v_cvt_pk_bf16_f32 v243, v218, v219
    v_cvt_pk_bf16_f32 v244, v220, v221
    v_cvt_pk_bf16_f32 v245, v222, v223
    s_add_u32 s31, s30, 1
    s_lshl_b32 s32, s31, 4
    s_add_u32 s32, s32, s25
    s_lshl_b32 s32, s32, 10
    s_add_u32 s32, s32, 83709952
    buffer_store_dwordx4 v[240:243], v4, s[16:19], s32 offen sc1
    s_lshl_b32 s32, s31, 2
    s_add_u32 s32, s32, s21
    s_lshl_b32 s32, s32, 10
    s_add_u32 s32, s32, 85807104
    s_and_b32 s33, s22, 1
    s_lshl_b32 s33, s33, 9
    s_add_u32 s32, s32, s33
    s_lshr_b32 s33, s22, 1
    s_lshl_b32 s33, s33, 3
    s_add_u32 s32, s32, s33
    s_mov_b32 exec_hi, 0
    buffer_store_dwordx2 v[244:245], v4, s[16:19], s32 offen sc1
    s_mov_b32 exec_hi, -1
    s_nop 1
    s_branch Lm_tnext
Lm_tx2:
    s_sub_u32 s21, s21, 4
    v_and_b32 v2, 15, v1
    v_lshrrev_b32 v3, 4, v1
    v_lshlrev_b32 v4, 4, v1
    s_lshl_b32 s25, s21, 2
    s_add_u32 s25, s25, s22
    s_mul_i32 s26, s20, 28
    s_add_u32 s26, s26, s25
    s_lshl_b32 s27, s26, 14
    s_add_u32 s27, s27, 47009792
    v_mul_u32_u24 v5, 896, v2
    v_lshlrev_b32 v6, 3, v3
    v_add_u32 v5, v5, v6
    s_mul_i32 s28, s20, 28672
    s_lshl_b32 s29, s25, 5
    s_add_u32 s28, s28, s29
    s_add_u32 s30, s28, 14336
    buffer_load_dwordx2 v[120:121], v5, s[12:15], s28 offen
    buffer_load_dwordx2 v[122:123], v5, s[12:15], s30 offen
    v_lshlrev_b32 v6, 4, v3
    s_lshl_b32 s29, s25, 6
    s_add_u32 s31, s29, 16518656
    buffer_load_dwordx4 v[124:127], v6, s[16:19], s31 offen
    s_add_u32 s31, s29, 16520448
    buffer_load_dwordx4 v[188:191], v6, s[16:19], s31 offen
    s_add_u32 s31, s29, 16522240
    buffer_load_dwordx4 v[192:195], v6, s[16:19], s31 offen
    s_add_u32 s31, s29, 16524032
    buffer_load_dwordx4 v[196:199], v6, s[16:19], s31 offen
    v_lshlrev_b32 v7, 3, v3
    s_lshl_b32 s31, s25, 5
    buffer_load_dwordx2 v[200:201], v7, s[48:51], s31 offen
    v_lshlrev_b32 v8, 2, v1
    v_lshlrev_b32 v9, 1, v1
    s_mov_b32 s31, 16520448
    s_mov_b32 s32, 16522240
    buffer_load_dword v204, v8, s[16:19], s31 offen offset:0
    buffer_load_dword v212, v8, s[16:19], s32 offen offset:0
    buffer_load_ushort v220, v9, s[48:51], 0 offen offset:0
    buffer_load_dword v205, v8, s[16:19], s31 offen offset:256
    buffer_load_dword v213, v8, s[16:19], s32 offen offset:256
    buffer_load_ushort v221, v9, s[48:51], 0 offen offset:128
    buffer_load_dword v206, v8, s[16:19], s31 offen offset:512
    buffer_load_dword v214, v8, s[16:19], s32 offen offset:512
    buffer_load_ushort v222, v9, s[48:51], 0 offen offset:256
    buffer_load_dword v207, v8, s[16:19], s31 offen offset:768
    buffer_load_dword v215, v8, s[16:19], s32 offen offset:768
    buffer_load_ushort v223, v9, s[48:51], 0 offen offset:384
    buffer_load_dword v208, v8, s[16:19], s31 offen offset:1024
    buffer_load_dword v216, v8, s[16:19], s32 offen offset:1024
    buffer_load_ushort v224, v9, s[48:51], 0 offen offset:512
    buffer_load_dword v209, v8, s[16:19], s31 offen offset:1280
    buffer_load_dword v217, v8, s[16:19], s32 offen offset:1280
    buffer_load_ushort v225, v9, s[48:51], 0 offen offset:640
    buffer_load_dword v210, v8, s[16:19], s31 offen offset:1536
    buffer_load_dword v218, v8, s[16:19], s32 offen offset:1536
    buffer_load_ushort v226, v9, s[48:51], 0 offen offset:768
    s_lshl_b32 s34, s20, 9
    s_add_u32 s34, s34, 100024320
    v_mov_b32 v11, v1
    v_min_u32 v11, 55, v11
    v_lshlrev_b32 v11, 3, v11
    s_mov_b32 s36, 0
Lm_wf_104:
    buffer_load_dwordx2 v[12:13], v11, s[16:19], s34 offen sc1
    s_waitcnt vmcnt(0)
    v_xor_b32 v12, s97, v12
    v_xor_b32 v13, s97, v13
    v_or_b32 v12, v12, v13
    v_cmp_ne_u32 vcc, 0, v12
    s_cbranch_vccz Lm_wf_104_ok
    s_sleep 8
    s_add_u32 s36, s36, 1
    s_cmp_lt_u32 s36, 400000
    s_cbranch_scc1 Lm_wf_104
Lm_wf_104_ok:
    buffer_load_dwordx4 v[32:35], v4, s[16:19], s27 offen offset:0 sc1
    buffer_load_dwordx4 v[36:39], v4, s[16:19], s27 offen offset:1024 sc1
    buffer_load_dwordx4 v[40:43], v4, s[16:19], s27 offen offset:2048 sc1
    buffer_load_dwordx4 v[44:47], v4, s[16:19], s27 offen offset:3072 sc1
    s_add_u32 s27, s27, 4096
    buffer_load_dwordx4 v[48:51], v4, s[16:19], s27 offen offset:0 sc1
    buffer_load_dwordx4 v[52:55], v4, s[16:19], s27 offen offset:1024 sc1
    buffer_load_dwordx4 v[56:59], v4, s[16:19], s27 offen offset:2048 sc1
    buffer_load_dwordx4 v[60:63], v4, s[16:19], s27 offen offset:3072 sc1
    s_add_u32 s27, s27, 4096
    buffer_load_dwordx4 v[64:67], v4, s[16:19], s27 offen offset:0 sc1
    buffer_load_dwordx4 v[68:71], v4, s[16:19], s27 offen offset:1024 sc1
    buffer_load_dwordx4 v[72:75], v4, s[16:19], s27 offen offset:2048 sc1
    buffer_load_dwordx4 v[76:79], v4, s[16:19], s27 offen offset:3072 sc1
    s_add_u32 s27, s27, 4096
    buffer_load_dwordx4 v[80:83], v4, s[16:19], s27 offen offset:0 sc1
    buffer_load_dwordx4 v[84:87], v4, s[16:19], s27 offen offset:1024 sc1
    buffer_load_dwordx4 v[88:91], v4, s[16:19], s27 offen offset:2048 sc1
    buffer_load_dwordx4 v[92:95], v4, s[16:19], s27 offen offset:3072 sc1
    s_add_u32 s27, s27, 4096
    v_mov_b32 v228, 0
    v_mov_b32 v229, 0
    v_lshlrev_b32 v220, 16, v220
    v_fmac_f32 v228, v204, v220
    v_add_f32 v212, 1.0, v212
    v_fmac_f32 v229, v212, v220
    v_lshlrev_b32 v221, 16, v221
    v_fmac_f32 v228, v205, v221
    v_add_f32 v213, 1.0, v213
    v_fmac_f32 v229, v213, v221
    v_lshlrev_b32 v222, 16, v222
    v_fmac_f32 v228, v206, v222
    v_add_f32 v214, 1.0, v214
    v_fmac_f32 v229, v214, v222
    v_lshlrev_b32 v223, 16, v223
    v_fmac_f32 v228, v207, v223
    v_add_f32 v215, 1.0, v215
    v_fmac_f32 v229, v215, v223
    v_lshlrev_b32 v224, 16, v224
    v_fmac_f32 v228, v208, v224
    v_add_f32 v216, 1.0, v216
    v_fmac_f32 v229, v216, v224
    v_lshlrev_b32 v225, 16, v225
    v_fmac_f32 v228, v209, v225
    v_add_f32 v217, 1.0, v217
    v_fmac_f32 v229, v217, v225
    v_lshlrev_b32 v226, 16, v226
    v_fmac_f32 v228, v210, v226
    v_add_f32 v218, 1.0, v218
    v_fmac_f32 v229, v218, v226
    s_nop 1
    v_add_f32_dpp v228, v228, v228 row_ror:4 row_mask:0xf bank_mask:0xf
    s_nop 1
    v_add_f32_dpp v228, v228, v228 row_ror:2 row_mask:0xf bank_mask:0xf
    s_nop 1
    v_add_f32_dpp v228, v228, v228 row_ror:1 row_mask:0xf bank_mask:0xf
    s_nop 1
    v_add_f32_dpp v228, v228, v228 row_ror:8 row_mask:0xf bank_mask:0xf
    v_mov_b32 v230, v228
    s_nop 1
    v_permlane16_swap_b32 v228, v230
    v_add_f32 v228, v228, v230
    v_mov_b32 v230, v228
    s_nop 1
    v_permlane32_swap_b32 v228, v230
    v_add_f32 v228, v228, v230
    s_nop 1
    v_add_f32_dpp v229, v229, v229 row_ror:4 row_mask:0xf bank_mask:0xf
    s_nop 1
    v_add_f32_dpp v229, v229, v229 row_ror:2 row_mask:0xf bank_mask:0xf
    s_nop 1
    v_add_f32_dpp v229, v229, v229 row_ror:1 row_mask:0xf bank_mask:0xf
    s_nop 1
    v_add_f32_dpp v229, v229, v229 row_ror:8 row_mask:0xf bank_mask:0xf
    v_mov_b32 v230, v229
    s_nop 1
    v_permlane16_swap_b32 v229, v230
    v_add_f32 v229, v229, v230
    v_mov_b32 v230, v229
    s_nop 1
    v_permlane32_swap_b32 v229, v230
    v_add_f32 v229, v229, v230
    v_add_f32 v192, 1.0, v192
    v_add_f32 v193, 1.0, v193
    v_add_f32 v194, 1.0, v194
    v_add_f32 v195, 1.0, v195
    v_lshlrev_b32 v232, 16, v200
    v_and_b32 v233, 0xffff0000, v200
    v_lshlrev_b32 v234, 16, v201
    v_and_b32 v235, 0xffff0000, v201
    v_mul_f32 v236, v192, v232
    v_mul_f32 v237, v193, v233
    v_mul_f32 v238, v194, v234
    v_mul_f32 v239, v195, v235
    v_mov_b32 v112, 0
    v_mov_b32 v113, 0
    v_mov_b32 v114, 0
    v_mov_b32 v115, 0
    v_mov_b32 v116, 0
    v_mov_b32 v117, 0
    v_mov_b32 v118, 0
    v_mov_b32 v119, 0
    s_lshl_b32 s34, s20, 11
    s_add_u32 s34, s34, 100057088
    v_mov_b32 v11, v1
    v_min_u32 v11, 13, v11
    v_lshlrev_b32 v11, 7, v11
    s_mov_b32 s36, 0
Lm_wf_105:
    buffer_load_dword v12, v11, s[16:19], s34 offen sc1
    s_waitcnt vmcnt(0)
    v_xor_b32 v12, s97, v12
    v_cmp_ne_u32 vcc, 0, v12
    s_cbranch_vccz Lm_wf_105_ok
    s_sleep 8
    s_add_u32 s36, s36, 1
    s_cmp_lt_u32 s36, 400000
    s_cbranch_scc1 Lm_wf_105
Lm_wf_105_ok:
    s_lshl_b32 s27, s26, 12
    s_add_u32 s27, s27, 76369920
    buffer_load_dwordx4 v[96:99], v4, s[16:19], s27 offen offset:0 sc1
    buffer_load_dwordx4 v[100:103], v4, s[16:19], s27 offen offset:1024 sc1
    buffer_load_dwordx4 v[104:107], v4, s[16:19], s27 offen offset:2048 sc1
    buffer_load_dwordx4 v[108:111], v4, s[16:19], s27 offen offset:3072 sc1
    v_lshlrev_b32 v10, 4, v0
    s_lshl_b32 s31, s20, 15
    s_add_u32 s31, s31, 83709952
    s_add_u32 s32, s31, 16384
    s_lshl_b32 s33, s20, 13
    s_add_u32 s33, s33, 85807104
    v_add_u32 v13, 4096, v10
    v_add_u32 v14, 8192, v10
    v_add_u32 v15, 12288, v10
    s_mov_b32 s36, 0
Lm_pd_106:
    buffer_load_dwordx4 v[148:151], v10, s[16:19], s31 offen sc1
    buffer_load_dwordx4 v[152:155], v13, s[16:19], s31 offen sc1
    buffer_load_dwordx4 v[156:159], v14, s[16:19], s31 offen sc1
    buffer_load_dwordx4 v[160:163], v15, s[16:19], s31 offen sc1
    buffer_load_dwordx4 v[164:167], v10, s[16:19], s32 offen sc1
    buffer_load_dwordx4 v[168:171], v13, s[16:19], s32 offen sc1
    buffer_load_dwordx4 v[172:175], v14, s[16:19], s32 offen sc1
    buffer_load_dwordx4 v[176:179], v15, s[16:19], s32 offen sc1
    buffer_load_dwordx4 v[180:183], v10, s[16:19], s33 offen sc1
    buffer_load_dwordx4 v[184:187], v13, s[16:19], s33 offen sc1
    s_waitcnt vmcnt(0)
    v_max3_u32 v16, v148, v149, v150
    v_max3_u32 v17, v151, v152, v153
    v_max3_u32 v16, v16, v154, v155
    v_max3_u32 v17, v17, v156, v157
    v_max3_u32 v16, v16, v158, v159
    v_max3_u32 v17, v17, v160, v161
    v_max3_u32 v16, v16, v162, v163
    v_max3_u32 v17, v17, v164, v165
    v_max3_u32 v16, v16, v166, v167
    v_max3_u32 v17, v17, v168, v169
    v_max3_u32 v16, v16, v170, v171
    v_max3_u32 v17, v17, v172, v173
    v_max3_u32 v16, v16, v174, v175
    v_max3_u32 v17, v17, v176, v177
    v_max3_u32 v16, v16, v178, v179
    v_max3_u32 v17, v17, v180, v181
    v_max3_u32 v16, v16, v182, v183
    v_max3_u32 v17, v17, v184, v185
    v_max3_u32 v16, v16, v186, v187
    v_max_u32 v16, v16, v17
    v_cmp_eq_u32 vcc, -1, v16
    s_cbranch_vccz Lm_pd_106_ok
    s_sleep 2
    s_add_u32 s36, s36, 1
    s_cmp_lt_u32 s36, 400000
    s_cbranch_scc1 Lm_pd_106
Lm_pd_106_ok:
    ds_write_b128 v10, v[148:151] offset:0
    ds_write_b128 v10, v[152:155] offset:4096
    ds_write_b128 v10, v[156:159] offset:8192
    ds_write_b128 v10, v[160:163] offset:12288
    ds_write_b128 v10, v[164:167] offset:16384
    ds_write_b128 v10, v[168:171] offset:20480
    ds_write_b128 v10, v[172:175] offset:24576
    ds_write_b128 v10, v[176:179] offset:28672
    ds_write_b128 v10, v[180:183] offset:32768
    ds_write_b128 v10, v[184:187] offset:36864
    s_waitcnt lgkmcnt(0)
    s_barrier
    ds_read_b128 v[128:131], v4 offset:0
    ds_read_b128 v[132:135], v4 offset:16384
    ds_read_b128 v[136:139], v4 offset:1024
    ds_read_b128 v[140:143], v4 offset:17408
    s_waitcnt lgkmcnt(3)
    v_mfma_f32_16x16x32_bf16 v[112:115], v[32:35], v[128:131], v[112:115]
    ds_read_b128 v[128:131], v4 offset:2048
    s_waitcnt lgkmcnt(3)
    v_mfma_f32_16x16x32_bf16 v[116:119], v[32:35], v[132:135], v[116:119]
    ds_read_b128 v[132:135], v4 offset:18432
    s_waitcnt lgkmcnt(3)
    v_mfma_f32_16x16x32_bf16 v[112:115], v[36:39], v[136:139], v[112:115]
    ds_read_b128 v[136:139], v4 offset:3072
    s_waitcnt lgkmcnt(3)
    v_mfma_f32_16x16x32_bf16 v[116:119], v[36:39], v[140:143], v[116:119]
    ds_read_b128 v[140:143], v4 offset:19456
    s_waitcnt lgkmcnt(3)
    v_mfma_f32_16x16x32_bf16 v[112:115], v[40:43], v[128:131], v[112:115]
    ds_read_b128 v[128:131], v4 offset:4096
    s_waitcnt lgkmcnt(3)
    v_mfma_f32_16x16x32_bf16 v[116:119], v[40:43], v[132:135], v[116:119]
    ds_read_b128 v[132:135], v4 offset:20480
    s_waitcnt lgkmcnt(3)
    v_mfma_f32_16x16x32_bf16 v[112:115], v[44:47], v[136:139], v[112:115]
    ds_read_b128 v[136:139], v4 offset:5120
    s_waitcnt lgkmcnt(3)
    v_mfma_f32_16x16x32_bf16 v[116:119], v[44:47], v[140:143], v[116:119]
    ds_read_b128 v[140:143], v4 offset:21504
    s_waitcnt lgkmcnt(3)
    v_mfma_f32_16x16x32_bf16 v[112:115], v[48:51], v[128:131], v[112:115]
    ds_read_b128 v[128:131], v4 offset:6144
    s_waitcnt lgkmcnt(3)
    v_mfma_f32_16x16x32_bf16 v[116:119], v[48:51], v[132:135], v[116:119]
    ds_read_b128 v[132:135], v4 offset:22528
    s_waitcnt lgkmcnt(3)
    v_mfma_f32_16x16x32_bf16 v[112:115], v[52:55], v[136:139], v[112:115]
    ds_read_b128 v[136:139], v4 offset:7168
    s_waitcnt lgkmcnt(3)
    v_mfma_f32_16x16x32_bf16 v[116:119], v[52:55], v[140:143], v[116:119]
    ds_read_b128 v[140:143], v4 offset:23552
    s_waitcnt lgkmcnt(3)
    v_mfma_f32_16x16x32_bf16 v[112:115], v[56:59], v[128:131], v[112:115]
    ds_read_b128 v[128:131], v4 offset:8192
    s_waitcnt lgkmcnt(3)
    v_mfma_f32_16x16x32_bf16 v[116:119], v[56:59], v[132:135], v[116:119]
    ds_read_b128 v[132:135], v4 offset:24576
    s_waitcnt lgkmcnt(3)
    v_mfma_f32_16x16x32_bf16 v[112:115], v[60:63], v[136:139], v[112:115]
    ds_read_b128 v[136:139], v4 offset:9216
    s_waitcnt lgkmcnt(3)
    v_mfma_f32_16x16x32_bf16 v[116:119], v[60:63], v[140:143], v[116:119]
    ds_read_b128 v[140:143], v4 offset:25600
    s_waitcnt lgkmcnt(3)
    v_mfma_f32_16x16x32_bf16 v[112:115], v[64:67], v[128:131], v[112:115]
    ds_read_b128 v[128:131], v4 offset:10240
    s_waitcnt lgkmcnt(3)
    v_mfma_f32_16x16x32_bf16 v[116:119], v[64:67], v[132:135], v[116:119]
    ds_read_b128 v[132:135], v4 offset:26624
    s_waitcnt lgkmcnt(3)
    v_mfma_f32_16x16x32_bf16 v[112:115], v[68:71], v[136:139], v[112:115]
    ds_read_b128 v[136:139], v4 offset:11264
    s_waitcnt lgkmcnt(3)
    v_mfma_f32_16x16x32_bf16 v[116:119], v[68:71], v[140:143], v[116:119]
    ds_read_b128 v[140:143], v4 offset:27648
    s_waitcnt lgkmcnt(3)
    v_mfma_f32_16x16x32_bf16 v[112:115], v[72:75], v[128:131], v[112:115]
    ds_read_b128 v[128:131], v4 offset:12288
    s_waitcnt lgkmcnt(3)
    v_mfma_f32_16x16x32_bf16 v[116:119], v[72:75], v[132:135], v[116:119]
    ds_read_b128 v[132:135], v4 offset:28672
    s_waitcnt lgkmcnt(3)
    v_mfma_f32_16x16x32_bf16 v[112:115], v[76:79], v[136:139], v[112:115]
    ds_read_b128 v[136:139], v4 offset:13312
    s_waitcnt lgkmcnt(3)
    v_mfma_f32_16x16x32_bf16 v[116:119], v[76:79], v[140:143], v[116:119]
    ds_read_b128 v[140:143], v4 offset:29696
    s_waitcnt lgkmcnt(3)
    v_mfma_f32_16x16x32_bf16 v[112:115], v[80:83], v[128:131], v[112:115]
    ds_read_b128 v[128:131], v4 offset:14336
    s_waitcnt lgkmcnt(3)
    v_mfma_f32_16x16x32_bf16 v[116:119], v[80:83], v[132:135], v[116:119]
    ds_read_b128 v[132:135], v4 offset:30720
    s_waitcnt lgkmcnt(3)
    v_mfma_f32_16x16x32_bf16 v[112:115], v[84:87], v[136:139], v[112:115]
    ds_read_b128 v[136:139], v4 offset:15360
    s_waitcnt lgkmcnt(3)
    v_mfma_f32_16x16x32_bf16 v[116:119], v[84:87], v[140:143], v[116:119]
    ds_read_b128 v[140:143], v4 offset:31744
    s_waitcnt lgkmcnt(3)
    v_mfma_f32_16x16x32_bf16 v[112:115], v[88:91], v[128:131], v[112:115]
    ds_read_b128 v[128:131], v4 offset:32768
    s_waitcnt lgkmcnt(3)
    v_mfma_f32_16x16x32_bf16 v[116:119], v[88:91], v[132:135], v[116:119]
    ds_read_b128 v[132:135], v4 offset:36864
    s_waitcnt lgkmcnt(3)
    v_mfma_f32_16x16x32_bf16 v[112:115], v[92:95], v[136:139], v[112:115]
    ds_read_b128 v[136:139], v4 offset:33792
    s_waitcnt lgkmcnt(3)
    v_mfma_f32_16x16x32_bf16 v[116:119], v[92:95], v[140:143], v[116:119]
    ds_read_b128 v[140:143], v4 offset:37888
    s_waitcnt lgkmcnt(3)
    v_mfma_f32_16x16x32_bf16 v[112:115], v[96:99], v[128:131], v[112:115]
    ds_read_b128 v[128:131], v4 offset:34816
    s_waitcnt lgkmcnt(3)
    v_mfma_f32_16x16x32_bf16 v[116:119], v[96:99], v[132:135], v[116:119]
    ds_read_b128 v[132:135], v4 offset:38912
    s_waitcnt lgkmcnt(3)
    v_mfma_f32_16x16x32_bf16 v[112:115], v[100:103], v[136:139], v[112:115]
    ds_read_b128 v[136:139], v4 offset:35840
    s_waitcnt lgkmcnt(3)
    v_mfma_f32_16x16x32_bf16 v[116:119], v[100:103], v[140:143], v[116:119]
    ds_read_b128 v[140:143], v4 offset:39936
    s_waitcnt lgkmcnt(3)
    v_mfma_f32_16x16x32_bf16 v[112:115], v[104:107], v[128:131], v[112:115]
    s_waitcnt lgkmcnt(2)
    v_mfma_f32_16x16x32_bf16 v[116:119], v[104:107], v[132:135], v[116:119]
    s_waitcnt lgkmcnt(1)
    v_mfma_f32_16x16x32_bf16 v[112:115], v[108:111], v[136:139], v[112:115]
    s_waitcnt lgkmcnt(0)
    v_mfma_f32_16x16x32_bf16 v[116:119], v[108:111], v[140:143], v[116:119]
    s_nop 9
    v_lshlrev_b32 v144, 16, v120
    v_and_b32 v145, 0xffff0000, v120
    v_lshlrev_b32 v146, 16, v121
    v_and_b32 v147, 0xffff0000, v121
    v_fmac_f32 v144, v124, v112
    v_fmac_f32 v145, v125, v113
    v_fmac_f32 v146, v126, v114
    v_fmac_f32 v147, v127, v115
    v_add_f32 v152, v144, v145
    v_add_f32 v152, v152, v146
    v_add_f32 v152, v152, v147
    v_mul_f32 v153, v144, v144
    v_fmac_f32 v153, v145, v145
    v_fmac_f32 v153, v146, v146
    v_fmac_f32 v153, v147, v147
    v_mul_f32 v154, v144, v236
    v_fmac_f32 v154, v145, v237
    v_fmac_f32 v154, v146, v238
    v_fmac_f32 v154, v147, v239
    v_lshlrev_b32 v148, 16, v122
    v_and_b32 v149, 0xffff0000, v122
    v_lshlrev_b32 v150, 16, v123
    v_and_b32 v151, 0xffff0000, v123
    v_fmac_f32 v148, v124, v116
    v_fmac_f32 v149, v125, v117
    v_fmac_f32 v150, v126, v118
    v_fmac_f32 v151, v127, v119
    v_add_f32 v155, v148, v149
    v_add_f32 v155, v155, v150
    v_add_f32 v155, v155, v151
    v_mul_f32 v156, v148, v148
    v_fmac_f32 v156, v149, v149
    v_fmac_f32 v156, v150, v150
    v_fmac_f32 v156, v151, v151
    v_mul_f32 v157, v148, v236
    v_fmac_f32 v157, v149, v237
    v_fmac_f32 v157, v150, v238
    v_fmac_f32 v157, v151, v239
    v_mov_b32 v158, v152
    s_nop 1
    v_permlane16_swap_b32 v152, v158
    v_add_f32 v152, v152, v158
    v_mov_b32 v158, v152
    s_nop 1
    v_permlane32_swap_b32 v152, v158
    v_add_f32 v152, v152, v158
    v_mov_b32 v158, v153
    s_nop 1
    v_permlane16_swap_b32 v153, v158
    v_add_f32 v153, v153, v158
    v_mov_b32 v158, v153
    s_nop 1
    v_permlane32_swap_b32 v153, v158
    v_add_f32 v153, v153, v158
    v_mov_b32 v158, v154
    s_nop 1
    v_permlane16_swap_b32 v154, v158
    v_add_f32 v154, v154, v158
    v_mov_b32 v158, v154
    s_nop 1
    v_permlane32_swap_b32 v154, v158
    v_add_f32 v154, v154, v158
    v_mov_b32 v158, v155
    s_nop 1
    v_permlane16_swap_b32 v155, v158
    v_add_f32 v155, v155, v158
    v_mov_b32 v158, v155
    s_nop 1
    v_permlane32_swap_b32 v155, v158
    v_add_f32 v155, v155, v158
    v_mov_b32 v158, v156
    s_nop 1
    v_permlane16_swap_b32 v156, v158
    v_add_f32 v156, v156, v158
    v_mov_b32 v158, v156
    s_nop 1
    v_permlane32_swap_b32 v156, v158
    v_add_f32 v156, v156, v158
    v_mov_b32 v158, v157
    s_nop 1
    v_permlane16_swap_b32 v157, v158
    v_add_f32 v157, v157, v158
    v_mov_b32 v158, v157
    s_nop 1
    v_permlane32_swap_b32 v157, v158
    v_add_f32 v157, v157, v158
    v_lshlrev_b32 v16, 4, v2
    s_lshl_b32 s35, s22, 9
    s_add_u32 s35, s35, 41984
    v_add_u32 v16, s35, v16
    v_mov_b32 v159, 0
    s_mov_b64 exec, 0xffff
    v_mov_b32 v160, v152
    v_mov_b32 v161, v153
    v_mov_b32 v162, v154
    v_mov_b32 v163, 0
    ds_write_b128 v16, v[160:163] offset:0
    v_mov_b32 v160, v155
    v_mov_b32 v161, v156
    v_mov_b32 v162, v157
    v_mov_b32 v163, 0
    ds_write_b128 v16, v[160:163] offset:256
    s_mov_b64 exec, -1
    s_waitcnt lgkmcnt(0)
    s_barrier
    s_cmp_eq_u32 s22, 0
    s_cbranch_scc0 Lm_st_107
    s_mov_b32 exec_hi, 0
    v_lshlrev_b32 v17, 4, v1
    v_add_u32 v18, 41984, v17
    ds_read_b128 v[164:167], v18 offset:0
    ds_read_b128 v[168:171], v18 offset:512
    ds_read_b128 v[172:175], v18 offset:1024
    ds_read_b128 v[176:179], v18 offset:1536
    s_waitcnt lgkmcnt(0)
    v_add_f32 v164, v164, v168
    v_add_f32 v172, v172, v176
    v_add_f32 v164, v164, v172
    v_add_f32 v165, v165, v169
    v_add_f32 v173, v173, v177
    v_add_f32 v165, v165, v173
    v_add_f32 v166, v166, v170
    v_add_f32 v174, v174, v178
    v_add_f32 v166, v166, v174
    s_mul_i32 s35, s20, 7
    s_add_u32 s35, s35, s21
    s_lshl_b32 s35, s35, 9
    s_add_u32 s35, s35, 99794944
    buffer_store_dwordx4 v[164:167], v17, s[16:19], s35 offen sc1
    s_mov_b32 exec_hi, -1
Lm_st_107:
    v_lshlrev_b32 v19, 4, v2
    v_lshlrev_b32 v21, 9, v3
    v_add_u32 v19, v19, v21
    v_add_u32 v22, 2048, v19
    v_cmp_eq_u32 vcc, 3, v3
    s_nop 1
    v_cndmask_b32 v22, v22, v19, vcc
    s_mul_i32 s35, s20, 3584
    s_add_u32 s35, s35, 99794944
    s_mov_b32 s36, 0
Lm_pd_108:
    buffer_load_dwordx4 v[32:35], v19, s[16:19], s35 offen sc1
    buffer_load_dwordx4 v[36:39], v19, s[16:19], s35 offen offset:256 sc1
    buffer_load_dwordx4 v[40:43], v22, s[16:19], s35 offen sc1
    buffer_load_dwordx4 v[44:47], v22, s[16:19], s35 offen offset:256 sc1
    s_waitcnt vmcnt(0)
    v_max3_u32 v16, v32, v33, v34
    v_max3_u32 v17, v36, v37, v38
    v_max3_u32 v16, v16, v40, v41
    v_max3_u32 v17, v17, v42, v44
    v_max3_u32 v16, v16, v45, v46
    v_max_u32 v16, v16, v17
    v_cmp_eq_u32 vcc, -1, v16
    s_cbranch_vccz Lm_pd_108_ok
    s_sleep 1
    s_add_u32 s36, s36, 1
    s_cmp_lt_u32 s36, 400000
    s_cbranch_scc1 Lm_pd_108
Lm_pd_108_ok:
    v_cmp_eq_u32 vcc, 3, v3
    s_nop 1
    v_cndmask_b32 v40, v40, 0, vcc
    v_add_f32 v32, v32, v40
    v_cndmask_b32 v41, v41, 0, vcc
    v_add_f32 v33, v33, v41
    v_cndmask_b32 v42, v42, 0, vcc
    v_add_f32 v34, v34, v42
    v_cndmask_b32 v44, v44, 0, vcc
    v_add_f32 v36, v36, v44
    v_cndmask_b32 v45, v45, 0, vcc
    v_add_f32 v37, v37, v45
    v_cndmask_b32 v46, v46, 0, vcc
    v_add_f32 v38, v38, v46
    v_mov_b32 v23, v32
    s_nop 1
    v_permlane16_swap_b32 v32, v23
    v_add_f32 v32, v32, v23
    v_mov_b32 v23, v32
    s_nop 1
    v_permlane32_swap_b32 v32, v23
    v_add_f32 v32, v32, v23
    v_mov_b32 v23, v33
    s_nop 1
    v_permlane16_swap_b32 v33, v23
    v_add_f32 v33, v33, v23
    v_mov_b32 v23, v33
    s_nop 1
    v_permlane32_swap_b32 v33, v23
    v_add_f32 v33, v33, v23
    v_mov_b32 v23, v34
    s_nop 1
    v_permlane16_swap_b32 v34, v23
    v_add_f32 v34, v34, v23
    v_mov_b32 v23, v34
    s_nop 1
    v_permlane32_swap_b32 v34, v23
    v_add_f32 v34, v34, v23
    v_mov_b32 v23, v36
    s_nop 1
    v_permlane16_swap_b32 v36, v23
    v_add_f32 v36, v36, v23
    v_mov_b32 v23, v36
    s_nop 1
    v_permlane32_swap_b32 v36, v23
    v_add_f32 v36, v36, v23
    v_mov_b32 v23, v37
    s_nop 1
    v_permlane16_swap_b32 v37, v23
    v_add_f32 v37, v37, v23
    v_mov_b32 v23, v37
    s_nop 1
    v_permlane32_swap_b32 v37, v23
    v_add_f32 v37, v37, v23
    v_mov_b32 v23, v38
    s_nop 1
    v_permlane16_swap_b32 v38, v23
    v_add_f32 v38, v38, v23
    v_mov_b32 v23, v38
    s_nop 1
    v_permlane32_swap_b32 v38, v23
    v_add_f32 v38, v38, v23
    v_mul_f32 v96, 0x3b124925, v32
    v_mul_f32 v97, v96, v96
    v_mov_b32 v104, 0x3727c5ac
    v_sub_f32 v104, v104, v97
    v_fmac_f32 v104, 0x3b124925, v33
    v_rsq_f32 v97, v104
    s_nop 0
    v_fma_f32 v105, -v96, v229, v34
    v_fma_f32 v98, v105, v97, v228
    v_mul_f32 v100, 0x3b124925, v36
    v_mul_f32 v101, v100, v100
    v_mov_b32 v104, 0x3727c5ac
    v_sub_f32 v104, v104, v101
    v_fmac_f32 v104, 0x3b124925, v37
    v_rsq_f32 v101, v104
    s_nop 0
    v_fma_f32 v105, -v100, v229, v38
    v_fma_f32 v102, v105, v101, v228
    s_add_u32 s35, s21, s22
    s_cmp_eq_u32 s35, 0
    s_cbranch_scc0 Lm_r_109
    v_lshlrev_b32 v20, 2, v2
    s_lshl_b32 s35, s20, 7
    s_add_u32 s35, s35, 91836416
    s_mov_b64 exec, 0xffff
    buffer_store_dword v98, v20, s[16:19], s35 offen sc1
    buffer_store_dword v102, v20, s[16:19], s35 offen offset:64 sc1
    s_mov_b64 exec, -1
Lm_r_109:
    v_sub_f32 v108, v144, v96
    v_mul_f32 v108, v108, v97
    v_fma_f32 v108, v108, v192, v188
    v_sub_f32 v109, v145, v96
    v_mul_f32 v109, v109, v97
    v_fma_f32 v109, v109, v193, v189
    v_sub_f32 v110, v146, v96
    v_mul_f32 v110, v110, v97
    v_fma_f32 v110, v110, v194, v190
    v_sub_f32 v111, v147, v96
    v_mul_f32 v111, v111, v97
    v_fma_f32 v111, v111, v195, v191
    v_cvt_pk_bf16_f32 v240, v108, v109
    v_cvt_pk_bf16_f32 v241, v110, v111
    v_lshlrev_b32 v108, 16, v240
    v_and_b32 v109, 0xffff0000, v240
    v_lshlrev_b32 v110, 16, v241
    v_and_b32 v111, 0xffff0000, v241
    v_fmac_f32 v144, v196, v108
    v_fmac_f32 v145, v197, v109
    v_fmac_f32 v146, v198, v110
    v_fmac_f32 v147, v199, v111
    v_cvt_pk_bf16_f32 v244, v144, v145
    v_cvt_pk_bf16_f32 v245, v146, v147
    v_sub_f32 v108, v148, v100
    v_mul_f32 v108, v108, v101
    v_fma_f32 v108, v108, v192, v188
    v_sub_f32 v109, v149, v100
    v_mul_f32 v109, v109, v101
    v_fma_f32 v109, v109, v193, v189
    v_sub_f32 v110, v150, v100
    v_mul_f32 v110, v110, v101
    v_fma_f32 v110, v110, v194, v190
    v_sub_f32 v111, v151, v100
    v_mul_f32 v111, v111, v101
    v_fma_f32 v111, v111, v195, v191
    v_cvt_pk_bf16_f32 v242, v108, v109
    v_cvt_pk_bf16_f32 v243, v110, v111
    v_lshlrev_b32 v108, 16, v242
    v_and_b32 v109, 0xffff0000, v242
    v_lshlrev_b32 v110, 16, v243
    v_and_b32 v111, 0xffff0000, v243
    v_fmac_f32 v148, v196, v108
    v_fmac_f32 v149, v197, v109
    v_fmac_f32 v150, v198, v110
    v_fmac_f32 v151, v199, v111
    v_cvt_pk_bf16_f32 v246, v148, v149
    v_cvt_pk_bf16_f32 v247, v150, v151
    buffer_store_dwordx2 v[244:245], v5, s[44:47], s28 offen sc1
    buffer_store_dwordx2 v[246:247], v5, s[44:47], s30 offen sc1
    s_waitcnt vmcnt(0)
    s_add_u32 s28, s28, 90001408
    s_add_u32 s30, s30, 90001408
    buffer_store_dwordx2 v[240:241], v5, s[16:19], s28 offen sc1
    buffer_store_dwordx2 v[242:243], v5, s[16:19], s30 offen sc1
Lm_tnext:
    s_waitcnt vmcnt(0)
    s_add_u32 s40, s40, 224
    s_branch Lm_task
Lm_wdone:
    s_barrier
    s_cmp_ge_u32 s41, 32
    s_cbranch_scc0 Lm_tdone
    s_cmp_lt_u32 s41, 200
    s_cbranch_scc0 Lm_tdone
    s_load_dwordx2 s[60:61], s[0:1], 72
    s_load_dwordx2 s[62:63], s[0:1], 80
    s_load_dwordx2 s[64:65], s[0:1], 88
    s_waitcnt lgkmcnt(0)
    s_mov_b32 s8, s60
    s_and_b32 s9, s61, 0xffff
    s_mov_b32 s10, 1605632
    s_mov_b32 s11, 0x20000
    s_mov_b32 s12, s62
    s_and_b32 s13, s63, 0xffff
    s_mov_b32 s14, 1605632
    s_mov_b32 s15, 0x20000
    s_mov_b32 s48, s64
    s_and_b32 s49, s65, 0xffff
    s_mov_b32 s50, 1605632
    s_mov_b32 s51, 0x20000
    s_cmp_lt_u32 s41, 144
    s_cbranch_scc0 Lm_tdown
    s_sub_u32 s43, s41, 32
    v_and_b32 v30, 7, v0
    v_lshrrev_b32 v31, 3, v0
    v_mul_u32_u24 v32, 14, v31
    s_movk_i32 s24, 3584
    v_mul_lo_u32 v33, v32, s24
    v_lshlrev_b32 v34, 2, v30
    v_add_u32 v33, v33, v34
    s_lshl_b32 s25, s43, 5
    buffer_load_dword v64, v33, s[8:11], s25 offen
    buffer_load_dword v80, v33, s[12:15], s25 offen
    s_add_u32 s25, s25, 3584
    buffer_load_dword v65, v33, s[8:11], s25 offen
    buffer_load_dword v81, v33, s[12:15], s25 offen
    s_add_u32 s25, s25, 3584
    buffer_load_dword v66, v33, s[8:11], s25 offen
    buffer_load_dword v82, v33, s[12:15], s25 offen
    s_add_u32 s25, s25, 3584
    buffer_load_dword v67, v33, s[8:11], s25 offen
    buffer_load_dword v83, v33, s[12:15], s25 offen
    s_add_u32 s25, s25, 3584
    buffer_load_dword v68, v33, s[8:11], s25 offen
    buffer_load_dword v84, v33, s[12:15], s25 offen
    s_add_u32 s25, s25, 3584
    buffer_load_dword v69, v33, s[8:11], s25 offen
    buffer_load_dword v85, v33, s[12:15], s25 offen
    s_add_u32 s25, s25, 3584
    buffer_load_dword v70, v33, s[8:11], s25 offen
    buffer_load_dword v86, v33, s[12:15], s25 offen
    s_add_u32 s25, s25, 3584
    buffer_load_dword v71, v33, s[8:11], s25 offen
    buffer_load_dword v87, v33, s[12:15], s25 offen
    s_add_u32 s25, s25, 3584
    buffer_load_dword v72, v33, s[8:11], s25 offen
    buffer_load_dword v88, v33, s[12:15], s25 offen
    s_add_u32 s25, s25, 3584
    buffer_load_dword v73, v33, s[8:11], s25 offen
    buffer_load_dword v89, v33, s[12:15], s25 offen
    s_add_u32 s25, s25, 3584
    buffer_load_dword v74, v33, s[8:11], s25 offen
    buffer_load_dword v90, v33, s[12:15], s25 offen
    s_add_u32 s25, s25, 3584
    buffer_load_dword v75, v33, s[8:11], s25 offen
    buffer_load_dword v91, v33, s[12:15], s25 offen
    s_add_u32 s25, s25, 3584
    buffer_load_dword v76, v33, s[8:11], s25 offen
    buffer_load_dword v92, v33, s[12:15], s25 offen
    s_add_u32 s25, s25, 3584
    buffer_load_dword v77, v33, s[8:11], s25 offen
    buffer_load_dword v93, v33, s[12:15], s25 offen
    s_add_u32 s25, s25, 3584
    v_lshlrev_b32 v2, 5, v0
    s_mov_b32 s23, 91836416
    v_min_u32 v2, 7648, v2
    s_mov_b32 s36, 0
Lm_pd_110:
    buffer_load_dwordx4 v[8:11], v2, s[16:19], s23 offen sc1
    buffer_load_dwordx4 v[12:15], v2, s[16:19], s23 offen offset:16 sc1
    s_waitcnt vmcnt(0)
    v_max3_u32 v4, v8, v9, v10
    v_max3_u32 v5, v11, v12, v13
    v_max3_u32 v4, v4, v14, v15
    v_max_u32 v4, v4, v5
    v_cmp_eq_u32 vcc, -1, v4
    s_cbranch_vccz Lm_pd_110_ok
    s_sleep 4
    s_add_u32 s36, s36, 1
    s_cmp_lt_u32 s36, 400000
    s_cbranch_scc1 Lm_pd_110
Lm_pd_110_ok:
    v_lshlrev_b32 v3, 3, v0
    v_sub_u32 v3, 2047, v3
    v_ashrrev_i32 v4, 31, v8
    v_or_b32 v4, 0x80000000, v4
    v_xor_b32 v8, v8, v4
    v_and_b32 v8, 0xfffff800, v8
    v_subrev_u32 v4, 0, v3
    v_or_b32 v8, v8, v4
    v_ashrrev_i32 v4, 31, v9
    v_or_b32 v4, 0x80000000, v4
    v_xor_b32 v9, v9, v4
    v_and_b32 v9, 0xfffff800, v9
    v_subrev_u32 v4, 1, v3
    v_or_b32 v9, v9, v4
    v_ashrrev_i32 v4, 31, v10
    v_or_b32 v4, 0x80000000, v4
    v_xor_b32 v10, v10, v4
    v_and_b32 v10, 0xfffff800, v10
    v_subrev_u32 v4, 2, v3
    v_or_b32 v10, v10, v4
    v_ashrrev_i32 v4, 31, v11
    v_or_b32 v4, 0x80000000, v4
    v_xor_b32 v11, v11, v4
    v_and_b32 v11, 0xfffff800, v11
    v_subrev_u32 v4, 3, v3
    v_or_b32 v11, v11, v4
    v_ashrrev_i32 v4, 31, v12
    v_or_b32 v4, 0x80000000, v4
    v_xor_b32 v12, v12, v4
    v_and_b32 v12, 0xfffff800, v12
    v_subrev_u32 v4, 4, v3
    v_or_b32 v12, v12, v4
    v_ashrrev_i32 v4, 31, v13
    v_or_b32 v4, 0x80000000, v4
    v_xor_b32 v13, v13, v4
    v_and_b32 v13, 0xfffff800, v13
    v_subrev_u32 v4, 5, v3
    v_or_b32 v13, v13, v4
    v_ashrrev_i32 v4, 31, v14
    v_or_b32 v4, 0x80000000, v4
    v_xor_b32 v14, v14, v4
    v_and_b32 v14, 0xfffff800, v14
    v_subrev_u32 v4, 6, v3
    v_or_b32 v14, v14, v4
    v_ashrrev_i32 v4, 31, v15
    v_or_b32 v4, 0x80000000, v4
    v_xor_b32 v15, v15, v4
    v_and_b32 v15, 0xfffff800, v15
    v_subrev_u32 v4, 7, v3
    v_or_b32 v15, v15, v4
    v_cmp_gt_u32 vcc, 240, v0
    s_nop 1
    v_cndmask_b32 v8, 0, v8, vcc
    v_cndmask_b32 v9, 0, v9, vcc
    v_cndmask_b32 v10, 0, v10, vcc
    v_cndmask_b32 v11, 0, v11, vcc
    v_cndmask_b32 v12, 0, v12, vcc
    v_cndmask_b32 v13, 0, v13, vcc
    v_cndmask_b32 v14, 0, v14, vcc
    v_cndmask_b32 v15, 0, v15, vcc
    v_lshrrev_b32 v20, 6, v0
    v_lshlrev_b32 v20, 2, v20
    v_mov_b32 v21, 0
    s_barrier
    v_max3_u32 v16, v8, v9, v10
    v_max3_u32 v16, v16, v11, v12
    v_max3_u32 v16, v16, v13, v14
    v_max_u32 v16, v16, v15
    s_nop 1
    v_max_u32_dpp v16, v16, v16 row_ror:4 row_mask:0xf bank_mask:0xf
    s_nop 1
    v_max_u32_dpp v16, v16, v16 row_ror:2 row_mask:0xf bank_mask:0xf
    s_nop 1
    v_max_u32_dpp v16, v16, v16 row_ror:1 row_mask:0xf bank_mask:0xf
    s_nop 1
    v_max_u32_dpp v16, v16, v16 row_ror:8 row_mask:0xf bank_mask:0xf
    v_mov_b32 v17, v16
    s_nop 1
    v_permlane16_swap_b32 v16, v17
    v_max_u32 v16, v16, v17
    v_mov_b32 v17, v16
    s_nop 1
    v_permlane32_swap_b32 v16, v17
    v_max_u32 v16, v16, v17
    ds_write_b32 v20, v16 offset:0
    s_waitcnt lgkmcnt(0)
    s_barrier
    ds_read_b128 v[24:27], v21 offset:0
    s_waitcnt lgkmcnt(0)
    v_max3_u32 v16, v24, v25, v26
    v_max_u32 v16, v16, v27
    v_and_b32 v18, 0x7ff, v16
    v_sub_u32 v18, 2047, v18
    s_nop 0
    v_readfirstlane_b32 s40, v18
    v_cmp_ne_u32 vcc, v8, v16
    s_nop 1
    v_cndmask_b32 v8, 0, v8, vcc
    v_cmp_ne_u32 vcc, v9, v16
    s_nop 1
    v_cndmask_b32 v9, 0, v9, vcc
    v_cmp_ne_u32 vcc, v10, v16
    s_nop 1
    v_cndmask_b32 v10, 0, v10, vcc
    v_cmp_ne_u32 vcc, v11, v16
    s_nop 1
    v_cndmask_b32 v11, 0, v11, vcc
    v_cmp_ne_u32 vcc, v12, v16
    s_nop 1
    v_cndmask_b32 v12, 0, v12, vcc
    v_cmp_ne_u32 vcc, v13, v16
    s_nop 1
    v_cndmask_b32 v13, 0, v13, vcc
    v_cmp_ne_u32 vcc, v14, v16
    s_nop 1
    v_cndmask_b32 v14, 0, v14, vcc
    v_cmp_ne_u32 vcc, v15, v16
    s_nop 1
    v_cndmask_b32 v15, 0, v15, vcc
    v_max3_u32 v16, v8, v9, v10
    v_max3_u32 v16, v16, v11, v12
    v_max3_u32 v16, v16, v13, v14
    v_max_u32 v16, v16, v15
    s_nop 1
    v_max_u32_dpp v16, v16, v16 row_ror:4 row_mask:0xf bank_mask:0xf
    s_nop 1
    v_max_u32_dpp v16, v16, v16 row_ror:2 row_mask:0xf bank_mask:0xf
    s_nop 1
    v_max_u32_dpp v16, v16, v16 row_ror:1 row_mask:0xf bank_mask:0xf
    s_nop 1
    v_max_u32_dpp v16, v16, v16 row_ror:8 row_mask:0xf bank_mask:0xf
    v_mov_b32 v17, v16
    s_nop 1
    v_permlane16_swap_b32 v16, v17
    v_max_u32 v16, v16, v17
    v_mov_b32 v17, v16
    s_nop 1
    v_permlane32_swap_b32 v16, v17
    v_max_u32 v16, v16, v17
    ds_write_b32 v20, v16 offset:16
    s_waitcnt lgkmcnt(0)
    s_barrier
    ds_read_b128 v[24:27], v21 offset:16
    s_waitcnt lgkmcnt(0)
    v_max3_u32 v16, v24, v25, v26
    v_max_u32 v16, v16, v27
    v_and_b32 v18, 0x7ff, v16
    v_sub_u32 v18, 2047, v18
    s_nop 0
    v_readfirstlane_b32 s41, v18
    s_nop 3
    s_mov_b32 s54, s40
    s_mov_b32 s55, s41
    v_lshlrev_b32 v35, 1, v32
    s_mul_i32 s26, s40, 896
    s_add_u32 s26, s26, 90001408
    s_mul_i32 s27, s41, 896
    s_add_u32 s27, s27, 90001408
    s_mov_b32 s36, 0
Lm_pd_111:
    buffer_load_dword v96, v35, s[16:19], s26 offen offset:0 sc1
    buffer_load_dword v112, v35, s[16:19], s27 offen offset:0 sc1
    buffer_load_dword v97, v35, s[16:19], s26 offen offset:4 sc1
    buffer_load_dword v113, v35, s[16:19], s27 offen offset:4 sc1
    buffer_load_dword v98, v35, s[16:19], s26 offen offset:8 sc1
    buffer_load_dword v114, v35, s[16:19], s27 offen offset:8 sc1
    buffer_load_dword v99, v35, s[16:19], s26 offen offset:12 sc1
    buffer_load_dword v115, v35, s[16:19], s27 offen offset:12 sc1
    buffer_load_dword v100, v35, s[16:19], s26 offen offset:16 sc1
    buffer_load_dword v116, v35, s[16:19], s27 offen offset:16 sc1
    buffer_load_dword v101, v35, s[16:19], s26 offen offset:20 sc1
    buffer_load_dword v117, v35, s[16:19], s27 offen offset:20 sc1
    buffer_load_dword v102, v35, s[16:19], s26 offen offset:24 sc1
    buffer_load_dword v118, v35, s[16:19], s27 offen offset:24 sc1
    s_waitcnt vmcnt(0)
    v_max3_u32 v4, v96, v97, v98
    v_max3_u32 v5, v99, v100, v101
    v_max3_u32 v4, v4, v102, v112
    v_max3_u32 v5, v5, v113, v114
    v_max3_u32 v4, v4, v115, v116
    v_max3_u32 v5, v5, v117, v118
    v_max_u32 v4, v4, v5
    v_cmp_eq_u32 vcc, -1, v4
    s_cbranch_vccz Lm_pd_111_ok
    s_sleep 1
    s_add_u32 s36, s36, 1
    s_cmp_lt_u32 s36, 400000
    s_cbranch_scc1 Lm_pd_111
Lm_pd_111_ok:
    v_mov_b32 v40, 0
    v_mov_b32 v41, 0
    v_mov_b32 v42, 0
    v_mov_b32 v43, 0
    v_mov_b32 v44, 0
    v_mov_b32 v45, 0
    v_mov_b32 v46, 0
    v_mov_b32 v47, 0
    v_lshlrev_b32 v48, 16, v64
    v_and_b32 v49, 0xffff0000, v64
    v_lshlrev_b32 v50, 16, v80
    v_and_b32 v51, 0xffff0000, v80
    v_lshlrev_b32 v52, 16, v96
    v_fmac_f32 v40, v48, v52
    v_fmac_f32 v41, v49, v52
    v_fmac_f32 v42, v50, v52
    v_fmac_f32 v43, v51, v52
    v_lshlrev_b32 v52, 16, v112
    v_fmac_f32 v44, v48, v52
    v_fmac_f32 v45, v49, v52
    v_fmac_f32 v46, v50, v52
    v_fmac_f32 v47, v51, v52
    v_lshlrev_b32 v48, 16, v65
    v_and_b32 v49, 0xffff0000, v65
    v_lshlrev_b32 v50, 16, v81
    v_and_b32 v51, 0xffff0000, v81
    v_and_b32 v52, 0xffff0000, v96
    v_fmac_f32 v40, v48, v52
    v_fmac_f32 v41, v49, v52
    v_fmac_f32 v42, v50, v52
    v_fmac_f32 v43, v51, v52
    v_and_b32 v52, 0xffff0000, v112
    v_fmac_f32 v44, v48, v52
    v_fmac_f32 v45, v49, v52
    v_fmac_f32 v46, v50, v52
    v_fmac_f32 v47, v51, v52
    v_lshlrev_b32 v48, 16, v66
    v_and_b32 v49, 0xffff0000, v66
    v_lshlrev_b32 v50, 16, v82
    v_and_b32 v51, 0xffff0000, v82
    v_lshlrev_b32 v52, 16, v97
    v_fmac_f32 v40, v48, v52
    v_fmac_f32 v41, v49, v52
    v_fmac_f32 v42, v50, v52
    v_fmac_f32 v43, v51, v52
    v_lshlrev_b32 v52, 16, v113
    v_fmac_f32 v44, v48, v52
    v_fmac_f32 v45, v49, v52
    v_fmac_f32 v46, v50, v52
    v_fmac_f32 v47, v51, v52
    v_lshlrev_b32 v48, 16, v67
    v_and_b32 v49, 0xffff0000, v67
    v_lshlrev_b32 v50, 16, v83
    v_and_b32 v51, 0xffff0000, v83
    v_and_b32 v52, 0xffff0000, v97
    v_fmac_f32 v40, v48, v52
    v_fmac_f32 v41, v49, v52
    v_fmac_f32 v42, v50, v52
    v_fmac_f32 v43, v51, v52
    v_and_b32 v52, 0xffff0000, v113
    v_fmac_f32 v44, v48, v52
    v_fmac_f32 v45, v49, v52
    v_fmac_f32 v46, v50, v52
    v_fmac_f32 v47, v51, v52
    v_lshlrev_b32 v48, 16, v68
    v_and_b32 v49, 0xffff0000, v68
    v_lshlrev_b32 v50, 16, v84
    v_and_b32 v51, 0xffff0000, v84
    v_lshlrev_b32 v52, 16, v98
    v_fmac_f32 v40, v48, v52
    v_fmac_f32 v41, v49, v52
    v_fmac_f32 v42, v50, v52
    v_fmac_f32 v43, v51, v52
    v_lshlrev_b32 v52, 16, v114
    v_fmac_f32 v44, v48, v52
    v_fmac_f32 v45, v49, v52
    v_fmac_f32 v46, v50, v52
    v_fmac_f32 v47, v51, v52
    v_lshlrev_b32 v48, 16, v69
    v_and_b32 v49, 0xffff0000, v69
    v_lshlrev_b32 v50, 16, v85
    v_and_b32 v51, 0xffff0000, v85
    v_and_b32 v52, 0xffff0000, v98
    v_fmac_f32 v40, v48, v52
    v_fmac_f32 v41, v49, v52
    v_fmac_f32 v42, v50, v52
    v_fmac_f32 v43, v51, v52
    v_and_b32 v52, 0xffff0000, v114
    v_fmac_f32 v44, v48, v52
    v_fmac_f32 v45, v49, v52
    v_fmac_f32 v46, v50, v52
    v_fmac_f32 v47, v51, v52
    v_lshlrev_b32 v48, 16, v70
    v_and_b32 v49, 0xffff0000, v70
    v_lshlrev_b32 v50, 16, v86
    v_and_b32 v51, 0xffff0000, v86
    v_lshlrev_b32 v52, 16, v99
    v_fmac_f32 v40, v48, v52
    v_fmac_f32 v41, v49, v52
    v_fmac_f32 v42, v50, v52
    v_fmac_f32 v43, v51, v52
    v_lshlrev_b32 v52, 16, v115
    v_fmac_f32 v44, v48, v52
    v_fmac_f32 v45, v49, v52
    v_fmac_f32 v46, v50, v52
    v_fmac_f32 v47, v51, v52
    v_lshlrev_b32 v48, 16, v71
    v_and_b32 v49, 0xffff0000, v71
    v_lshlrev_b32 v50, 16, v87
    v_and_b32 v51, 0xffff0000, v87
    v_and_b32 v52, 0xffff0000, v99
    v_fmac_f32 v40, v48, v52
    v_fmac_f32 v41, v49, v52
    v_fmac_f32 v42, v50, v52
    v_fmac_f32 v43, v51, v52
    v_and_b32 v52, 0xffff0000, v115
    v_fmac_f32 v44, v48, v52
    v_fmac_f32 v45, v49, v52
    v_fmac_f32 v46, v50, v52
    v_fmac_f32 v47, v51, v52
    v_lshlrev_b32 v48, 16, v72
    v_and_b32 v49, 0xffff0000, v72
    v_lshlrev_b32 v50, 16, v88
    v_and_b32 v51, 0xffff0000, v88
    v_lshlrev_b32 v52, 16, v100
    v_fmac_f32 v40, v48, v52
    v_fmac_f32 v41, v49, v52
    v_fmac_f32 v42, v50, v52
    v_fmac_f32 v43, v51, v52
    v_lshlrev_b32 v52, 16, v116
    v_fmac_f32 v44, v48, v52
    v_fmac_f32 v45, v49, v52
    v_fmac_f32 v46, v50, v52
    v_fmac_f32 v47, v51, v52
    v_lshlrev_b32 v48, 16, v73
    v_and_b32 v49, 0xffff0000, v73
    v_lshlrev_b32 v50, 16, v89
    v_and_b32 v51, 0xffff0000, v89
    v_and_b32 v52, 0xffff0000, v100
    v_fmac_f32 v40, v48, v52
    v_fmac_f32 v41, v49, v52
    v_fmac_f32 v42, v50, v52
    v_fmac_f32 v43, v51, v52
    v_and_b32 v52, 0xffff0000, v116
    v_fmac_f32 v44, v48, v52
    v_fmac_f32 v45, v49, v52
    v_fmac_f32 v46, v50, v52
    v_fmac_f32 v47, v51, v52
    v_lshlrev_b32 v48, 16, v74
    v_and_b32 v49, 0xffff0000, v74
    v_lshlrev_b32 v50, 16, v90
    v_and_b32 v51, 0xffff0000, v90
    v_lshlrev_b32 v52, 16, v101
    v_fmac_f32 v40, v48, v52
    v_fmac_f32 v41, v49, v52
    v_fmac_f32 v42, v50, v52
    v_fmac_f32 v43, v51, v52
    v_lshlrev_b32 v52, 16, v117
    v_fmac_f32 v44, v48, v52
    v_fmac_f32 v45, v49, v52
    v_fmac_f32 v46, v50, v52
    v_fmac_f32 v47, v51, v52
    v_lshlrev_b32 v48, 16, v75
    v_and_b32 v49, 0xffff0000, v75
    v_lshlrev_b32 v50, 16, v91
    v_and_b32 v51, 0xffff0000, v91
    v_and_b32 v52, 0xffff0000, v101
    v_fmac_f32 v40, v48, v52
    v_fmac_f32 v41, v49, v52
    v_fmac_f32 v42, v50, v52
    v_fmac_f32 v43, v51, v52
    v_and_b32 v52, 0xffff0000, v117
    v_fmac_f32 v44, v48, v52
    v_fmac_f32 v45, v49, v52
    v_fmac_f32 v46, v50, v52
    v_fmac_f32 v47, v51, v52
    v_lshlrev_b32 v48, 16, v76
    v_and_b32 v49, 0xffff0000, v76
    v_lshlrev_b32 v50, 16, v92
    v_and_b32 v51, 0xffff0000, v92
    v_lshlrev_b32 v52, 16, v102
    v_fmac_f32 v40, v48, v52
    v_fmac_f32 v41, v49, v52
    v_fmac_f32 v42, v50, v52
    v_fmac_f32 v43, v51, v52
    v_lshlrev_b32 v52, 16, v118
    v_fmac_f32 v44, v48, v52
    v_fmac_f32 v45, v49, v52
    v_fmac_f32 v46, v50, v52
    v_fmac_f32 v47, v51, v52
    v_lshlrev_b32 v48, 16, v77
    v_and_b32 v49, 0xffff0000, v77
    v_lshlrev_b32 v50, 16, v93
    v_and_b32 v51, 0xffff0000, v93
    v_and_b32 v52, 0xffff0000, v102
    v_fmac_f32 v40, v48, v52
    v_fmac_f32 v41, v49, v52
    v_fmac_f32 v42, v50, v52
    v_fmac_f32 v43, v51, v52
    v_and_b32 v52, 0xffff0000, v118
    v_fmac_f32 v44, v48, v52
    v_fmac_f32 v45, v49, v52
    v_fmac_f32 v46, v50, v52
    v_fmac_f32 v47, v51, v52
    s_nop 1
    v_add_f32_dpp v40, v40, v40 row_ror:8 row_mask:0xf bank_mask:0xf
    v_mov_b32 v52, v40
    s_nop 1
    v_permlane16_swap_b32 v40, v52
    v_add_f32 v40, v40, v52
    v_mov_b32 v52, v40
    s_nop 1
    v_permlane32_swap_b32 v40, v52
    v_add_f32 v40, v40, v52
    s_nop 1
    v_add_f32_dpp v41, v41, v41 row_ror:8 row_mask:0xf bank_mask:0xf
    v_mov_b32 v52, v41
    s_nop 1
    v_permlane16_swap_b32 v41, v52
    v_add_f32 v41, v41, v52
    v_mov_b32 v52, v41
    s_nop 1
    v_permlane32_swap_b32 v41, v52
    v_add_f32 v41, v41, v52
    s_nop 1
    v_add_f32_dpp v42, v42, v42 row_ror:8 row_mask:0xf bank_mask:0xf
    v_mov_b32 v52, v42
    s_nop 1
    v_permlane16_swap_b32 v42, v52
    v_add_f32 v42, v42, v52
    v_mov_b32 v52, v42
    s_nop 1
    v_permlane32_swap_b32 v42, v52
    v_add_f32 v42, v42, v52
    s_nop 1
    v_add_f32_dpp v43, v43, v43 row_ror:8 row_mask:0xf bank_mask:0xf
    v_mov_b32 v52, v43
    s_nop 1
    v_permlane16_swap_b32 v43, v52
    v_add_f32 v43, v43, v52
    v_mov_b32 v52, v43
    s_nop 1
    v_permlane32_swap_b32 v43, v52
    v_add_f32 v43, v43, v52
    s_nop 1
    v_add_f32_dpp v44, v44, v44 row_ror:8 row_mask:0xf bank_mask:0xf
    v_mov_b32 v52, v44
    s_nop 1
    v_permlane16_swap_b32 v44, v52
    v_add_f32 v44, v44, v52
    v_mov_b32 v52, v44
    s_nop 1
    v_permlane32_swap_b32 v44, v52
    v_add_f32 v44, v44, v52
    s_nop 1
    v_add_f32_dpp v45, v45, v45 row_ror:8 row_mask:0xf bank_mask:0xf
    v_mov_b32 v52, v45
    s_nop 1
    v_permlane16_swap_b32 v45, v52
    v_add_f32 v45, v45, v52
    v_mov_b32 v52, v45
    s_nop 1
    v_permlane32_swap_b32 v45, v52
    v_add_f32 v45, v45, v52
    s_nop 1
    v_add_f32_dpp v46, v46, v46 row_ror:8 row_mask:0xf bank_mask:0xf
    v_mov_b32 v52, v46
    s_nop 1
    v_permlane16_swap_b32 v46, v52
    v_add_f32 v46, v46, v52
    v_mov_b32 v52, v46
    s_nop 1
    v_permlane32_swap_b32 v46, v52
    v_add_f32 v46, v46, v52
    s_nop 1
    v_add_f32_dpp v47, v47, v47 row_ror:8 row_mask:0xf bank_mask:0xf
    v_mov_b32 v52, v47
    s_nop 1
    v_permlane16_swap_b32 v47, v52
    v_add_f32 v47, v47, v52
    v_mov_b32 v52, v47
    s_nop 1
    v_permlane32_swap_b32 v47, v52
    v_add_f32 v47, v47, v52
    v_lshlrev_b32 v53, 5, v30
    s_lshl_b32 s28, s22, 8
    s_add_u32 s28, s28, 256
    v_add_u32 v53, s28, v53
    s_mov_b64 exec, 0xff
    ds_write_b128 v53, v[40:43]
    ds_write_b128 v53, v[44:47] offset:16
    s_mov_b64 exec, -1
    s_waitcnt lgkmcnt(0)
    s_barrier
    v_cmp_gt_u32 vcc, 32, v0
    s_and_saveexec_b64 s[30:31], vcc
    s_cbranch_execz Lm_gf_112
    v_lshrrev_b32 v54, 4, v0
    v_and_b32 v55, 15, v0
    v_lshrrev_b32 v56, 1, v55
    v_lshlrev_b32 v56, 3, v56
    v_lshlrev_b32 v57, 2, v54
    v_add_u32 v56, v56, v57
    v_and_b32 v57, 1, v55
    v_add_u32 v56, v56, v57
    v_lshlrev_b32 v56, 2, v56
    v_add_u32 v56, 256, v56
    ds_read_b32 v100, v56 offset:0
    ds_read_b32 v104, v56 offset:8
    ds_read_b32 v101, v56 offset:256
    ds_read_b32 v105, v56 offset:264
    ds_read_b32 v102, v56 offset:512
    ds_read_b32 v106, v56 offset:520
    ds_read_b32 v103, v56 offset:768
    ds_read_b32 v107, v56 offset:776
    s_waitcnt lgkmcnt(0)
    v_add_f32 v100, v100, v101
    v_add_f32 v102, v102, v103
    v_add_f32 v100, v100, v102
    v_add_f32 v104, v104, v105
    v_add_f32 v106, v106, v107
    v_add_f32 v104, v104, v106
    v_cvt_pk_bf16_f32 v100, v100, v100
    v_lshlrev_b32 v100, 16, v100
    v_cvt_pk_bf16_f32 v104, v104, v104
    v_lshlrev_b32 v104, 16, v104
    v_mul_f32 v101, 0xbfb8aa3b, v100
    v_exp_f32 v101, v101
    s_nop 0
    v_add_f32 v101, 1.0, v101
    v_rcp_f32 v101, v101
    s_nop 0
    v_mul_f32 v100, v100, v101
    v_cvt_pk_bf16_f32 v100, v100, v100
    v_lshlrev_b32 v100, 16, v100
    v_mul_f32 v100, v100, v104
    v_cvt_pk_bf16_f32 v100, v100, v100
    v_lshlrev_b32 v100, 16, v100
    v_mul_u32_u24 v58, 7168, v54
    v_lshlrev_b32 v59, 2, v55
    v_add_u32 v58, v58, v59
    s_lshl_b32 s28, s43, 6
    s_add_u32 s28, s28, 91844608
    buffer_store_dword v100, v58, s[16:19], s28 offen sc1
Lm_gf_112:
    s_mov_b64 exec, s[30:31]
    v_lshlrev_b32 v2, 5, v0
    s_mov_b32 s23, 91836416
    s_mov_b32 s36, 0
Lm_pd_113:
    buffer_load_dwordx4 v[8:11], v2, s[16:19], s23 offen sc1
    buffer_load_dwordx4 v[12:15], v2, s[16:19], s23 offen offset:16 sc1
    s_waitcnt vmcnt(0)
    v_max3_u32 v4, v8, v9, v10
    v_max3_u32 v5, v11, v12, v13
    v_max3_u32 v4, v4, v14, v15
    v_max_u32 v4, v4, v5
    v_cmp_eq_u32 vcc, -1, v4
    s_cbranch_vccz Lm_pd_113_ok
    s_sleep 2
    s_add_u32 s36, s36, 1
    s_cmp_lt_u32 s36, 400000
    s_cbranch_scc1 Lm_pd_113
Lm_pd_113_ok:
    v_lshlrev_b32 v3, 3, v0
    v_sub_u32 v3, 2047, v3
    v_ashrrev_i32 v4, 31, v8
    v_or_b32 v4, 0x80000000, v4
    v_xor_b32 v8, v8, v4
    v_and_b32 v8, 0xfffff800, v8
    v_subrev_u32 v4, 0, v3
    v_or_b32 v8, v8, v4
    v_ashrrev_i32 v4, 31, v9
    v_or_b32 v4, 0x80000000, v4
    v_xor_b32 v9, v9, v4
    v_and_b32 v9, 0xfffff800, v9
    v_subrev_u32 v4, 1, v3
    v_or_b32 v9, v9, v4
    v_ashrrev_i32 v4, 31, v10
    v_or_b32 v4, 0x80000000, v4
    v_xor_b32 v10, v10, v4
    v_and_b32 v10, 0xfffff800, v10
    v_subrev_u32 v4, 2, v3
    v_or_b32 v10, v10, v4
    v_ashrrev_i32 v4, 31, v11
    v_or_b32 v4, 0x80000000, v4
    v_xor_b32 v11, v11, v4
    v_and_b32 v11, 0xfffff800, v11
    v_subrev_u32 v4, 3, v3
    v_or_b32 v11, v11, v4
    v_ashrrev_i32 v4, 31, v12
    v_or_b32 v4, 0x80000000, v4
    v_xor_b32 v12, v12, v4
    v_and_b32 v12, 0xfffff800, v12
    v_subrev_u32 v4, 4, v3
    v_or_b32 v12, v12, v4
    v_ashrrev_i32 v4, 31, v13
    v_or_b32 v4, 0x80000000, v4
    v_xor_b32 v13, v13, v4
    v_and_b32 v13, 0xfffff800, v13
    v_subrev_u32 v4, 5, v3
    v_or_b32 v13, v13, v4
    v_ashrrev_i32 v4, 31, v14
    v_or_b32 v4, 0x80000000, v4
    v_xor_b32 v14, v14, v4
    v_and_b32 v14, 0xfffff800, v14
    v_subrev_u32 v4, 6, v3
    v_or_b32 v14, v14, v4
    v_ashrrev_i32 v4, 31, v15
    v_or_b32 v4, 0x80000000, v4
    v_xor_b32 v15, v15, v4
    v_and_b32 v15, 0xfffff800, v15
    v_subrev_u32 v4, 7, v3
    v_or_b32 v15, v15, v4
    v_lshrrev_b32 v20, 6, v0
    v_lshlrev_b32 v20, 2, v20
    v_mov_b32 v21, 0
    s_barrier
    v_max3_u32 v16, v8, v9, v10
    v_max3_u32 v16, v16, v11, v12
    v_max3_u32 v16, v16, v13, v14
    v_max_u32 v16, v16, v15
    s_nop 1
    v_max_u32_dpp v16, v16, v16 row_ror:4 row_mask:0xf bank_mask:0xf
    s_nop 1
    v_max_u32_dpp v16, v16, v16 row_ror:2 row_mask:0xf bank_mask:0xf
    s_nop 1
    v_max_u32_dpp v16, v16, v16 row_ror:1 row_mask:0xf bank_mask:0xf
    s_nop 1
    v_max_u32_dpp v16, v16, v16 row_ror:8 row_mask:0xf bank_mask:0xf
    v_mov_b32 v17, v16
    s_nop 1
    v_permlane16_swap_b32 v16, v17
    v_max_u32 v16, v16, v17
    v_mov_b32 v17, v16
    s_nop 1
    v_permlane32_swap_b32 v16, v17
    v_max_u32 v16, v16, v17
    ds_write_b32 v20, v16 offset:0
    s_waitcnt lgkmcnt(0)
    s_barrier
    ds_read_b128 v[24:27], v21 offset:0
    s_waitcnt lgkmcnt(0)
    v_max3_u32 v16, v24, v25, v26
    v_max_u32 v16, v16, v27
    v_and_b32 v18, 0x7ff, v16
    v_sub_u32 v18, 2047, v18
    s_nop 0
    v_readfirstlane_b32 s40, v18
    v_cmp_ne_u32 vcc, v8, v16
    s_nop 1
    v_cndmask_b32 v8, 0, v8, vcc
    v_cmp_ne_u32 vcc, v9, v16
    s_nop 1
    v_cndmask_b32 v9, 0, v9, vcc
    v_cmp_ne_u32 vcc, v10, v16
    s_nop 1
    v_cndmask_b32 v10, 0, v10, vcc
    v_cmp_ne_u32 vcc, v11, v16
    s_nop 1
    v_cndmask_b32 v11, 0, v11, vcc
    v_cmp_ne_u32 vcc, v12, v16
    s_nop 1
    v_cndmask_b32 v12, 0, v12, vcc
    v_cmp_ne_u32 vcc, v13, v16
    s_nop 1
    v_cndmask_b32 v13, 0, v13, vcc
    v_cmp_ne_u32 vcc, v14, v16
    s_nop 1
    v_cndmask_b32 v14, 0, v14, vcc
    v_cmp_ne_u32 vcc, v15, v16
    s_nop 1
    v_cndmask_b32 v15, 0, v15, vcc
    v_max3_u32 v16, v8, v9, v10
    v_max3_u32 v16, v16, v11, v12
    v_max3_u32 v16, v16, v13, v14
    v_max_u32 v16, v16, v15
    s_nop 1
    v_max_u32_dpp v16, v16, v16 row_ror:4 row_mask:0xf bank_mask:0xf
    s_nop 1
    v_max_u32_dpp v16, v16, v16 row_ror:2 row_mask:0xf bank_mask:0xf
    s_nop 1
    v_max_u32_dpp v16, v16, v16 row_ror:1 row_mask:0xf bank_mask:0xf
    s_nop 1
    v_max_u32_dpp v16, v16, v16 row_ror:8 row_mask:0xf bank_mask:0xf
    v_mov_b32 v17, v16
    s_nop 1
    v_permlane16_swap_b32 v16, v17
    v_max_u32 v16, v16, v17
    v_mov_b32 v17, v16
    s_nop 1
    v_permlane32_swap_b32 v16, v17
    v_max_u32 v16, v16, v17
    ds_write_b32 v20, v16 offset:16
    s_waitcnt lgkmcnt(0)
    s_barrier
    ds_read_b128 v[24:27], v21 offset:16
    s_waitcnt lgkmcnt(0)
    v_max3_u32 v16, v24, v25, v26
    v_max_u32 v16, v16, v27
    v_and_b32 v18, 0x7ff, v16
    v_sub_u32 v18, 2047, v18
    s_nop 0
    v_readfirstlane_b32 s41, v18
    s_nop 3
    s_cmp_eq_u32 s40, s54
    s_cselect_b32 s56, 1, 0
    s_cmp_eq_u32 s41, s55
    s_cselect_b32 s56, s56, 0
    s_cmp_eq_u32 s56, 1
    s_cbranch_scc1 Lm_gd_114
    v_lshlrev_b32 v35, 1, v32
    s_mul_i32 s26, s40, 896
    s_add_u32 s26, s26, 90001408
    s_mul_i32 s27, s41, 896
    s_add_u32 s27, s27, 90001408
    s_mov_b32 s36, 0
Lm_pd_115:
    buffer_load_dword v96, v35, s[16:19], s26 offen offset:0 sc1
    buffer_load_dword v112, v35, s[16:19], s27 offen offset:0 sc1
    buffer_load_dword v97, v35, s[16:19], s26 offen offset:4 sc1
    buffer_load_dword v113, v35, s[16:19], s27 offen offset:4 sc1
    buffer_load_dword v98, v35, s[16:19], s26 offen offset:8 sc1
    buffer_load_dword v114, v35, s[16:19], s27 offen offset:8 sc1
    buffer_load_dword v99, v35, s[16:19], s26 offen offset:12 sc1
    buffer_load_dword v115, v35, s[16:19], s27 offen offset:12 sc1
    buffer_load_dword v100, v35, s[16:19], s26 offen offset:16 sc1
    buffer_load_dword v116, v35, s[16:19], s27 offen offset:16 sc1
    buffer_load_dword v101, v35, s[16:19], s26 offen offset:20 sc1
    buffer_load_dword v117, v35, s[16:19], s27 offen offset:20 sc1
    buffer_load_dword v102, v35, s[16:19], s26 offen offset:24 sc1
    buffer_load_dword v118, v35, s[16:19], s27 offen offset:24 sc1
    s_waitcnt vmcnt(0)
    v_max3_u32 v4, v96, v97, v98
    v_max3_u32 v5, v99, v100, v101
    v_max3_u32 v4, v4, v102, v112
    v_max3_u32 v5, v5, v113, v114
    v_max3_u32 v4, v4, v115, v116
    v_max3_u32 v5, v5, v117, v118
    v_max_u32 v4, v4, v5
    v_cmp_eq_u32 vcc, -1, v4
    s_cbranch_vccz Lm_pd_115_ok
    s_sleep 1
    s_add_u32 s36, s36, 1
    s_cmp_lt_u32 s36, 400000
    s_cbranch_scc1 Lm_pd_115
Lm_pd_115_ok:
    v_mov_b32 v40, 0
    v_mov_b32 v41, 0
    v_mov_b32 v42, 0
    v_mov_b32 v43, 0
    v_mov_b32 v44, 0
    v_mov_b32 v45, 0
    v_mov_b32 v46, 0
    v_mov_b32 v47, 0
    v_lshlrev_b32 v48, 16, v64
    v_and_b32 v49, 0xffff0000, v64
    v_lshlrev_b32 v50, 16, v80
    v_and_b32 v51, 0xffff0000, v80
    v_lshlrev_b32 v52, 16, v96
    v_fmac_f32 v40, v48, v52
    v_fmac_f32 v41, v49, v52
    v_fmac_f32 v42, v50, v52
    v_fmac_f32 v43, v51, v52
    v_lshlrev_b32 v52, 16, v112
    v_fmac_f32 v44, v48, v52
    v_fmac_f32 v45, v49, v52
    v_fmac_f32 v46, v50, v52
    v_fmac_f32 v47, v51, v52
    v_lshlrev_b32 v48, 16, v65
    v_and_b32 v49, 0xffff0000, v65
    v_lshlrev_b32 v50, 16, v81
    v_and_b32 v51, 0xffff0000, v81
    v_and_b32 v52, 0xffff0000, v96
    v_fmac_f32 v40, v48, v52
    v_fmac_f32 v41, v49, v52
    v_fmac_f32 v42, v50, v52
    v_fmac_f32 v43, v51, v52
    v_and_b32 v52, 0xffff0000, v112
    v_fmac_f32 v44, v48, v52
    v_fmac_f32 v45, v49, v52
    v_fmac_f32 v46, v50, v52
    v_fmac_f32 v47, v51, v52
    v_lshlrev_b32 v48, 16, v66
    v_and_b32 v49, 0xffff0000, v66
    v_lshlrev_b32 v50, 16, v82
    v_and_b32 v51, 0xffff0000, v82
    v_lshlrev_b32 v52, 16, v97
    v_fmac_f32 v40, v48, v52
    v_fmac_f32 v41, v49, v52
    v_fmac_f32 v42, v50, v52
    v_fmac_f32 v43, v51, v52
    v_lshlrev_b32 v52, 16, v113
    v_fmac_f32 v44, v48, v52
    v_fmac_f32 v45, v49, v52
    v_fmac_f32 v46, v50, v52
    v_fmac_f32 v47, v51, v52
    v_lshlrev_b32 v48, 16, v67
    v_and_b32 v49, 0xffff0000, v67
    v_lshlrev_b32 v50, 16, v83
    v_and_b32 v51, 0xffff0000, v83
    v_and_b32 v52, 0xffff0000, v97
    v_fmac_f32 v40, v48, v52
    v_fmac_f32 v41, v49, v52
    v_fmac_f32 v42, v50, v52
    v_fmac_f32 v43, v51, v52
    v_and_b32 v52, 0xffff0000, v113
    v_fmac_f32 v44, v48, v52
    v_fmac_f32 v45, v49, v52
    v_fmac_f32 v46, v50, v52
    v_fmac_f32 v47, v51, v52
    v_lshlrev_b32 v48, 16, v68
    v_and_b32 v49, 0xffff0000, v68
    v_lshlrev_b32 v50, 16, v84
    v_and_b32 v51, 0xffff0000, v84
    v_lshlrev_b32 v52, 16, v98
    v_fmac_f32 v40, v48, v52
    v_fmac_f32 v41, v49, v52
    v_fmac_f32 v42, v50, v52
    v_fmac_f32 v43, v51, v52
    v_lshlrev_b32 v52, 16, v114
    v_fmac_f32 v44, v48, v52
    v_fmac_f32 v45, v49, v52
    v_fmac_f32 v46, v50, v52
    v_fmac_f32 v47, v51, v52
    v_lshlrev_b32 v48, 16, v69
    v_and_b32 v49, 0xffff0000, v69
    v_lshlrev_b32 v50, 16, v85
    v_and_b32 v51, 0xffff0000, v85
    v_and_b32 v52, 0xffff0000, v98
    v_fmac_f32 v40, v48, v52
    v_fmac_f32 v41, v49, v52
    v_fmac_f32 v42, v50, v52
    v_fmac_f32 v43, v51, v52
    v_and_b32 v52, 0xffff0000, v114
    v_fmac_f32 v44, v48, v52
    v_fmac_f32 v45, v49, v52
    v_fmac_f32 v46, v50, v52
    v_fmac_f32 v47, v51, v52
    v_lshlrev_b32 v48, 16, v70
    v_and_b32 v49, 0xffff0000, v70
    v_lshlrev_b32 v50, 16, v86
    v_and_b32 v51, 0xffff0000, v86
    v_lshlrev_b32 v52, 16, v99
    v_fmac_f32 v40, v48, v52
    v_fmac_f32 v41, v49, v52
    v_fmac_f32 v42, v50, v52
    v_fmac_f32 v43, v51, v52
    v_lshlrev_b32 v52, 16, v115
    v_fmac_f32 v44, v48, v52
    v_fmac_f32 v45, v49, v52
    v_fmac_f32 v46, v50, v52
    v_fmac_f32 v47, v51, v52
    v_lshlrev_b32 v48, 16, v71
    v_and_b32 v49, 0xffff0000, v71
    v_lshlrev_b32 v50, 16, v87
    v_and_b32 v51, 0xffff0000, v87
    v_and_b32 v52, 0xffff0000, v99
    v_fmac_f32 v40, v48, v52
    v_fmac_f32 v41, v49, v52
    v_fmac_f32 v42, v50, v52
    v_fmac_f32 v43, v51, v52
    v_and_b32 v52, 0xffff0000, v115
    v_fmac_f32 v44, v48, v52
    v_fmac_f32 v45, v49, v52
    v_fmac_f32 v46, v50, v52
    v_fmac_f32 v47, v51, v52
    v_lshlrev_b32 v48, 16, v72
    v_and_b32 v49, 0xffff0000, v72
    v_lshlrev_b32 v50, 16, v88
    v_and_b32 v51, 0xffff0000, v88
    v_lshlrev_b32 v52, 16, v100
    v_fmac_f32 v40, v48, v52
    v_fmac_f32 v41, v49, v52
    v_fmac_f32 v42, v50, v52
    v_fmac_f32 v43, v51, v52
    v_lshlrev_b32 v52, 16, v116
    v_fmac_f32 v44, v48, v52
    v_fmac_f32 v45, v49, v52
    v_fmac_f32 v46, v50, v52
    v_fmac_f32 v47, v51, v52
    v_lshlrev_b32 v48, 16, v73
    v_and_b32 v49, 0xffff0000, v73
    v_lshlrev_b32 v50, 16, v89
    v_and_b32 v51, 0xffff0000, v89
    v_and_b32 v52, 0xffff0000, v100
    v_fmac_f32 v40, v48, v52
    v_fmac_f32 v41, v49, v52
    v_fmac_f32 v42, v50, v52
    v_fmac_f32 v43, v51, v52
    v_and_b32 v52, 0xffff0000, v116
    v_fmac_f32 v44, v48, v52
    v_fmac_f32 v45, v49, v52
    v_fmac_f32 v46, v50, v52
    v_fmac_f32 v47, v51, v52
    v_lshlrev_b32 v48, 16, v74
    v_and_b32 v49, 0xffff0000, v74
    v_lshlrev_b32 v50, 16, v90
    v_and_b32 v51, 0xffff0000, v90
    v_lshlrev_b32 v52, 16, v101
    v_fmac_f32 v40, v48, v52
    v_fmac_f32 v41, v49, v52
    v_fmac_f32 v42, v50, v52
    v_fmac_f32 v43, v51, v52
    v_lshlrev_b32 v52, 16, v117
    v_fmac_f32 v44, v48, v52
    v_fmac_f32 v45, v49, v52
    v_fmac_f32 v46, v50, v52
    v_fmac_f32 v47, v51, v52
    v_lshlrev_b32 v48, 16, v75
    v_and_b32 v49, 0xffff0000, v75
    v_lshlrev_b32 v50, 16, v91
    v_and_b32 v51, 0xffff0000, v91
    v_and_b32 v52, 0xffff0000, v101
    v_fmac_f32 v40, v48, v52
    v_fmac_f32 v41, v49, v52
    v_fmac_f32 v42, v50, v52
    v_fmac_f32 v43, v51, v52
    v_and_b32 v52, 0xffff0000, v117
    v_fmac_f32 v44, v48, v52
    v_fmac_f32 v45, v49, v52
    v_fmac_f32 v46, v50, v52
    v_fmac_f32 v47, v51, v52
    v_lshlrev_b32 v48, 16, v76
    v_and_b32 v49, 0xffff0000, v76
    v_lshlrev_b32 v50, 16, v92
    v_and_b32 v51, 0xffff0000, v92
    v_lshlrev_b32 v52, 16, v102
    v_fmac_f32 v40, v48, v52
    v_fmac_f32 v41, v49, v52
    v_fmac_f32 v42, v50, v52
    v_fmac_f32 v43, v51, v52
    v_lshlrev_b32 v52, 16, v118
    v_fmac_f32 v44, v48, v52
    v_fmac_f32 v45, v49, v52
    v_fmac_f32 v46, v50, v52
    v_fmac_f32 v47, v51, v52
    v_lshlrev_b32 v48, 16, v77
    v_and_b32 v49, 0xffff0000, v77
    v_lshlrev_b32 v50, 16, v93
    v_and_b32 v51, 0xffff0000, v93
    v_and_b32 v52, 0xffff0000, v102
    v_fmac_f32 v40, v48, v52
    v_fmac_f32 v41, v49, v52
    v_fmac_f32 v42, v50, v52
    v_fmac_f32 v43, v51, v52
    v_and_b32 v52, 0xffff0000, v118
    v_fmac_f32 v44, v48, v52
    v_fmac_f32 v45, v49, v52
    v_fmac_f32 v46, v50, v52
    v_fmac_f32 v47, v51, v52
    s_nop 1
    v_add_f32_dpp v40, v40, v40 row_ror:8 row_mask:0xf bank_mask:0xf
    v_mov_b32 v52, v40
    s_nop 1
    v_permlane16_swap_b32 v40, v52
    v_add_f32 v40, v40, v52
    v_mov_b32 v52, v40
    s_nop 1
    v_permlane32_swap_b32 v40, v52
    v_add_f32 v40, v40, v52
    s_nop 1
    v_add_f32_dpp v41, v41, v41 row_ror:8 row_mask:0xf bank_mask:0xf
    v_mov_b32 v52, v41
    s_nop 1
    v_permlane16_swap_b32 v41, v52
    v_add_f32 v41, v41, v52
    v_mov_b32 v52, v41
    s_nop 1
    v_permlane32_swap_b32 v41, v52
    v_add_f32 v41, v41, v52
    s_nop 1
    v_add_f32_dpp v42, v42, v42 row_ror:8 row_mask:0xf bank_mask:0xf
    v_mov_b32 v52, v42
    s_nop 1
    v_permlane16_swap_b32 v42, v52
    v_add_f32 v42, v42, v52
    v_mov_b32 v52, v42
    s_nop 1
    v_permlane32_swap_b32 v42, v52
    v_add_f32 v42, v42, v52
    s_nop 1
    v_add_f32_dpp v43, v43, v43 row_ror:8 row_mask:0xf bank_mask:0xf
    v_mov_b32 v52, v43
    s_nop 1
    v_permlane16_swap_b32 v43, v52
    v_add_f32 v43, v43, v52
    v_mov_b32 v52, v43
    s_nop 1
    v_permlane32_swap_b32 v43, v52
    v_add_f32 v43, v43, v52
    s_nop 1
    v_add_f32_dpp v44, v44, v44 row_ror:8 row_mask:0xf bank_mask:0xf
    v_mov_b32 v52, v44
    s_nop 1
    v_permlane16_swap_b32 v44, v52
    v_add_f32 v44, v44, v52
    v_mov_b32 v52, v44
    s_nop 1
    v_permlane32_swap_b32 v44, v52
    v_add_f32 v44, v44, v52
    s_nop 1
    v_add_f32_dpp v45, v45, v45 row_ror:8 row_mask:0xf bank_mask:0xf
    v_mov_b32 v52, v45
    s_nop 1
    v_permlane16_swap_b32 v45, v52
    v_add_f32 v45, v45, v52
    v_mov_b32 v52, v45
    s_nop 1
    v_permlane32_swap_b32 v45, v52
    v_add_f32 v45, v45, v52
    s_nop 1
    v_add_f32_dpp v46, v46, v46 row_ror:8 row_mask:0xf bank_mask:0xf
    v_mov_b32 v52, v46
    s_nop 1
    v_permlane16_swap_b32 v46, v52
    v_add_f32 v46, v46, v52
    v_mov_b32 v52, v46
    s_nop 1
    v_permlane32_swap_b32 v46, v52
    v_add_f32 v46, v46, v52
    s_nop 1
    v_add_f32_dpp v47, v47, v47 row_ror:8 row_mask:0xf bank_mask:0xf
    v_mov_b32 v52, v47
    s_nop 1
    v_permlane16_swap_b32 v47, v52
    v_add_f32 v47, v47, v52
    v_mov_b32 v52, v47
    s_nop 1
    v_permlane32_swap_b32 v47, v52
    v_add_f32 v47, v47, v52
    v_lshlrev_b32 v53, 5, v30
    s_lshl_b32 s28, s22, 8
    s_add_u32 s28, s28, 256
    v_add_u32 v53, s28, v53
    s_mov_b64 exec, 0xff
    ds_write_b128 v53, v[40:43]
    ds_write_b128 v53, v[44:47] offset:16
    s_mov_b64 exec, -1
    s_waitcnt lgkmcnt(0)
    s_barrier
    v_cmp_gt_u32 vcc, 32, v0
    s_and_saveexec_b64 s[30:31], vcc
    s_cbranch_execz Lm_gf_116
    v_lshrrev_b32 v54, 4, v0
    v_and_b32 v55, 15, v0
    v_lshrrev_b32 v56, 1, v55
    v_lshlrev_b32 v56, 3, v56
    v_lshlrev_b32 v57, 2, v54
    v_add_u32 v56, v56, v57
    v_and_b32 v57, 1, v55
    v_add_u32 v56, v56, v57
    v_lshlrev_b32 v56, 2, v56
    v_add_u32 v56, 256, v56
    ds_read_b32 v100, v56 offset:0
    ds_read_b32 v104, v56 offset:8
    ds_read_b32 v101, v56 offset:256
    ds_read_b32 v105, v56 offset:264
    ds_read_b32 v102, v56 offset:512
    ds_read_b32 v106, v56 offset:520
    ds_read_b32 v103, v56 offset:768
    ds_read_b32 v107, v56 offset:776
    s_waitcnt lgkmcnt(0)
    v_add_f32 v100, v100, v101
    v_add_f32 v102, v102, v103
    v_add_f32 v100, v100, v102
    v_add_f32 v104, v104, v105
    v_add_f32 v106, v106, v107
    v_add_f32 v104, v104, v106
    v_cvt_pk_bf16_f32 v100, v100, v100
    v_lshlrev_b32 v100, 16, v100
    v_cvt_pk_bf16_f32 v104, v104, v104
    v_lshlrev_b32 v104, 16, v104
    v_mul_f32 v101, 0xbfb8aa3b, v100
    v_exp_f32 v101, v101
    s_nop 0
    v_add_f32 v101, 1.0, v101
    v_rcp_f32 v101, v101
    s_nop 0
    v_mul_f32 v100, v100, v101
    v_cvt_pk_bf16_f32 v100, v100, v100
    v_lshlrev_b32 v100, 16, v100
    v_mul_f32 v100, v100, v104
    v_cvt_pk_bf16_f32 v100, v100, v100
    v_lshlrev_b32 v100, 16, v100
    v_mul_u32_u24 v58, 7168, v54
    v_lshlrev_b32 v59, 2, v55
    v_add_u32 v58, v58, v59
    s_lshl_b32 s28, s43, 6
    s_add_u32 s28, s28, 91860992
    buffer_store_dword v100, v58, s[16:19], s28 offen sc1
Lm_gf_116:
    s_mov_b64 exec, s[30:31]
Lm_gd_114:
    s_branch Lm_tdone
Lm_tdown:
    s_sub_u32 s43, s41, 144
    v_and_b32 v30, 3, v0
    v_lshrrev_b32 v31, 2, v0
    v_mul_u32_u24 v32, 28, v31
    v_mul_u32_u24 v33, 896, v32
    v_lshlrev_b32 v34, 2, v30
    v_add_u32 v33, v33, v34
    s_lshl_b32 s26, s43, 4
    buffer_load_dword v64, v33, s[48:51], s26 offen
    s_add_u32 s26, s26, 896
    buffer_load_dword v65, v33, s[48:51], s26 offen
    s_add_u32 s26, s26, 896
    buffer_load_dword v66, v33, s[48:51], s26 offen
    s_add_u32 s26, s26, 896
    buffer_load_dword v67, v33, s[48:51], s26 offen
    s_add_u32 s26, s26, 896
    buffer_load_dword v68, v33, s[48:51], s26 offen
    s_add_u32 s26, s26, 896
    buffer_load_dword v69, v33, s[48:51], s26 offen
    s_add_u32 s26, s26, 896
    buffer_load_dword v70, v33, s[48:51], s26 offen
    s_add_u32 s26, s26, 896
    buffer_load_dword v71, v33, s[48:51], s26 offen
    s_add_u32 s26, s26, 896
    buffer_load_dword v72, v33, s[48:51], s26 offen
    s_add_u32 s26, s26, 896
    buffer_load_dword v73, v33, s[48:51], s26 offen
    s_add_u32 s26, s26, 896
    buffer_load_dword v74, v33, s[48:51], s26 offen
    s_add_u32 s26, s26, 896
    buffer_load_dword v75, v33, s[48:51], s26 offen
    s_add_u32 s26, s26, 896
    buffer_load_dword v76, v33, s[48:51], s26 offen
    s_add_u32 s26, s26, 896
    buffer_load_dword v77, v33, s[48:51], s26 offen
    s_add_u32 s26, s26, 896
    buffer_load_dword v78, v33, s[48:51], s26 offen
    s_add_u32 s26, s26, 896
    buffer_load_dword v79, v33, s[48:51], s26 offen
    s_add_u32 s26, s26, 896
    buffer_load_dword v80, v33, s[48:51], s26 offen
    s_add_u32 s26, s26, 896
    buffer_load_dword v81, v33, s[48:51], s26 offen
    s_add_u32 s26, s26, 896
    buffer_load_dword v82, v33, s[48:51], s26 offen
    s_add_u32 s26, s26, 896
    buffer_load_dword v83, v33, s[48:51], s26 offen
    s_add_u32 s26, s26, 896
    buffer_load_dword v84, v33, s[48:51], s26 offen
    s_add_u32 s26, s26, 896
    buffer_load_dword v85, v33, s[48:51], s26 offen
    s_add_u32 s26, s26, 896
    buffer_load_dword v86, v33, s[48:51], s26 offen
    s_add_u32 s26, s26, 896
    buffer_load_dword v87, v33, s[48:51], s26 offen
    s_add_u32 s26, s26, 896
    buffer_load_dword v88, v33, s[48:51], s26 offen
    s_add_u32 s26, s26, 896
    buffer_load_dword v89, v33, s[48:51], s26 offen
    s_add_u32 s26, s26, 896
    buffer_load_dword v90, v33, s[48:51], s26 offen
    s_add_u32 s26, s26, 896
    buffer_load_dword v91, v33, s[48:51], s26 offen
    s_add_u32 s26, s26, 896
    v_lshlrev_b32 v2, 5, v0
    s_mov_b32 s23, 91836416
    v_min_u32 v2, 7648, v2
    s_mov_b32 s36, 0
Lm_pd_117:
    buffer_load_dwordx4 v[8:11], v2, s[16:19], s23 offen sc1
    buffer_load_dwordx4 v[12:15], v2, s[16:19], s23 offen offset:16 sc1
    s_waitcnt vmcnt(0)
    v_max3_u32 v4, v8, v9, v10
    v_max3_u32 v5, v11, v12, v13
    v_max3_u32 v4, v4, v14, v15
    v_max_u32 v4, v4, v5
    v_cmp_eq_u32 vcc, -1, v4
    s_cbranch_vccz Lm_pd_117_ok
    s_sleep 4
    s_add_u32 s36, s36, 1
    s_cmp_lt_u32 s36, 400000
    s_cbranch_scc1 Lm_pd_117
Lm_pd_117_ok:
    v_lshlrev_b32 v3, 3, v0
    v_sub_u32 v3, 2047, v3
    v_ashrrev_i32 v4, 31, v8
    v_or_b32 v4, 0x80000000, v4
    v_xor_b32 v8, v8, v4
    v_and_b32 v8, 0xfffff800, v8
    v_subrev_u32 v4, 0, v3
    v_or_b32 v8, v8, v4
    v_ashrrev_i32 v4, 31, v9
    v_or_b32 v4, 0x80000000, v4
    v_xor_b32 v9, v9, v4
    v_and_b32 v9, 0xfffff800, v9
    v_subrev_u32 v4, 1, v3
    v_or_b32 v9, v9, v4
    v_ashrrev_i32 v4, 31, v10
    v_or_b32 v4, 0x80000000, v4
    v_xor_b32 v10, v10, v4
    v_and_b32 v10, 0xfffff800, v10
    v_subrev_u32 v4, 2, v3
    v_or_b32 v10, v10, v4
    v_ashrrev_i32 v4, 31, v11
    v_or_b32 v4, 0x80000000, v4
    v_xor_b32 v11, v11, v4
    v_and_b32 v11, 0xfffff800, v11
    v_subrev_u32 v4, 3, v3
    v_or_b32 v11, v11, v4
    v_ashrrev_i32 v4, 31, v12
    v_or_b32 v4, 0x80000000, v4
    v_xor_b32 v12, v12, v4
    v_and_b32 v12, 0xfffff800, v12
    v_subrev_u32 v4, 4, v3
    v_or_b32 v12, v12, v4
    v_ashrrev_i32 v4, 31, v13
    v_or_b32 v4, 0x80000000, v4
    v_xor_b32 v13, v13, v4
    v_and_b32 v13, 0xfffff800, v13
    v_subrev_u32 v4, 5, v3
    v_or_b32 v13, v13, v4
    v_ashrrev_i32 v4, 31, v14
    v_or_b32 v4, 0x80000000, v4
    v_xor_b32 v14, v14, v4
    v_and_b32 v14, 0xfffff800, v14
    v_subrev_u32 v4, 6, v3
    v_or_b32 v14, v14, v4
    v_ashrrev_i32 v4, 31, v15
    v_or_b32 v4, 0x80000000, v4
    v_xor_b32 v15, v15, v4
    v_and_b32 v15, 0xfffff800, v15
    v_subrev_u32 v4, 7, v3
    v_or_b32 v15, v15, v4
    v_cmp_gt_u32 vcc, 240, v0
    s_nop 1
    v_cndmask_b32 v8, 0, v8, vcc
    v_cndmask_b32 v9, 0, v9, vcc
    v_cndmask_b32 v10, 0, v10, vcc
    v_cndmask_b32 v11, 0, v11, vcc
    v_cndmask_b32 v12, 0, v12, vcc
    v_cndmask_b32 v13, 0, v13, vcc
    v_cndmask_b32 v14, 0, v14, vcc
    v_cndmask_b32 v15, 0, v15, vcc
    v_lshrrev_b32 v20, 6, v0
    v_lshlrev_b32 v20, 2, v20
    v_mov_b32 v21, 0
    s_barrier
    v_max3_u32 v16, v8, v9, v10
    v_max3_u32 v16, v16, v11, v12
    v_max3_u32 v16, v16, v13, v14
    v_max_u32 v16, v16, v15
    s_nop 1
    v_max_u32_dpp v16, v16, v16 row_ror:4 row_mask:0xf bank_mask:0xf
    s_nop 1
    v_max_u32_dpp v16, v16, v16 row_ror:2 row_mask:0xf bank_mask:0xf
    s_nop 1
    v_max_u32_dpp v16, v16, v16 row_ror:1 row_mask:0xf bank_mask:0xf
    s_nop 1
    v_max_u32_dpp v16, v16, v16 row_ror:8 row_mask:0xf bank_mask:0xf
    v_mov_b32 v17, v16
    s_nop 1
    v_permlane16_swap_b32 v16, v17
    v_max_u32 v16, v16, v17
    v_mov_b32 v17, v16
    s_nop 1
    v_permlane32_swap_b32 v16, v17
    v_max_u32 v16, v16, v17
    ds_write_b32 v20, v16 offset:0
    s_waitcnt lgkmcnt(0)
    s_barrier
    ds_read_b128 v[24:27], v21 offset:0
    s_waitcnt lgkmcnt(0)
    v_max3_u32 v16, v24, v25, v26
    v_max_u32 v16, v16, v27
    v_and_b32 v18, 0x7ff, v16
    v_sub_u32 v18, 2047, v18
    s_nop 0
    v_readfirstlane_b32 s40, v18
    v_cmp_ne_u32 vcc, v8, v16
    s_nop 1
    v_cndmask_b32 v8, 0, v8, vcc
    v_cmp_ne_u32 vcc, v9, v16
    s_nop 1
    v_cndmask_b32 v9, 0, v9, vcc
    v_cmp_ne_u32 vcc, v10, v16
    s_nop 1
    v_cndmask_b32 v10, 0, v10, vcc
    v_cmp_ne_u32 vcc, v11, v16
    s_nop 1
    v_cndmask_b32 v11, 0, v11, vcc
    v_cmp_ne_u32 vcc, v12, v16
    s_nop 1
    v_cndmask_b32 v12, 0, v12, vcc
    v_cmp_ne_u32 vcc, v13, v16
    s_nop 1
    v_cndmask_b32 v13, 0, v13, vcc
    v_cmp_ne_u32 vcc, v14, v16
    s_nop 1
    v_cndmask_b32 v14, 0, v14, vcc
    v_cmp_ne_u32 vcc, v15, v16
    s_nop 1
    v_cndmask_b32 v15, 0, v15, vcc
    v_max3_u32 v16, v8, v9, v10
    v_max3_u32 v16, v16, v11, v12
    v_max3_u32 v16, v16, v13, v14
    v_max_u32 v16, v16, v15
    s_nop 1
    v_max_u32_dpp v16, v16, v16 row_ror:4 row_mask:0xf bank_mask:0xf
    s_nop 1
    v_max_u32_dpp v16, v16, v16 row_ror:2 row_mask:0xf bank_mask:0xf
    s_nop 1
    v_max_u32_dpp v16, v16, v16 row_ror:1 row_mask:0xf bank_mask:0xf
    s_nop 1
    v_max_u32_dpp v16, v16, v16 row_ror:8 row_mask:0xf bank_mask:0xf
    v_mov_b32 v17, v16
    s_nop 1
    v_permlane16_swap_b32 v16, v17
    v_max_u32 v16, v16, v17
    v_mov_b32 v17, v16
    s_nop 1
    v_permlane32_swap_b32 v16, v17
    v_max_u32 v16, v16, v17
    ds_write_b32 v20, v16 offset:16
    s_waitcnt lgkmcnt(0)
    s_barrier
    ds_read_b128 v[24:27], v21 offset:16
    s_waitcnt lgkmcnt(0)
    v_max3_u32 v16, v24, v25, v26
    v_max_u32 v16, v16, v27
    v_and_b32 v18, 0x7ff, v16
    v_sub_u32 v18, 2047, v18
    s_nop 0
    v_readfirstlane_b32 s41, v18
    s_nop 3
    s_mov_b32 s54, s40
    s_mov_b32 s55, s41
    v_lshrrev_b32 v54, 3, v0
    v_and_b32 v54, 1, v54
    v_and_b32 v55, 7, v0
    v_mov_b32 v58, s40
    v_mov_b32 v59, s41
    v_cmp_eq_u32 vcc, 0, v54
    s_nop 1
    v_cndmask_b32 v58, v59, v58, vcc
    s_lshl_b32 s34, s43, 3
    v_add_u32 v59, s34, v55
    s_movk_i32 s35, 448
    v_mul_lo_u32 v160, v58, s35
    v_add_u32 v160, v160, v59
    v_lshlrev_b32 v163, 1, v160
    v_and_b32 v161, -4, v163
    s_mov_b32 s37, 90001408
    s_mov_b32 s36, 0
Lm_pd_118:
    buffer_load_dword v164, v161, s[16:19], s37 offen sc1
    s_waitcnt vmcnt(0)
    v_max3_u32 v4, v164, v164, v164
    v_cmp_eq_u32 vcc, -1, v4
    s_cbranch_vccz Lm_pd_118_ok
    s_sleep 1
    s_add_u32 s36, s36, 1
    s_cmp_lt_u32 s36, 400000
    s_cbranch_scc1 Lm_pd_118
Lm_pd_118_ok:
    buffer_load_ushort v162, v163, s[44:47], 0 offen sc1
    v_lshlrev_b32 v165, 2, v59
    s_mov_b32 s38, 16524032
    buffer_load_dword v166, v165, s[16:19], s38 offen
    v_lshlrev_b32 v167, 2, v58
    s_mov_b32 s39, 91836416
    buffer_load_dword v168, v167, s[16:19], s39 offen sc1
    v_lshlrev_b32 v35, 2, v32
    s_mov_b32 s27, 91844608
    s_mov_b32 s28, 91851776
    s_mov_b32 s36, 0
Lm_pd_119:
    buffer_load_dwordx4 v[96:99], v35, s[16:19], s27 offen offset:0 sc1
    buffer_load_dwordx4 v[128:131], v35, s[16:19], s28 offen offset:0 sc1
    buffer_load_dwordx4 v[100:103], v35, s[16:19], s27 offen offset:16 sc1
    buffer_load_dwordx4 v[132:135], v35, s[16:19], s28 offen offset:16 sc1
    buffer_load_dwordx4 v[104:107], v35, s[16:19], s27 offen offset:32 sc1
    buffer_load_dwordx4 v[136:139], v35, s[16:19], s28 offen offset:32 sc1
    buffer_load_dwordx4 v[108:111], v35, s[16:19], s27 offen offset:48 sc1
    buffer_load_dwordx4 v[140:143], v35, s[16:19], s28 offen offset:48 sc1
    buffer_load_dwordx4 v[112:115], v35, s[16:19], s27 offen offset:64 sc1
    buffer_load_dwordx4 v[144:147], v35, s[16:19], s28 offen offset:64 sc1
    buffer_load_dwordx4 v[116:119], v35, s[16:19], s27 offen offset:80 sc1
    buffer_load_dwordx4 v[148:151], v35, s[16:19], s28 offen offset:80 sc1
    buffer_load_dwordx4 v[120:123], v35, s[16:19], s27 offen offset:96 sc1
    buffer_load_dwordx4 v[152:155], v35, s[16:19], s28 offen offset:96 sc1
    s_waitcnt vmcnt(0)
    v_max3_u32 v4, v96, v97, v98
    v_max3_u32 v5, v99, v100, v101
    v_max3_u32 v4, v4, v102, v103
    v_max3_u32 v5, v5, v104, v105
    v_max3_u32 v4, v4, v106, v107
    v_max3_u32 v5, v5, v108, v109
    v_max3_u32 v4, v4, v110, v111
    v_max3_u32 v5, v5, v112, v113
    v_max3_u32 v4, v4, v114, v115
    v_max3_u32 v5, v5, v116, v117
    v_max3_u32 v4, v4, v118, v119
    v_max3_u32 v5, v5, v120, v121
    v_max3_u32 v4, v4, v122, v123
    v_max3_u32 v5, v5, v128, v129
    v_max3_u32 v4, v4, v130, v131
    v_max3_u32 v5, v5, v132, v133
    v_max3_u32 v4, v4, v134, v135
    v_max3_u32 v5, v5, v136, v137
    v_max3_u32 v4, v4, v138, v139
    v_max3_u32 v5, v5, v140, v141
    v_max3_u32 v4, v4, v142, v143
    v_max3_u32 v5, v5, v144, v145
    v_max3_u32 v4, v4, v146, v147
    v_max3_u32 v5, v5, v148, v149
    v_max3_u32 v4, v4, v150, v151
    v_max3_u32 v5, v5, v152, v153
    v_max3_u32 v4, v4, v154, v155
    v_max_u32 v4, v4, v5
    v_cmp_eq_u32 vcc, -1, v4
    s_cbranch_vccz Lm_pd_119_ok
    s_sleep 2
    s_add_u32 s36, s36, 1
    s_cmp_lt_u32 s36, 400000
    s_cbranch_scc1 Lm_pd_119
Lm_pd_119_ok:
    v_mov_b32 v40, 0
    v_mov_b32 v41, 0
    v_mov_b32 v42, 0
    v_mov_b32 v43, 0
    v_lshlrev_b32 v48, 16, v64
    v_and_b32 v49, 0xffff0000, v64
    v_fmac_f32 v40, v48, v96
    v_fmac_f32 v41, v49, v96
    v_fmac_f32 v42, v48, v128
    v_fmac_f32 v43, v49, v128
    v_lshlrev_b32 v48, 16, v65
    v_and_b32 v49, 0xffff0000, v65
    v_fmac_f32 v40, v48, v97
    v_fmac_f32 v41, v49, v97
    v_fmac_f32 v42, v48, v129
    v_fmac_f32 v43, v49, v129
    v_lshlrev_b32 v48, 16, v66
    v_and_b32 v49, 0xffff0000, v66
    v_fmac_f32 v40, v48, v98
    v_fmac_f32 v41, v49, v98
    v_fmac_f32 v42, v48, v130
    v_fmac_f32 v43, v49, v130
    v_lshlrev_b32 v48, 16, v67
    v_and_b32 v49, 0xffff0000, v67
    v_fmac_f32 v40, v48, v99
    v_fmac_f32 v41, v49, v99
    v_fmac_f32 v42, v48, v131
    v_fmac_f32 v43, v49, v131
    v_lshlrev_b32 v48, 16, v68
    v_and_b32 v49, 0xffff0000, v68
    v_fmac_f32 v40, v48, v100
    v_fmac_f32 v41, v49, v100
    v_fmac_f32 v42, v48, v132
    v_fmac_f32 v43, v49, v132
    v_lshlrev_b32 v48, 16, v69
    v_and_b32 v49, 0xffff0000, v69
    v_fmac_f32 v40, v48, v101
    v_fmac_f32 v41, v49, v101
    v_fmac_f32 v42, v48, v133
    v_fmac_f32 v43, v49, v133
    v_lshlrev_b32 v48, 16, v70
    v_and_b32 v49, 0xffff0000, v70
    v_fmac_f32 v40, v48, v102
    v_fmac_f32 v41, v49, v102
    v_fmac_f32 v42, v48, v134
    v_fmac_f32 v43, v49, v134
    v_lshlrev_b32 v48, 16, v71
    v_and_b32 v49, 0xffff0000, v71
    v_fmac_f32 v40, v48, v103
    v_fmac_f32 v41, v49, v103
    v_fmac_f32 v42, v48, v135
    v_fmac_f32 v43, v49, v135
    v_lshlrev_b32 v48, 16, v72
    v_and_b32 v49, 0xffff0000, v72
    v_fmac_f32 v40, v48, v104
    v_fmac_f32 v41, v49, v104
    v_fmac_f32 v42, v48, v136
    v_fmac_f32 v43, v49, v136
    v_lshlrev_b32 v48, 16, v73
    v_and_b32 v49, 0xffff0000, v73
    v_fmac_f32 v40, v48, v105
    v_fmac_f32 v41, v49, v105
    v_fmac_f32 v42, v48, v137
    v_fmac_f32 v43, v49, v137
    v_lshlrev_b32 v48, 16, v74
    v_and_b32 v49, 0xffff0000, v74
    v_fmac_f32 v40, v48, v106
    v_fmac_f32 v41, v49, v106
    v_fmac_f32 v42, v48, v138
    v_fmac_f32 v43, v49, v138
    v_lshlrev_b32 v48, 16, v75
    v_and_b32 v49, 0xffff0000, v75
    v_fmac_f32 v40, v48, v107
    v_fmac_f32 v41, v49, v107
    v_fmac_f32 v42, v48, v139
    v_fmac_f32 v43, v49, v139
    v_lshlrev_b32 v48, 16, v76
    v_and_b32 v49, 0xffff0000, v76
    v_fmac_f32 v40, v48, v108
    v_fmac_f32 v41, v49, v108
    v_fmac_f32 v42, v48, v140
    v_fmac_f32 v43, v49, v140
    v_lshlrev_b32 v48, 16, v77
    v_and_b32 v49, 0xffff0000, v77
    v_fmac_f32 v40, v48, v109
    v_fmac_f32 v41, v49, v109
    v_fmac_f32 v42, v48, v141
    v_fmac_f32 v43, v49, v141
    v_lshlrev_b32 v48, 16, v78
    v_and_b32 v49, 0xffff0000, v78
    v_fmac_f32 v40, v48, v110
    v_fmac_f32 v41, v49, v110
    v_fmac_f32 v42, v48, v142
    v_fmac_f32 v43, v49, v142
    v_lshlrev_b32 v48, 16, v79
    v_and_b32 v49, 0xffff0000, v79
    v_fmac_f32 v40, v48, v111
    v_fmac_f32 v41, v49, v111
    v_fmac_f32 v42, v48, v143
    v_fmac_f32 v43, v49, v143
    v_lshlrev_b32 v48, 16, v80
    v_and_b32 v49, 0xffff0000, v80
    v_fmac_f32 v40, v48, v112
    v_fmac_f32 v41, v49, v112
    v_fmac_f32 v42, v48, v144
    v_fmac_f32 v43, v49, v144
    v_lshlrev_b32 v48, 16, v81
    v_and_b32 v49, 0xffff0000, v81
    v_fmac_f32 v40, v48, v113
    v_fmac_f32 v41, v49, v113
    v_fmac_f32 v42, v48, v145
    v_fmac_f32 v43, v49, v145
    v_lshlrev_b32 v48, 16, v82
    v_and_b32 v49, 0xffff0000, v82
    v_fmac_f32 v40, v48, v114
    v_fmac_f32 v41, v49, v114
    v_fmac_f32 v42, v48, v146
    v_fmac_f32 v43, v49, v146
    v_lshlrev_b32 v48, 16, v83
    v_and_b32 v49, 0xffff0000, v83
    v_fmac_f32 v40, v48, v115
    v_fmac_f32 v41, v49, v115
    v_fmac_f32 v42, v48, v147
    v_fmac_f32 v43, v49, v147
    v_lshlrev_b32 v48, 16, v84
    v_and_b32 v49, 0xffff0000, v84
    v_fmac_f32 v40, v48, v116
    v_fmac_f32 v41, v49, v116
    v_fmac_f32 v42, v48, v148
    v_fmac_f32 v43, v49, v148
    v_lshlrev_b32 v48, 16, v85
    v_and_b32 v49, 0xffff0000, v85
    v_fmac_f32 v40, v48, v117
    v_fmac_f32 v41, v49, v117
    v_fmac_f32 v42, v48, v149
    v_fmac_f32 v43, v49, v149
    v_lshlrev_b32 v48, 16, v86
    v_and_b32 v49, 0xffff0000, v86
    v_fmac_f32 v40, v48, v118
    v_fmac_f32 v41, v49, v118
    v_fmac_f32 v42, v48, v150
    v_fmac_f32 v43, v49, v150
    v_lshlrev_b32 v48, 16, v87
    v_and_b32 v49, 0xffff0000, v87
    v_fmac_f32 v40, v48, v119
    v_fmac_f32 v41, v49, v119
    v_fmac_f32 v42, v48, v151
    v_fmac_f32 v43, v49, v151
    v_lshlrev_b32 v48, 16, v88
    v_and_b32 v49, 0xffff0000, v88
    v_fmac_f32 v40, v48, v120
    v_fmac_f32 v41, v49, v120
    v_fmac_f32 v42, v48, v152
    v_fmac_f32 v43, v49, v152
    v_lshlrev_b32 v48, 16, v89
    v_and_b32 v49, 0xffff0000, v89
    v_fmac_f32 v40, v48, v121
    v_fmac_f32 v41, v49, v121
    v_fmac_f32 v42, v48, v153
    v_fmac_f32 v43, v49, v153
    v_lshlrev_b32 v48, 16, v90
    v_and_b32 v49, 0xffff0000, v90
    v_fmac_f32 v40, v48, v122
    v_fmac_f32 v41, v49, v122
    v_fmac_f32 v42, v48, v154
    v_fmac_f32 v43, v49, v154
    v_lshlrev_b32 v48, 16, v91
    v_and_b32 v49, 0xffff0000, v91
    v_fmac_f32 v40, v48, v123
    v_fmac_f32 v41, v49, v123
    v_fmac_f32 v42, v48, v155
    v_fmac_f32 v43, v49, v155
    s_nop 1
    v_add_f32_dpp v40, v40, v40 row_ror:4 row_mask:0xf bank_mask:0xf
    s_nop 1
    v_add_f32_dpp v40, v40, v40 row_ror:8 row_mask:0xf bank_mask:0xf
    v_mov_b32 v52, v40
    s_nop 1
    v_permlane16_swap_b32 v40, v52
    v_add_f32 v40, v40, v52
    v_mov_b32 v52, v40
    s_nop 1
    v_permlane32_swap_b32 v40, v52
    v_add_f32 v40, v40, v52
    s_nop 1
    v_add_f32_dpp v41, v41, v41 row_ror:4 row_mask:0xf bank_mask:0xf
    s_nop 1
    v_add_f32_dpp v41, v41, v41 row_ror:8 row_mask:0xf bank_mask:0xf
    v_mov_b32 v52, v41
    s_nop 1
    v_permlane16_swap_b32 v41, v52
    v_add_f32 v41, v41, v52
    v_mov_b32 v52, v41
    s_nop 1
    v_permlane32_swap_b32 v41, v52
    v_add_f32 v41, v41, v52
    s_nop 1
    v_add_f32_dpp v42, v42, v42 row_ror:4 row_mask:0xf bank_mask:0xf
    s_nop 1
    v_add_f32_dpp v42, v42, v42 row_ror:8 row_mask:0xf bank_mask:0xf
    v_mov_b32 v52, v42
    s_nop 1
    v_permlane16_swap_b32 v42, v52
    v_add_f32 v42, v42, v52
    v_mov_b32 v52, v42
    s_nop 1
    v_permlane32_swap_b32 v42, v52
    v_add_f32 v42, v42, v52
    s_nop 1
    v_add_f32_dpp v43, v43, v43 row_ror:4 row_mask:0xf bank_mask:0xf
    s_nop 1
    v_add_f32_dpp v43, v43, v43 row_ror:8 row_mask:0xf bank_mask:0xf
    v_mov_b32 v52, v43
    s_nop 1
    v_permlane16_swap_b32 v43, v52
    v_add_f32 v43, v43, v52
    v_mov_b32 v52, v43
    s_nop 1
    v_permlane32_swap_b32 v43, v52
    v_add_f32 v43, v43, v52
    v_lshlrev_b32 v53, 4, v30
    s_lshl_b32 s30, s22, 6
    s_add_u32 s30, s30, 64
    v_add_u32 v53, s30, v53
    s_mov_b64 exec, 0xf
    ds_write_b128 v53, v[40:43]
    s_mov_b64 exec, -1
    s_waitcnt lgkmcnt(0)
    s_barrier
    v_lshrrev_b32 v56, 1, v55
    v_lshlrev_b32 v56, 2, v56
    v_lshlrev_b32 v57, 1, v54
    v_add_u32 v56, v56, v57
    v_and_b32 v57, 1, v55
    v_add_u32 v56, v56, v57
    v_lshlrev_b32 v56, 2, v56
    v_add_u32 v56, 64, v56
    ds_read_b32 v156, v56 offset:0
    ds_read_b32 v157, v56 offset:64
    ds_read_b32 v158, v56 offset:128
    ds_read_b32 v159, v56 offset:192
    s_waitcnt lgkmcnt(0)
    v_add_f32 v156, v156, v157
    v_add_f32 v158, v158, v159
    v_add_f32 v156, v156, v158
    v_cvt_pk_bf16_f32 v156, v156, v156
    v_lshlrev_b32 v156, 16, v156
    v_mul_f32 v168, 0xbfb8aa3b, v168
    v_exp_f32 v168, v168
    s_nop 0
    v_add_f32 v168, 1.0, v168
    v_rcp_f32 v168, v168
    s_nop 0
    v_mul_f32 v156, v156, v168
    v_cvt_pk_bf16_f32 v156, v156, v156
    v_lshlrev_b32 v156, 16, v156
    v_lshlrev_b32 v162, 16, v162
    v_fmac_f32 v162, v166, v156
    v_cvt_pk_bf16_f32 v162, v162, v162
    v_lshlrev_b32 v2, 5, v0
    s_mov_b32 s23, 91836416
    s_mov_b32 s36, 0
Lm_pd_120:
    buffer_load_dwordx4 v[8:11], v2, s[16:19], s23 offen sc1
    buffer_load_dwordx4 v[12:15], v2, s[16:19], s23 offen offset:16 sc1
    s_waitcnt vmcnt(0)
    v_max3_u32 v4, v8, v9, v10
    v_max3_u32 v5, v11, v12, v13
    v_max3_u32 v4, v4, v14, v15
    v_max_u32 v4, v4, v5
    v_cmp_eq_u32 vcc, -1, v4
    s_cbranch_vccz Lm_pd_120_ok
    s_sleep 2
    s_add_u32 s36, s36, 1
    s_cmp_lt_u32 s36, 400000
    s_cbranch_scc1 Lm_pd_120
Lm_pd_120_ok:
    v_lshlrev_b32 v3, 3, v0
    v_sub_u32 v3, 2047, v3
    v_ashrrev_i32 v4, 31, v8
    v_or_b32 v4, 0x80000000, v4
    v_xor_b32 v8, v8, v4
    v_and_b32 v8, 0xfffff800, v8
    v_subrev_u32 v4, 0, v3
    v_or_b32 v8, v8, v4
    v_ashrrev_i32 v4, 31, v9
    v_or_b32 v4, 0x80000000, v4
    v_xor_b32 v9, v9, v4
    v_and_b32 v9, 0xfffff800, v9
    v_subrev_u32 v4, 1, v3
    v_or_b32 v9, v9, v4
    v_ashrrev_i32 v4, 31, v10
    v_or_b32 v4, 0x80000000, v4
    v_xor_b32 v10, v10, v4
    v_and_b32 v10, 0xfffff800, v10
    v_subrev_u32 v4, 2, v3
    v_or_b32 v10, v10, v4
    v_ashrrev_i32 v4, 31, v11
    v_or_b32 v4, 0x80000000, v4
    v_xor_b32 v11, v11, v4
    v_and_b32 v11, 0xfffff800, v11
    v_subrev_u32 v4, 3, v3
    v_or_b32 v11, v11, v4
    v_ashrrev_i32 v4, 31, v12
    v_or_b32 v4, 0x80000000, v4
    v_xor_b32 v12, v12, v4
    v_and_b32 v12, 0xfffff800, v12
    v_subrev_u32 v4, 4, v3
    v_or_b32 v12, v12, v4
    v_ashrrev_i32 v4, 31, v13
    v_or_b32 v4, 0x80000000, v4
    v_xor_b32 v13, v13, v4
    v_and_b32 v13, 0xfffff800, v13
    v_subrev_u32 v4, 5, v3
    v_or_b32 v13, v13, v4
    v_ashrrev_i32 v4, 31, v14
    v_or_b32 v4, 0x80000000, v4
    v_xor_b32 v14, v14, v4
    v_and_b32 v14, 0xfffff800, v14
    v_subrev_u32 v4, 6, v3
    v_or_b32 v14, v14, v4
    v_ashrrev_i32 v4, 31, v15
    v_or_b32 v4, 0x80000000, v4
    v_xor_b32 v15, v15, v4
    v_and_b32 v15, 0xfffff800, v15
    v_subrev_u32 v4, 7, v3
    v_or_b32 v15, v15, v4
    v_lshrrev_b32 v20, 6, v0
    v_lshlrev_b32 v20, 2, v20
    v_mov_b32 v21, 0
    s_barrier
    v_max3_u32 v16, v8, v9, v10
    v_max3_u32 v16, v16, v11, v12
    v_max3_u32 v16, v16, v13, v14
    v_max_u32 v16, v16, v15
    s_nop 1
    v_max_u32_dpp v16, v16, v16 row_ror:4 row_mask:0xf bank_mask:0xf
    s_nop 1
    v_max_u32_dpp v16, v16, v16 row_ror:2 row_mask:0xf bank_mask:0xf
    s_nop 1
    v_max_u32_dpp v16, v16, v16 row_ror:1 row_mask:0xf bank_mask:0xf
    s_nop 1
    v_max_u32_dpp v16, v16, v16 row_ror:8 row_mask:0xf bank_mask:0xf
    v_mov_b32 v17, v16
    s_nop 1
    v_permlane16_swap_b32 v16, v17
    v_max_u32 v16, v16, v17
    v_mov_b32 v17, v16
    s_nop 1
    v_permlane32_swap_b32 v16, v17
    v_max_u32 v16, v16, v17
    ds_write_b32 v20, v16 offset:0
    s_waitcnt lgkmcnt(0)
    s_barrier
    ds_read_b128 v[24:27], v21 offset:0
    s_waitcnt lgkmcnt(0)
    v_max3_u32 v16, v24, v25, v26
    v_max_u32 v16, v16, v27
    v_and_b32 v18, 0x7ff, v16
    v_sub_u32 v18, 2047, v18
    s_nop 0
    v_readfirstlane_b32 s40, v18
    v_cmp_ne_u32 vcc, v8, v16
    s_nop 1
    v_cndmask_b32 v8, 0, v8, vcc
    v_cmp_ne_u32 vcc, v9, v16
    s_nop 1
    v_cndmask_b32 v9, 0, v9, vcc
    v_cmp_ne_u32 vcc, v10, v16
    s_nop 1
    v_cndmask_b32 v10, 0, v10, vcc
    v_cmp_ne_u32 vcc, v11, v16
    s_nop 1
    v_cndmask_b32 v11, 0, v11, vcc
    v_cmp_ne_u32 vcc, v12, v16
    s_nop 1
    v_cndmask_b32 v12, 0, v12, vcc
    v_cmp_ne_u32 vcc, v13, v16
    s_nop 1
    v_cndmask_b32 v13, 0, v13, vcc
    v_cmp_ne_u32 vcc, v14, v16
    s_nop 1
    v_cndmask_b32 v14, 0, v14, vcc
    v_cmp_ne_u32 vcc, v15, v16
    s_nop 1
    v_cndmask_b32 v15, 0, v15, vcc
    v_max3_u32 v16, v8, v9, v10
    v_max3_u32 v16, v16, v11, v12
    v_max3_u32 v16, v16, v13, v14
    v_max_u32 v16, v16, v15
    s_nop 1
    v_max_u32_dpp v16, v16, v16 row_ror:4 row_mask:0xf bank_mask:0xf
    s_nop 1
    v_max_u32_dpp v16, v16, v16 row_ror:2 row_mask:0xf bank_mask:0xf
    s_nop 1
    v_max_u32_dpp v16, v16, v16 row_ror:1 row_mask:0xf bank_mask:0xf
    s_nop 1
    v_max_u32_dpp v16, v16, v16 row_ror:8 row_mask:0xf bank_mask:0xf
    v_mov_b32 v17, v16
    s_nop 1
    v_permlane16_swap_b32 v16, v17
    v_max_u32 v16, v16, v17
    v_mov_b32 v17, v16
    s_nop 1
    v_permlane32_swap_b32 v16, v17
    v_max_u32 v16, v16, v17
    ds_write_b32 v20, v16 offset:16
    s_waitcnt lgkmcnt(0)
    s_barrier
    ds_read_b128 v[24:27], v21 offset:16
    s_waitcnt lgkmcnt(0)
    v_max3_u32 v16, v24, v25, v26
    v_max_u32 v16, v16, v27
    v_and_b32 v18, 0x7ff, v16
    v_sub_u32 v18, 2047, v18
    s_nop 0
    v_readfirstlane_b32 s41, v18
    s_nop 3
    s_cmp_eq_u32 s40, s54
    s_cselect_b32 s56, 1, 0
    s_cmp_eq_u32 s41, s55
    s_cselect_b32 s56, s56, 0
    s_cmp_eq_u32 s56, 1
    s_cbranch_scc1 Lm_dd_121
    v_lshrrev_b32 v54, 3, v0
    v_and_b32 v54, 1, v54
    v_and_b32 v55, 7, v0
    v_mov_b32 v58, s40
    v_mov_b32 v59, s41
    v_cmp_eq_u32 vcc, 0, v54
    s_nop 1
    v_cndmask_b32 v58, v59, v58, vcc
    s_lshl_b32 s34, s43, 3
    v_add_u32 v59, s34, v55
    s_movk_i32 s35, 448
    v_mul_lo_u32 v160, v58, s35
    v_add_u32 v160, v160, v59
    v_lshlrev_b32 v163, 1, v160
    v_and_b32 v161, -4, v163
    s_mov_b32 s37, 90001408
    s_mov_b32 s36, 0
Lm_pd_122:
    buffer_load_dword v164, v161, s[16:19], s37 offen sc1
    s_waitcnt vmcnt(0)
    v_max3_u32 v4, v164, v164, v164
    v_cmp_eq_u32 vcc, -1, v4
    s_cbranch_vccz Lm_pd_122_ok
    s_sleep 1
    s_add_u32 s36, s36, 1
    s_cmp_lt_u32 s36, 400000
    s_cbranch_scc1 Lm_pd_122
Lm_pd_122_ok:
    buffer_load_ushort v162, v163, s[44:47], 0 offen sc1
    v_lshlrev_b32 v165, 2, v59
    s_mov_b32 s38, 16524032
    buffer_load_dword v166, v165, s[16:19], s38 offen
    v_lshlrev_b32 v167, 2, v58
    s_mov_b32 s39, 91836416
    buffer_load_dword v168, v167, s[16:19], s39 offen sc1
    v_lshlrev_b32 v35, 2, v32
    s_mov_b32 s27, 91860992
    s_mov_b32 s28, 91868160
    s_mov_b32 s36, 0
Lm_pd_123:
    buffer_load_dwordx4 v[96:99], v35, s[16:19], s27 offen offset:0 sc1
    buffer_load_dwordx4 v[128:131], v35, s[16:19], s28 offen offset:0 sc1
    buffer_load_dwordx4 v[100:103], v35, s[16:19], s27 offen offset:16 sc1
    buffer_load_dwordx4 v[132:135], v35, s[16:19], s28 offen offset:16 sc1
    buffer_load_dwordx4 v[104:107], v35, s[16:19], s27 offen offset:32 sc1
    buffer_load_dwordx4 v[136:139], v35, s[16:19], s28 offen offset:32 sc1
    buffer_load_dwordx4 v[108:111], v35, s[16:19], s27 offen offset:48 sc1
    buffer_load_dwordx4 v[140:143], v35, s[16:19], s28 offen offset:48 sc1
    buffer_load_dwordx4 v[112:115], v35, s[16:19], s27 offen offset:64 sc1
    buffer_load_dwordx4 v[144:147], v35, s[16:19], s28 offen offset:64 sc1
    buffer_load_dwordx4 v[116:119], v35, s[16:19], s27 offen offset:80 sc1
    buffer_load_dwordx4 v[148:151], v35, s[16:19], s28 offen offset:80 sc1
    buffer_load_dwordx4 v[120:123], v35, s[16:19], s27 offen offset:96 sc1
    buffer_load_dwordx4 v[152:155], v35, s[16:19], s28 offen offset:96 sc1
    s_waitcnt vmcnt(0)
    v_max3_u32 v4, v96, v97, v98
    v_max3_u32 v5, v99, v100, v101
    v_max3_u32 v4, v4, v102, v103
    v_max3_u32 v5, v5, v104, v105
    v_max3_u32 v4, v4, v106, v107
    v_max3_u32 v5, v5, v108, v109
    v_max3_u32 v4, v4, v110, v111
    v_max3_u32 v5, v5, v112, v113
    v_max3_u32 v4, v4, v114, v115
    v_max3_u32 v5, v5, v116, v117
    v_max3_u32 v4, v4, v118, v119
    v_max3_u32 v5, v5, v120, v121
    v_max3_u32 v4, v4, v122, v123
    v_max3_u32 v5, v5, v128, v129
    v_max3_u32 v4, v4, v130, v131
    v_max3_u32 v5, v5, v132, v133
    v_max3_u32 v4, v4, v134, v135
    v_max3_u32 v5, v5, v136, v137
    v_max3_u32 v4, v4, v138, v139
    v_max3_u32 v5, v5, v140, v141
    v_max3_u32 v4, v4, v142, v143
    v_max3_u32 v5, v5, v144, v145
    v_max3_u32 v4, v4, v146, v147
    v_max3_u32 v5, v5, v148, v149
    v_max3_u32 v4, v4, v150, v151
    v_max3_u32 v5, v5, v152, v153
    v_max3_u32 v4, v4, v154, v155
    v_max_u32 v4, v4, v5
    v_cmp_eq_u32 vcc, -1, v4
    s_cbranch_vccz Lm_pd_123_ok
    s_sleep 2
    s_add_u32 s36, s36, 1
    s_cmp_lt_u32 s36, 400000
    s_cbranch_scc1 Lm_pd_123
Lm_pd_123_ok:
    v_mov_b32 v40, 0
    v_mov_b32 v41, 0
    v_mov_b32 v42, 0
    v_mov_b32 v43, 0
    v_lshlrev_b32 v48, 16, v64
    v_and_b32 v49, 0xffff0000, v64
    v_fmac_f32 v40, v48, v96
    v_fmac_f32 v41, v49, v96
    v_fmac_f32 v42, v48, v128
    v_fmac_f32 v43, v49, v128
    v_lshlrev_b32 v48, 16, v65
    v_and_b32 v49, 0xffff0000, v65
    v_fmac_f32 v40, v48, v97
    v_fmac_f32 v41, v49, v97
    v_fmac_f32 v42, v48, v129
    v_fmac_f32 v43, v49, v129
    v_lshlrev_b32 v48, 16, v66
    v_and_b32 v49, 0xffff0000, v66
    v_fmac_f32 v40, v48, v98
    v_fmac_f32 v41, v49, v98
    v_fmac_f32 v42, v48, v130
    v_fmac_f32 v43, v49, v130
    v_lshlrev_b32 v48, 16, v67
    v_and_b32 v49, 0xffff0000, v67
    v_fmac_f32 v40, v48, v99
    v_fmac_f32 v41, v49, v99
    v_fmac_f32 v42, v48, v131
    v_fmac_f32 v43, v49, v131
    v_lshlrev_b32 v48, 16, v68
    v_and_b32 v49, 0xffff0000, v68
    v_fmac_f32 v40, v48, v100
    v_fmac_f32 v41, v49, v100
    v_fmac_f32 v42, v48, v132
    v_fmac_f32 v43, v49, v132
    v_lshlrev_b32 v48, 16, v69
    v_and_b32 v49, 0xffff0000, v69
    v_fmac_f32 v40, v48, v101
    v_fmac_f32 v41, v49, v101
    v_fmac_f32 v42, v48, v133
    v_fmac_f32 v43, v49, v133
    v_lshlrev_b32 v48, 16, v70
    v_and_b32 v49, 0xffff0000, v70
    v_fmac_f32 v40, v48, v102
    v_fmac_f32 v41, v49, v102
    v_fmac_f32 v42, v48, v134
    v_fmac_f32 v43, v49, v134
    v_lshlrev_b32 v48, 16, v71
    v_and_b32 v49, 0xffff0000, v71
    v_fmac_f32 v40, v48, v103
    v_fmac_f32 v41, v49, v103
    v_fmac_f32 v42, v48, v135
    v_fmac_f32 v43, v49, v135
    v_lshlrev_b32 v48, 16, v72
    v_and_b32 v49, 0xffff0000, v72
    v_fmac_f32 v40, v48, v104
    v_fmac_f32 v41, v49, v104
    v_fmac_f32 v42, v48, v136
    v_fmac_f32 v43, v49, v136
    v_lshlrev_b32 v48, 16, v73
    v_and_b32 v49, 0xffff0000, v73
    v_fmac_f32 v40, v48, v105
    v_fmac_f32 v41, v49, v105
    v_fmac_f32 v42, v48, v137
    v_fmac_f32 v43, v49, v137
    v_lshlrev_b32 v48, 16, v74
    v_and_b32 v49, 0xffff0000, v74
    v_fmac_f32 v40, v48, v106
    v_fmac_f32 v41, v49, v106
    v_fmac_f32 v42, v48, v138
    v_fmac_f32 v43, v49, v138
    v_lshlrev_b32 v48, 16, v75
    v_and_b32 v49, 0xffff0000, v75
    v_fmac_f32 v40, v48, v107
    v_fmac_f32 v41, v49, v107
    v_fmac_f32 v42, v48, v139
    v_fmac_f32 v43, v49, v139
    v_lshlrev_b32 v48, 16, v76
    v_and_b32 v49, 0xffff0000, v76
    v_fmac_f32 v40, v48, v108
    v_fmac_f32 v41, v49, v108
    v_fmac_f32 v42, v48, v140
    v_fmac_f32 v43, v49, v140
    v_lshlrev_b32 v48, 16, v77
    v_and_b32 v49, 0xffff0000, v77
    v_fmac_f32 v40, v48, v109
    v_fmac_f32 v41, v49, v109
    v_fmac_f32 v42, v48, v141
    v_fmac_f32 v43, v49, v141
    v_lshlrev_b32 v48, 16, v78
    v_and_b32 v49, 0xffff0000, v78
    v_fmac_f32 v40, v48, v110
    v_fmac_f32 v41, v49, v110
    v_fmac_f32 v42, v48, v142
    v_fmac_f32 v43, v49, v142
    v_lshlrev_b32 v48, 16, v79
    v_and_b32 v49, 0xffff0000, v79
    v_fmac_f32 v40, v48, v111
    v_fmac_f32 v41, v49, v111
    v_fmac_f32 v42, v48, v143
    v_fmac_f32 v43, v49, v143
    v_lshlrev_b32 v48, 16, v80
    v_and_b32 v49, 0xffff0000, v80
    v_fmac_f32 v40, v48, v112
    v_fmac_f32 v41, v49, v112
    v_fmac_f32 v42, v48, v144
    v_fmac_f32 v43, v49, v144
    v_lshlrev_b32 v48, 16, v81
    v_and_b32 v49, 0xffff0000, v81
    v_fmac_f32 v40, v48, v113
    v_fmac_f32 v41, v49, v113
    v_fmac_f32 v42, v48, v145
    v_fmac_f32 v43, v49, v145
    v_lshlrev_b32 v48, 16, v82
    v_and_b32 v49, 0xffff0000, v82
    v_fmac_f32 v40, v48, v114
    v_fmac_f32 v41, v49, v114
    v_fmac_f32 v42, v48, v146
    v_fmac_f32 v43, v49, v146
    v_lshlrev_b32 v48, 16, v83
    v_and_b32 v49, 0xffff0000, v83
    v_fmac_f32 v40, v48, v115
    v_fmac_f32 v41, v49, v115
    v_fmac_f32 v42, v48, v147
    v_fmac_f32 v43, v49, v147
    v_lshlrev_b32 v48, 16, v84
    v_and_b32 v49, 0xffff0000, v84
    v_fmac_f32 v40, v48, v116
    v_fmac_f32 v41, v49, v116
    v_fmac_f32 v42, v48, v148
    v_fmac_f32 v43, v49, v148
    v_lshlrev_b32 v48, 16, v85
    v_and_b32 v49, 0xffff0000, v85
    v_fmac_f32 v40, v48, v117
    v_fmac_f32 v41, v49, v117
    v_fmac_f32 v42, v48, v149
    v_fmac_f32 v43, v49, v149
    v_lshlrev_b32 v48, 16, v86
    v_and_b32 v49, 0xffff0000, v86
    v_fmac_f32 v40, v48, v118
    v_fmac_f32 v41, v49, v118
    v_fmac_f32 v42, v48, v150
    v_fmac_f32 v43, v49, v150
    v_lshlrev_b32 v48, 16, v87
    v_and_b32 v49, 0xffff0000, v87
    v_fmac_f32 v40, v48, v119
    v_fmac_f32 v41, v49, v119
    v_fmac_f32 v42, v48, v151
    v_fmac_f32 v43, v49, v151
    v_lshlrev_b32 v48, 16, v88
    v_and_b32 v49, 0xffff0000, v88
    v_fmac_f32 v40, v48, v120
    v_fmac_f32 v41, v49, v120
    v_fmac_f32 v42, v48, v152
    v_fmac_f32 v43, v49, v152
    v_lshlrev_b32 v48, 16, v89
    v_and_b32 v49, 0xffff0000, v89
    v_fmac_f32 v40, v48, v121
    v_fmac_f32 v41, v49, v121
    v_fmac_f32 v42, v48, v153
    v_fmac_f32 v43, v49, v153
    v_lshlrev_b32 v48, 16, v90
    v_and_b32 v49, 0xffff0000, v90
    v_fmac_f32 v40, v48, v122
    v_fmac_f32 v41, v49, v122
    v_fmac_f32 v42, v48, v154
    v_fmac_f32 v43, v49, v154
    v_lshlrev_b32 v48, 16, v91
    v_and_b32 v49, 0xffff0000, v91
    v_fmac_f32 v40, v48, v123
    v_fmac_f32 v41, v49, v123
    v_fmac_f32 v42, v48, v155
    v_fmac_f32 v43, v49, v155
    s_nop 1
    v_add_f32_dpp v40, v40, v40 row_ror:4 row_mask:0xf bank_mask:0xf
    s_nop 1
    v_add_f32_dpp v40, v40, v40 row_ror:8 row_mask:0xf bank_mask:0xf
    v_mov_b32 v52, v40
    s_nop 1
    v_permlane16_swap_b32 v40, v52
    v_add_f32 v40, v40, v52
    v_mov_b32 v52, v40
    s_nop 1
    v_permlane32_swap_b32 v40, v52
    v_add_f32 v40, v40, v52
    s_nop 1
    v_add_f32_dpp v41, v41, v41 row_ror:4 row_mask:0xf bank_mask:0xf
    s_nop 1
    v_add_f32_dpp v41, v41, v41 row_ror:8 row_mask:0xf bank_mask:0xf
    v_mov_b32 v52, v41
    s_nop 1
    v_permlane16_swap_b32 v41, v52
    v_add_f32 v41, v41, v52
    v_mov_b32 v52, v41
    s_nop 1
    v_permlane32_swap_b32 v41, v52
    v_add_f32 v41, v41, v52
    s_nop 1
    v_add_f32_dpp v42, v42, v42 row_ror:4 row_mask:0xf bank_mask:0xf
    s_nop 1
    v_add_f32_dpp v42, v42, v42 row_ror:8 row_mask:0xf bank_mask:0xf
    v_mov_b32 v52, v42
    s_nop 1
    v_permlane16_swap_b32 v42, v52
    v_add_f32 v42, v42, v52
    v_mov_b32 v52, v42
    s_nop 1
    v_permlane32_swap_b32 v42, v52
    v_add_f32 v42, v42, v52
    s_nop 1
    v_add_f32_dpp v43, v43, v43 row_ror:4 row_mask:0xf bank_mask:0xf
    s_nop 1
    v_add_f32_dpp v43, v43, v43 row_ror:8 row_mask:0xf bank_mask:0xf
    v_mov_b32 v52, v43
    s_nop 1
    v_permlane16_swap_b32 v43, v52
    v_add_f32 v43, v43, v52
    v_mov_b32 v52, v43
    s_nop 1
    v_permlane32_swap_b32 v43, v52
    v_add_f32 v43, v43, v52
    v_lshlrev_b32 v53, 4, v30
    s_lshl_b32 s30, s22, 6
    s_add_u32 s30, s30, 64
    v_add_u32 v53, s30, v53
    s_mov_b64 exec, 0xf
    ds_write_b128 v53, v[40:43]
    s_mov_b64 exec, -1
    s_waitcnt lgkmcnt(0)
    s_barrier
    v_lshrrev_b32 v56, 1, v55
    v_lshlrev_b32 v56, 2, v56
    v_lshlrev_b32 v57, 1, v54
    v_add_u32 v56, v56, v57
    v_and_b32 v57, 1, v55
    v_add_u32 v56, v56, v57
    v_lshlrev_b32 v56, 2, v56
    v_add_u32 v56, 64, v56
    ds_read_b32 v156, v56 offset:0
    ds_read_b32 v157, v56 offset:64
    ds_read_b32 v158, v56 offset:128
    ds_read_b32 v159, v56 offset:192
    s_waitcnt lgkmcnt(0)
    v_add_f32 v156, v156, v157
    v_add_f32 v158, v158, v159
    v_add_f32 v156, v156, v158
    v_cvt_pk_bf16_f32 v156, v156, v156
    v_lshlrev_b32 v156, 16, v156
    v_mul_f32 v168, 0xbfb8aa3b, v168
    v_exp_f32 v168, v168
    s_nop 0
    v_add_f32 v168, 1.0, v168
    v_rcp_f32 v168, v168
    s_nop 0
    v_mul_f32 v156, v156, v168
    v_cvt_pk_bf16_f32 v156, v156, v156
    v_lshlrev_b32 v156, 16, v156
    v_lshlrev_b32 v162, 16, v162
    v_fmac_f32 v162, v166, v156
    v_cvt_pk_bf16_f32 v162, v162, v162
Lm_dd_121:
    v_cmp_gt_u32 vcc, 16, v0
    s_and_saveexec_b64 s[32:33], vcc
    s_cbranch_execz Lm_df_124
    buffer_store_short v162, v163, s[44:47], 0 offen sc1
Lm_df_124:
    s_mov_b64 exec, s[32:33]
Lm_tdone:
Lm_fin:
Lm_wfin:
    s_waitcnt vmcnt(0)
Lm_exit:
    s_endpgm

.section .rodata,"a"
.p2align 6
.amdhsa_kernel main_kernel
  .amdhsa_next_free_vgpr 512
  .amdhsa_next_free_sgpr 102
  .amdhsa_accum_offset 256
  .amdhsa_group_segment_fixed_size 0
  .amdhsa_kernarg_size 136
  .amdhsa_user_sgpr_count 2
  .amdhsa_user_sgpr_kernarg_segment_ptr 1
  .amdhsa_system_sgpr_workgroup_id_x 1
.end_amdhsa_kernel
```
